```python
import torch

def _softmax(x, axis=-1):
    return torch.softmax(x, dim=axis)
def _gelu(x):
    return torch.nn.functional.gelu(x, approximate="tanh")
def _silu(x):
    return torch.nn.functional.silu(x)
def _sigmoid(x):
    return torch.sigmoid(x)
def _layernorm(x, axis=-1, eps=1e-5):
    m = x.mean(dim=axis, keepdim=True)
    v = x.var(dim=axis, keepdim=True, unbiased=False)
    return (x - m) / torch.sqrt(v + eps)
def _scatter_add(tgt, idx, src, axis=0):
    return tgt.clone().index_add_(axis, idx, src)
def _segment_sum(src, seg, n):
    out = torch.zeros((n,) + src.shape[1:], dtype=src.dtype)
    return out.index_add_(0, seg, src)
def _pad(x, pw):
    flat = tuple(v for pair in reversed(pw) for v in pair)
    return torch.nn.functional.pad(x, flat)

kernel_name = 'standalone__mha_block_cached__near_ridge'

def setup_inputs():

    _w = (lambda a: (lambda t: t.to(torch.bfloat16) if t.is_floating_point() else t)(torch.as_tensor(a)))
    B, Sq, D = 16, 192, 1024
    H, Sk, Dh = 32, 1024, 128
    return {
        "x": _w((lambda *s: torch.randn(*s, dtype=torch.bfloat16) * 0.8)(B, Sq, D)),
        "k_cache": _w((lambda *s: torch.randn(*s, dtype=torch.bfloat16) * 0.8)(B, H, Sk, Dh)),
        "v_cache": _w((lambda *s: torch.randn(*s, dtype=torch.bfloat16) * 0.05)(B, H, Sk, Dh)),
        "wq": _w((lambda *s: torch.randn(*s, dtype=torch.bfloat16) * 0.8)(D, H * Dh) * (D ** -0.5)),
        "wo": _w((lambda *s: torch.randn(*s, dtype=torch.bfloat16) * 0.05)(H * Dh, D) * ((H * Dh) ** -0.5)),
    }

def reference(x, k_cache, v_cache, wq, wo):
    B, Sq, D = x.shape
    H, Dh = 32, 128
    q = (lambda x, *d: x.permute(*d))((x @ wq).reshape(B, Sq, H, Dh), 0, 2, 1, 3)
    scores = torch.einsum("bhqd,bhkd->bhqk", q, k_cache) * (Dh ** -0.5)
    p = _softmax(scores, axis=-1)
    o = torch.einsum("bhqk,bhkd->bhqd", p, v_cache)
    return (lambda x, *d: x.permute(*d))(o, 0, 2, 1, 3).reshape(B, Sq, H * Dh) @ wo
```

```asm
; @launch kernel=mha_qattn_kernel grid=(256,1,1) block=(256,1,1) lds=163840
.amdgcn_target "amdgcn-amd-amdhsa--gfx950"
.text
.globl mha_qattn_kernel
.p2align 8
.type mha_qattn_kernel,@function
mha_qattn_kernel:
 s_cmp_ge_u32 s2, 256
 s_cbranch_scc1 L1_end
 s_load_dwordx16 s[4:19], s[0:1], 0
 v_lshrrev_b32 v2, 6, v0
 v_and_b32 v1, 63, v0
 s_and_b32 s3, s2, 7
 s_lshr_b32 s42, s2, 3
 v_readfirstlane_b32 s36, v2
 s_and_b32 s43, s3, 1
 s_and_b32 s44, s42, 7
 s_lshl_b32 s43, s43, 3
 s_add_u32 s37, s43, s44
 s_lshr_b32 s43, s3, 1
 s_lshl_b32 s43, s43, 2
 s_lshr_b32 s38, s42, 3
 s_add_u32 s38, s38, s43
 s_lshr_b32 s43, s3, 2
 s_lshl_b32 s43, s43, 3
 s_and_b32 s44, s42, 7
 s_add_u32 s37, s43, s44
 s_and_b32 s43, s3, 2
 s_lshl_b32 s43, s43, 1
 s_and_b32 s44, s3, 1
 s_lshl3_add_u32 s38, s44, s43
 s_lshr_b32 s43, s42, 3
 s_xor_b32 s43, s43, 1
 s_add_u32 s38, s38, s43
 s_and_b32 s40, s36, 1
 s_lshr_b32 s41, s36, 1
 v_lshrrev_b32 v4, 4, v1
 v_and_b32 v3, 15, v1
 v_lshlrev_b32 v5, 1, v4
 v_xor_b32 v3, v3, v5
 s_lshl_b32 s42, s40, 4
 v_add_u32 v2, s42, v4
 v_lshlrev_b32 v2, 13, v2
 s_lshl_b32 s42, s41, 8
 v_add_u32 v2, s42, v2
 v_xor_b32 v5, 0, v3
 v_lshl_add_u32 v5, v5, 4, v2
 v_add_u32 v28, 0, v5
 v_xor_b32 v5, 0, v3
 v_lshl_add_u32 v5, v5, 4, v2
 v_add_u32 v29, 31744, v5
 v_xor_b32 v5, 8, v3
 v_lshl_add_u32 v5, v5, 4, v2
 v_add_u32 v30, 63488, v5
 v_xor_b32 v5, 8, v3
 v_lshl_add_u32 v5, v5, 4, v2
 v_add_u32 v31, 95232, v5
 v_lshrrev_b32 v2, 3, v1
 v_and_b32 v3, 7, v1
 v_xor_b32 v3, v3, v4
 s_mul_i32 s42, s36, 48
 v_add_u32 v2, s42, v2
 v_lshlrev_b32 v2, 11, v2
 v_xor_b32 v5, 0, v3
 v_lshl_add_u32 v5, v5, 4, v2
 v_add_u32 v22, 0, v5
 v_xor_b32 v5, 4, v3
 v_lshl_add_u32 v5, v5, 4, v2
 v_add_u32 v23, 15360, v5
 v_xor_b32 v5, 0, v3
 v_lshl_add_u32 v5, v5, 4, v2
 v_add_u32 v24, 30720, v5
 v_xor_b32 v5, 4, v3
 v_lshl_add_u32 v5, v5, 4, v2
 v_add_u32 v25, 49152, v5
 v_xor_b32 v5, 0, v3
 v_lshl_add_u32 v5, v5, 4, v2
 v_add_u32 v26, 64512, v5
 v_xor_b32 v5, 4, v3
 v_lshl_add_u32 v5, v5, 4, v2
 v_add_u32 v27, 79872, v5
 s_mul_i32 s48, s36, 6144
 s_add_u32 s48, s48, 65536
 s_lshl_b32 s49, s36, 12
 s_waitcnt lgkmcnt(0)
 s_lshl_b32 s42, s38, 9
 s_add_u32 s24, s10, s42
 s_addc_u32 s25, s11, 0
 s_sub_u32 s26, 8388608, s42
 s_mov_b32 s27, 0x20000
 s_mul_i32 s42, s37, 393216
 s_add_u32 s20, s4, s42
 s_addc_u32 s21, s5, 0
 s_mov_b32 s22, 393216
 s_mov_b32 s23, 0x20000
 s_add_u32 m0, s49, 0
 s_mov_b32 s47, 0
 buffer_load_dwordx4 v28, s[24:27], s47 offen lds
 buffer_load_dwordx4 v29, s[24:27], s47 offen offset:1024 lds
 buffer_load_dwordx4 v30, s[24:27], s47 offen offset:2048 lds
 buffer_load_dwordx4 v31, s[24:27], s47 offen offset:3072 lds
 s_add_u32 m0, s48, 0
 s_movk_i32 s46, 0
 buffer_load_dwordx4 v22, s[20:23], s46 offen lds
 buffer_load_dwordx4 v23, s[20:23], s46 offen offset:1024 lds
 buffer_load_dwordx4 v24, s[20:23], s46 offen offset:2048 lds
 s_add_u32 m0, s48, 3072
 s_movk_i32 s46, 0
 buffer_load_dwordx4 v25, s[20:23], s46 offen lds
 buffer_load_dwordx4 v26, s[20:23], s46 offen offset:1024 lds
 buffer_load_dwordx4 v27, s[20:23], s46 offen offset:2048 lds
 s_add_u32 m0, s49, 16384
 s_mov_b32 s47, 262144
 buffer_load_dwordx4 v28, s[24:27], s47 offen lds
 buffer_load_dwordx4 v29, s[24:27], s47 offen offset:1024 lds
 buffer_load_dwordx4 v30, s[24:27], s47 offen offset:2048 lds
 buffer_load_dwordx4 v31, s[24:27], s47 offen offset:3072 lds
 s_add_u32 m0, s49, 32768
 s_mov_b32 s47, 524288
 buffer_load_dwordx4 v28, s[24:27], s47 offen lds
 buffer_load_dwordx4 v29, s[24:27], s47 offen offset:1024 lds
 buffer_load_dwordx4 v30, s[24:27], s47 offen offset:2048 lds
 buffer_load_dwordx4 v31, s[24:27], s47 offen offset:3072 lds
 s_add_u32 m0, s48, 24576
 s_movk_i32 s46, 128
 buffer_load_dwordx4 v22, s[20:23], s46 offen lds
 buffer_load_dwordx4 v23, s[20:23], s46 offen offset:1024 lds
 buffer_load_dwordx4 v24, s[20:23], s46 offen offset:2048 lds
 s_add_u32 m0, s48, 27648
 s_movk_i32 s46, 128
 buffer_load_dwordx4 v25, s[20:23], s46 offen lds
 buffer_load_dwordx4 v26, s[20:23], s46 offen offset:1024 lds
 buffer_load_dwordx4 v27, s[20:23], s46 offen offset:2048 lds
 s_add_u32 m0, s49, 49152
 s_mov_b32 s47, 786432
 buffer_load_dwordx4 v28, s[24:27], s47 offen lds
 buffer_load_dwordx4 v29, s[24:27], s47 offen offset:1024 lds
 buffer_load_dwordx4 v30, s[24:27], s47 offen offset:2048 lds
 buffer_load_dwordx4 v31, s[24:27], s47 offen offset:3072 lds
 s_getpc_b64 s[84:85]
mha_qattn_kernel_pc:
 s_sub_u32 s84, s84, mha_qattn_kernel_pc-mha_qattn_kernel
 s_subb_u32 s85, s85, 0
 s_mov_b32 s86, L_text_end-mha_qattn_kernel
 s_mov_b32 s87, 0x20000
 v_lshlrev_b32 v60, 7, v1
 s_lshl_b32 s93, s36, 13
 buffer_load_dword v61, v60, s[84:87], s93 offen
 s_add_u32 s93, s93, 32768
 buffer_load_dword v61, v60, s[84:87], s93 offen
 s_add_u32 s93, s93, 32768
 s_add_u32 m0, s48, 49152
 s_movk_i32 s46, 256
 buffer_load_dwordx4 v22, s[20:23], s46 offen lds
 buffer_load_dwordx4 v23, s[20:23], s46 offen offset:1024 lds
 buffer_load_dwordx4 v24, s[20:23], s46 offen offset:2048 lds
 s_add_u32 m0, s48, 52224
 s_movk_i32 s46, 256
 buffer_load_dwordx4 v25, s[20:23], s46 offen lds
 buffer_load_dwordx4 v26, s[20:23], s46 offen offset:1024 lds
 buffer_load_dwordx4 v27, s[20:23], s46 offen offset:2048 lds
 s_add_u32 m0, s48, 73728
 s_movk_i32 s46, 384
 buffer_load_dwordx4 v22, s[20:23], s46 offen lds
 buffer_load_dwordx4 v23, s[20:23], s46 offen offset:1024 lds
 buffer_load_dwordx4 v24, s[20:23], s46 offen offset:2048 lds
 s_add_u32 m0, s48, 76800
 s_movk_i32 s46, 384
 buffer_load_dwordx4 v25, s[20:23], s46 offen lds
 buffer_load_dwordx4 v26, s[20:23], s46 offen offset:1024 lds
 buffer_load_dwordx4 v27, s[20:23], s46 offen offset:2048 lds
 s_lshl_b32 s42, s37, 5
 s_lshl_b32 s43, s38, 1
 s_add_u32 s42, s42, s43
 s_add_u32 s42, s42, s41
 s_lshl_b32 s42, s42, 18
 s_cmp_eq_u32 s40, 0
 s_cselect_b32 s43, s6, s8
 s_cselect_b32 s44, s7, s9
 s_add_u32 s28, s43, s42
 s_addc_u32 s29, s44, 0
 s_mov_b32 s30, 262144
 s_mov_b32 s31, 0x20000
 s_mov_b32 s32, s18
 s_mov_b32 s33, s19
 s_mov_b32 s34, 25165824
 s_mov_b32 s35, 0x20000
 s_mov_b32 s53, 0x4e800000
 s_mov_b32 s54, 0x3e0293ee
 s_mov_b32 s55, 0x3e0293ee
 s_mul_i32 s58, s41, 0
 s_mov_b32 s59, 0
 s_and_b32 s58, s2, 7
 s_mul_i32 s58, s58, 1
 s_lshr_b32 s43, s2, 5
 s_mul_i32 s43, s43, 1
 s_add_u32 s58, s58, s43
 s_mul_i32 s43, s41, 1
 s_add_u32 s58, s58, s43
 s_and_b32 s58, s58, 7
 s_lshl_b32 s58, s58, 15
 s_mul_i32 s79, s41, 49152
 s_sub_u32 s79, 131072, s79
 v_lshlrev_b32 v60, 7, v1
 v_lshrrev_b32 v0, 0, v1
 v_lshlrev_b32 v0, 7, v0
 s_mov_b32 s80, s12
 s_mov_b32 s81, s13
 s_mov_b32 s82, 8388608
 s_mov_b32 s83, 0x20000
 v_lshrrev_b32 v3, 4, v1
 v_bfe_u32 v4, v1, 2, 2
 v_and_b32 v6, 3, v1
 v_lshl_add_u32 v8, v3, 3, v4
 v_lshlrev_b32 v8, 8, v8
 s_lshl_b32 s42, s41, 13
 v_add_u32 v8, s42, v8
 v_lshl_add_u32 v8, v6, 3, v8
 v_lshl_add_u32 v8, v4, 5, v8
 v_and_b32 v9, 1, v3
 v_lshl_add_u32 v14, v9, 7, v8
 v_xor_b32 v15, 32, v14
 v_xor_b32 v16, 64, v14
 v_xor_b32 v17, 96, v14
 v_xor_b32 v18, 128, v14
 v_xor_b32 v19, 160, v14
 v_xor_b32 v20, 192, v14
 v_xor_b32 v21, 224, v14
 v_and_b32 v7, 15, v1
 s_mul_i32 s43, s40, 12288
 s_add_u32 s43, s43, 65536
 v_lshlrev_b32 v8, 7, v7
 v_add_u32 v8, s43, v8
 v_lshrrev_b32 v9, 1, v7
 v_xor_b32 v9, v9, v3
 v_lshl_add_u32 v10, v9, 4, v8
 v_xor_b32 v11, 64, v10
 v_add_u32 v12, 49152, v10
 v_add_u32 v13, 49152, v11
 v_lshlrev_b32 v2, s40, v3
 v_xor_b32 v2, v2, v7
 v_lshlrev_b32 v8, 8, v3
 v_lshl_add_u32 v48, v2, 4, v8
 s_cmp_eq_u32 s40, 0
 s_cselect_b32 s43, 4, 8
 s_mul_i32 s43, s43, 16
 v_xor_b32 v49, s43, v48
 s_cselect_b32 s43, 8, 0
 s_mul_i32 s43, s43, 16
 v_xor_b32 v50, s43, v48
 s_cselect_b32 s43, 12, 8
 s_mul_i32 s43, s43, 16
 v_xor_b32 v51, s43, v48
 s_waitcnt vmcnt(32)
 s_barrier
 ds_read_b128 a[160:163], v10
 ds_read_b64_tr_b16 a[128:129], v14
 ds_read_b64_tr_b16 a[130:131], v14 offset:1024
 ds_read_b128 a[164:167], v10 offset:2048
 ds_read_b64_tr_b16 a[132:133], v15
 ds_read_b64_tr_b16 a[134:135], v15 offset:1024
 ds_read_b128 a[168:171], v10 offset:4096
 ds_read_b64_tr_b16 a[136:137], v16
 ds_read_b64_tr_b16 a[138:139], v16 offset:1024
 ds_read_b128 a[172:175], v10 offset:6144
 ds_read_b64_tr_b16 a[140:141], v17
 ds_read_b64_tr_b16 a[142:143], v17 offset:1024
 ds_read_b128 a[176:179], v10 offset:8192
 ds_read_b64_tr_b16 a[144:145], v18
 ds_read_b64_tr_b16 a[146:147], v18 offset:1024
 ds_read_b128 a[180:183], v10 offset:10240
 ds_read_b64_tr_b16 a[148:149], v19
 ds_read_b64_tr_b16 a[150:151], v19 offset:1024
 ds_read_b64_tr_b16 a[152:153], v20
 ds_read_b64_tr_b16 a[154:155], v20 offset:1024
 s_waitcnt lgkmcnt(15)
 v_mfma_f32_16x16x32_bf16 v[64:67], a[128:131], a[160:163], 0
 ds_read_b64_tr_b16 a[156:157], v21
 v_mfma_f32_16x16x32_bf16 v[68:71], a[128:131], a[164:167], 0
 ds_read_b64_tr_b16 a[158:159], v21 offset:1024
 s_waitcnt lgkmcnt(15)
 v_mfma_f32_16x16x32_bf16 v[128:131], a[128:131], a[168:171], 0
 s_waitcnt lgkmcnt(12)
 v_mfma_f32_16x16x32_bf16 v[132:135], a[128:131], a[172:175], 0
 s_waitcnt lgkmcnt(9)
 v_mfma_f32_16x16x32_bf16 v[192:195], a[128:131], a[176:179], 0
 s_waitcnt lgkmcnt(6)
 v_mfma_f32_16x16x32_bf16 v[196:199], a[128:131], a[180:183], 0
 v_mfma_f32_16x16x32_bf16 v[72:75], a[132:135], a[160:163], 0
 v_mfma_f32_16x16x32_bf16 v[76:79], a[132:135], a[164:167], 0
 s_waitcnt vmcnt(28) lgkmcnt(0)
 s_barrier
 v_mfma_f32_16x16x32_bf16 v[136:139], a[132:135], a[168:171], 0
 ds_read_b64_tr_b16 a[128:129], v14 offset:16384
 v_lshrrev_b32 v3, 4, v1
 v_bfe_u32 v4, v1, 2, 2
 v_mfma_f32_16x16x32_bf16 v[140:143], a[132:135], a[172:175], 0
 ds_read_b64_tr_b16 a[130:131], v14 offset:17408
 v_and_b32 v6, 3, v1
 v_and_b32 v7, 15, v1
 v_mfma_f32_16x16x32_bf16 v[200:203], a[132:135], a[176:179], 0
 ds_read_b128 a[224:227], v11
 v_lshrrev_b32 v5, 2, v1
 s_lshl_b32 s42, s41, 16
 v_mfma_f32_16x16x32_bf16 v[204:207], a[132:135], a[180:183], 0
 ds_read_b128 a[228:231], v11 offset:2048
 s_add_u32 s43, s42, 8192
 v_lshlrev_b32 v8, 8, v5
 v_mfma_f32_16x16x32_bf16 v[80:83], a[136:139], a[160:163], 0
 ds_read_b64_tr_b16 a[132:133], v15 offset:16384
 v_add_u32 v8, s43, v8
 v_lshl_add_u32 v8, v6, 3, v8
 v_mfma_f32_16x16x32_bf16 v[84:87], a[136:139], a[164:167], 0
 ds_read_b64_tr_b16 a[134:135], v15 offset:17408
 v_and_b32 v9, 7, v5
 v_lshl_add_u32 v40, v9, 5, v8
 v_mfma_f32_16x16x32_bf16 v[144:147], a[136:139], a[168:171], 0
 ds_read_b128 a[232:235], v11 offset:4096
 v_xor_b32 v41, 32, v40
 v_xor_b32 v42, 64, v40
 v_mfma_f32_16x16x32_bf16 v[148:151], a[136:139], a[172:175], 0
 ds_read_b128 a[236:239], v11 offset:6144
 v_xor_b32 v43, 96, v40
 v_xor_b32 v44, 128, v40
 v_mfma_f32_16x16x32_bf16 v[208:211], a[136:139], a[176:179], 0
 ds_read_b128 a[240:243], v11 offset:8192
 v_xor_b32 v45, 160, v40
 v_xor_b32 v46, 192, v40
 v_mfma_f32_16x16x32_bf16 v[212:215], a[136:139], a[180:183], 0
 ds_read_b128 a[244:247], v11 offset:10240
 v_xor_b32 v47, 224, v40
 v_lshlrev_b32 v8, 8, v7
 v_mfma_f32_16x16x32_bf16 v[88:91], a[140:143], a[160:163], 0
 ds_read_b64_tr_b16 a[136:137], v16 offset:16384
 v_add_u32 v8, s42, v8
 v_and_b32 v9, 1, v3
 v_mfma_f32_16x16x32_bf16 v[92:95], a[140:143], a[164:167], 0
 ds_read_b64_tr_b16 a[138:139], v16 offset:17408
 v_lshl_add_u32 v8, v9, 3, v8
 v_lshrrev_b32 v9, 1, v3
 v_mfma_f32_16x16x32_bf16 v[152:155], a[140:143], a[168:171], 0
 s_add_u32 m0, s49, 0
 s_mov_b32 s47, 1048576
 v_xor_b32 v9, v9, v7
 v_lshl_add_u32 v32, v9, 4, v8
 v_mfma_f32_16x16x32_bf16 v[156:159], a[140:143], a[172:175], 0
 v_xor_b32 v33, 32, v32
 v_xor_b32 v34, 64, v32
 v_mfma_f32_16x16x32_bf16 v[216:219], a[140:143], a[176:179], 0
 buffer_load_dwordx4 v28, s[24:27], s47 offen lds
 v_xor_b32 v35, 96, v32
 v_xor_b32 v36, 128, v32
 v_mfma_f32_16x16x32_bf16 v[220:223], a[140:143], a[180:183], 0
 v_xor_b32 v37, 160, v32
 v_xor_b32 v38, 192, v32
 v_mfma_f32_16x16x32_bf16 v[96:99], a[144:147], a[160:163], 0
 ds_read_b64_tr_b16 a[140:141], v17 offset:16384
 v_xor_b32 v39, 224, v32
 s_lshl_b32 s52, s40, 13
 v_mfma_f32_16x16x32_bf16 v[100:103], a[144:147], a[164:167], 0
 ds_read_b64_tr_b16 a[142:143], v17 offset:17408
 s_add_u32 s52, s52, s42
 v_lshlrev_b32 v59, 4, v1
 v_mfma_f32_16x16x32_bf16 v[160:163], a[144:147], a[168:171], 0
 v_add_u32 v58, s52, v59
 s_add_u32 s72, s52, s79
 v_mfma_f32_16x16x32_bf16 v[164:167], a[144:147], a[172:175], 0
 buffer_load_dwordx4 v29, s[24:27], s47 offen offset:1024 lds
 s_lshl_b32 s56, s37, 1
 s_add_u32 s56, s56, s40
 v_mfma_f32_16x16x32_bf16 v[224:227], a[144:147], a[176:179], 0
 s_mul_i32 s56, s56, 786432
 s_bfe_u32 s43, s38, 0x20001
 v_mfma_f32_16x16x32_bf16 v[228:231], a[144:147], a[180:183], 0
 buffer_load_dwordx4 v30, s[24:27], s47 offen offset:2048 lds
 s_lshr_b32 s93, s38, 3
 s_lshl1_add_u32 s43, s43, s93
 v_mfma_f32_16x16x32_bf16 v[104:107], a[148:151], a[160:163], 0
 ds_read_b64_tr_b16 a[144:145], v18 offset:16384
 s_and_b32 s93, s38, 1
 s_lshl1_add_u32 s93, s43, s93
 v_mfma_f32_16x16x32_bf16 v[108:111], a[148:151], a[164:167], 0
 ds_read_b64_tr_b16 a[146:147], v18 offset:17408
 s_lshl_b32 s43, s93, 1
 s_add_u32 s43, s43, s41
 v_mfma_f32_16x16x32_bf16 v[168:171], a[148:151], a[168:171], 0
 s_lshl_b32 s43, s43, 12
 s_add_u32 s56, s56, s43
 v_mfma_f32_16x16x32_bf16 v[172:175], a[148:151], a[172:175], 0
 s_lshl_b32 s43, s36, 2
 s_add_u32 s43, s43, 65536
 v_mfma_f32_16x16x32_bf16 v[232:235], a[148:151], a[176:179], 0
 buffer_load_dwordx4 v31, s[24:27], s47 offen offset:3072 lds
 v_mov_b32 v62, s43
 v_mov_b32 v52, 0
 v_mfma_f32_16x16x32_bf16 v[236:239], a[148:151], a[180:183], 0
 v_mov_b32 v53, 0
 v_mov_b32 v54, 0
 v_mfma_f32_16x16x32_bf16 v[112:115], a[152:155], a[160:163], 0
 ds_read_b64_tr_b16 a[148:149], v19 offset:16384
 v_mov_b32 v55, 0
 v_mov_b32 v56, 0
 v_mfma_f32_16x16x32_bf16 v[116:119], a[152:155], a[164:167], 0
 ds_read_b64_tr_b16 a[150:151], v19 offset:17408
 v_mov_b32 v57, 0
 v_mov_b32 v0, 0
 v_mfma_f32_16x16x32_bf16 v[176:179], a[152:155], a[168:171], 0
 s_add_u32 s39, s58, 0
 s_and_b32 s39, s39, 262143
 s_lshl_b32 s43, s37, 12
 s_lshl_b32 s73, s93, 2
 v_mfma_f32_16x16x32_bf16 v[180:183], a[152:155], a[172:175], 0
 s_add_u32 s43, s43, s73
 s_add_u32 s73, s43, 33554432
 v_mfma_f32_16x16x32_bf16 v[240:243], a[152:155], a[176:179], 0
 s_or_b32 s43, s2, s36
 s_cselect_b32 s86, 0, 33619968
 s_cselect_b32 s90, 0, 4
 s_mov_b32 s84, s18
 v_mfma_f32_16x16x32_bf16 v[244:247], a[152:155], a[180:183], 0
 buffer_load_dwordx4 a[0:3], v48, s[28:31], s39 offen nt
 s_mov_b32 s85, s19
 s_mov_b32 s87, 0x20000
 v_mfma_f32_16x16x32_bf16 v[120:123], a[156:159], a[160:163], 0
 ds_read_b64_tr_b16 a[152:153], v20 offset:16384
 s_mov_b32 s88, s16
 s_mov_b32 s89, s17
 v_mfma_f32_16x16x32_bf16 v[124:127], a[156:159], a[164:167], 0
 ds_read_b64_tr_b16 a[154:155], v20 offset:17408
 s_mov_b32 s91, 0x20000
 v_mfma_f32_16x16x32_bf16 v[184:187], a[156:159], a[168:171], 0
 v_mfma_f32_16x16x32_bf16 v[188:191], a[156:159], a[172:175], 0
 buffer_load_dwordx4 a[4:7], v49, s[28:31], s39 offen offset:1024 nt
 v_mfma_f32_16x16x32_bf16 v[248:251], a[156:159], a[176:179], 0
 v_mfma_f32_16x16x32_bf16 v[252:255], a[156:159], a[180:183], 0
 s_waitcnt lgkmcnt(2)
 v_mfma_f32_16x16x32_bf16 v[64:67], a[128:131], a[224:227], v[64:67]
 ds_read_b64_tr_b16 a[156:157], v21 offset:16384
 v_mfma_f32_16x16x32_bf16 v[68:71], a[128:131], a[228:231], v[68:71]
 ds_read_b64_tr_b16 a[158:159], v21 offset:17408
 v_mfma_f32_16x16x32_bf16 v[128:131], a[128:131], a[232:235], v[128:131]
 v_mfma_f32_16x16x32_bf16 v[132:135], a[128:131], a[236:239], v[132:135]
 v_mfma_f32_16x16x32_bf16 v[192:195], a[128:131], a[240:243], v[192:195]
 v_mfma_f32_16x16x32_bf16 v[196:199], a[128:131], a[244:247], v[196:199]
 v_mfma_f32_16x16x32_bf16 v[72:75], a[132:135], a[224:227], v[72:75]
 v_mfma_f32_16x16x32_bf16 v[76:79], a[132:135], a[228:231], v[76:79]
 s_waitcnt vmcnt(24) lgkmcnt(0)
 s_barrier
 v_mfma_f32_16x16x32_bf16 v[136:139], a[132:135], a[232:235], v[136:139]
 ds_read_b64_tr_b16 a[128:129], v14 offset:32768
 v_mfma_f32_16x16x32_bf16 v[140:143], a[132:135], a[236:239], v[140:143]
 ds_read_b64_tr_b16 a[130:131], v14 offset:33792
 v_mfma_f32_16x16x32_bf16 v[200:203], a[132:135], a[240:243], v[200:203]
 ds_read_b128 a[160:163], v10 offset:24576
 v_mfma_f32_16x16x32_bf16 v[204:207], a[132:135], a[244:247], v[204:207]
 ds_read_b128 a[164:167], v10 offset:26624
 v_mfma_f32_16x16x32_bf16 v[80:83], a[136:139], a[224:227], v[80:83]
 ds_read_b64_tr_b16 a[132:133], v15 offset:32768
 v_mfma_f32_16x16x32_bf16 v[84:87], a[136:139], a[228:231], v[84:87]
 ds_read_b64_tr_b16 a[134:135], v15 offset:33792
 v_mfma_f32_16x16x32_bf16 v[144:147], a[136:139], a[232:235], v[144:147]
 ds_read_b128 a[168:171], v10 offset:28672
 v_mfma_f32_16x16x32_bf16 v[148:151], a[136:139], a[236:239], v[148:151]
 ds_read_b128 a[172:175], v10 offset:30720
 v_mfma_f32_16x16x32_bf16 v[208:211], a[136:139], a[240:243], v[208:211]
 ds_read_b128 a[176:179], v10 offset:32768
 v_mfma_f32_16x16x32_bf16 v[212:215], a[136:139], a[244:247], v[212:215]
 ds_read_b128 a[180:183], v10 offset:34816
 v_mfma_f32_16x16x32_bf16 v[88:91], a[140:143], a[224:227], v[88:91]
 ds_read_b64_tr_b16 a[136:137], v16 offset:32768
 v_mfma_f32_16x16x32_bf16 v[92:95], a[140:143], a[228:231], v[92:95]
 ds_read_b64_tr_b16 a[138:139], v16 offset:33792
 v_mfma_f32_16x16x32_bf16 v[152:155], a[140:143], a[232:235], v[152:155]
 s_add_u32 m0, s49, 16384
 s_mov_b32 s47, 1310720
 v_mfma_f32_16x16x32_bf16 v[156:159], a[140:143], a[236:239], v[156:159]
 v_mfma_f32_16x16x32_bf16 v[216:219], a[140:143], a[240:243], v[216:219]
 buffer_load_dwordx4 v28, s[24:27], s47 offen lds
 v_mfma_f32_16x16x32_bf16 v[220:223], a[140:143], a[244:247], v[220:223]
 v_mfma_f32_16x16x32_bf16 v[96:99], a[144:147], a[224:227], v[96:99]
 ds_read_b64_tr_b16 a[140:141], v17 offset:32768
 v_mfma_f32_16x16x32_bf16 v[100:103], a[144:147], a[228:231], v[100:103]
 ds_read_b64_tr_b16 a[142:143], v17 offset:33792
 v_mfma_f32_16x16x32_bf16 v[160:163], a[144:147], a[232:235], v[160:163]
 buffer_load_dwordx4 v29, s[24:27], s47 offen offset:1024 lds
 v_mfma_f32_16x16x32_bf16 v[164:167], a[144:147], a[236:239], v[164:167]
 v_mfma_f32_16x16x32_bf16 v[224:227], a[144:147], a[240:243], v[224:227]
 buffer_load_dwordx4 v30, s[24:27], s47 offen offset:2048 lds
 v_mfma_f32_16x16x32_bf16 v[228:231], a[144:147], a[244:247], v[228:231]
 v_mfma_f32_16x16x32_bf16 v[104:107], a[148:151], a[224:227], v[104:107]
 ds_read_b64_tr_b16 a[144:145], v18 offset:32768
 v_mfma_f32_16x16x32_bf16 v[108:111], a[148:151], a[228:231], v[108:111]
 ds_read_b64_tr_b16 a[146:147], v18 offset:33792
 v_mfma_f32_16x16x32_bf16 v[168:171], a[148:151], a[232:235], v[168:171]
 buffer_load_dwordx4 v31, s[24:27], s47 offen offset:3072 lds
 v_mfma_f32_16x16x32_bf16 v[172:175], a[148:151], a[236:239], v[172:175]
 v_mfma_f32_16x16x32_bf16 v[232:235], a[148:151], a[240:243], v[232:235]
 s_add_u32 m0, s48, 0
 s_movk_i32 s46, 512
 v_mfma_f32_16x16x32_bf16 v[236:239], a[148:151], a[244:247], v[236:239]
 v_mfma_f32_16x16x32_bf16 v[112:115], a[152:155], a[224:227], v[112:115]
 ds_read_b64_tr_b16 a[148:149], v19 offset:32768
 v_mfma_f32_16x16x32_bf16 v[116:119], a[152:155], a[228:231], v[116:119]
 ds_read_b64_tr_b16 a[150:151], v19 offset:33792
 v_mfma_f32_16x16x32_bf16 v[176:179], a[152:155], a[232:235], v[176:179]
 buffer_load_dwordx4 v22, s[20:23], s46 offen lds
 v_mfma_f32_16x16x32_bf16 v[180:183], a[152:155], a[236:239], v[180:183]
 v_mfma_f32_16x16x32_bf16 v[240:243], a[152:155], a[240:243], v[240:243]
 buffer_load_dwordx4 v23, s[20:23], s46 offen offset:1024 lds
 v_mfma_f32_16x16x32_bf16 v[244:247], a[152:155], a[244:247], v[244:247]
 v_mfma_f32_16x16x32_bf16 v[120:123], a[156:159], a[224:227], v[120:123]
 ds_read_b64_tr_b16 a[152:153], v20 offset:32768
 v_mfma_f32_16x16x32_bf16 v[124:127], a[156:159], a[228:231], v[124:127]
 ds_read_b64_tr_b16 a[154:155], v20 offset:33792
 v_mfma_f32_16x16x32_bf16 v[184:187], a[156:159], a[232:235], v[184:187]
 buffer_load_dwordx4 v24, s[20:23], s46 offen offset:2048 lds
 v_mfma_f32_16x16x32_bf16 v[188:191], a[156:159], a[236:239], v[188:191]
 v_mfma_f32_16x16x32_bf16 v[248:251], a[156:159], a[240:243], v[248:251]
 buffer_load_dwordx4 a[8:11], v50, s[28:31], s39 offen offset:2048 nt
 v_mfma_f32_16x16x32_bf16 v[252:255], a[156:159], a[244:247], v[252:255]
 s_waitcnt lgkmcnt(2)
 v_mfma_f32_16x16x32_bf16 v[64:67], a[128:131], a[160:163], v[64:67]
 ds_read_b64_tr_b16 a[156:157], v21 offset:32768
 v_mfma_f32_16x16x32_bf16 v[68:71], a[128:131], a[164:167], v[68:71]
 ds_read_b64_tr_b16 a[158:159], v21 offset:33792
 v_mfma_f32_16x16x32_bf16 v[128:131], a[128:131], a[168:171], v[128:131]
 v_mfma_f32_16x16x32_bf16 v[132:135], a[128:131], a[172:175], v[132:135]
 v_mfma_f32_16x16x32_bf16 v[192:195], a[128:131], a[176:179], v[192:195]
 v_mfma_f32_16x16x32_bf16 v[196:199], a[128:131], a[180:183], v[196:199]
 v_mfma_f32_16x16x32_bf16 v[72:75], a[132:135], a[160:163], v[72:75]
 v_mfma_f32_16x16x32_bf16 v[76:79], a[132:135], a[164:167], v[76:79]
 s_waitcnt vmcnt(28) lgkmcnt(0)
 s_barrier
 v_mfma_f32_16x16x32_bf16 v[136:139], a[132:135], a[168:171], v[136:139]
 ds_read_b64_tr_b16 a[128:129], v14 offset:49152
 v_mfma_f32_16x16x32_bf16 v[140:143], a[132:135], a[172:175], v[140:143]
 ds_read_b64_tr_b16 a[130:131], v14 offset:50176
 v_mfma_f32_16x16x32_bf16 v[200:203], a[132:135], a[176:179], v[200:203]
 ds_read_b128 a[224:227], v11 offset:24576
 v_mfma_f32_16x16x32_bf16 v[204:207], a[132:135], a[180:183], v[204:207]
 ds_read_b128 a[228:231], v11 offset:26624
 v_mfma_f32_16x16x32_bf16 v[80:83], a[136:139], a[160:163], v[80:83]
 ds_read_b64_tr_b16 a[132:133], v15 offset:49152
 v_mfma_f32_16x16x32_bf16 v[84:87], a[136:139], a[164:167], v[84:87]
 ds_read_b64_tr_b16 a[134:135], v15 offset:50176
 v_mfma_f32_16x16x32_bf16 v[144:147], a[136:139], a[168:171], v[144:147]
 ds_read_b128 a[232:235], v11 offset:28672
 v_mfma_f32_16x16x32_bf16 v[148:151], a[136:139], a[172:175], v[148:151]
 ds_read_b128 a[236:239], v11 offset:30720
 v_mfma_f32_16x16x32_bf16 v[208:211], a[136:139], a[176:179], v[208:211]
 ds_read_b128 a[240:243], v11 offset:32768
 v_mfma_f32_16x16x32_bf16 v[212:215], a[136:139], a[180:183], v[212:215]
 ds_read_b128 a[244:247], v11 offset:34816
 v_mfma_f32_16x16x32_bf16 v[88:91], a[140:143], a[160:163], v[88:91]
 ds_read_b64_tr_b16 a[136:137], v16 offset:49152
 v_mfma_f32_16x16x32_bf16 v[92:95], a[140:143], a[164:167], v[92:95]
 ds_read_b64_tr_b16 a[138:139], v16 offset:50176
 v_mfma_f32_16x16x32_bf16 v[152:155], a[140:143], a[168:171], v[152:155]
 s_add_u32 m0, s49, 32768
 s_mov_b32 s47, 1572864
 v_mfma_f32_16x16x32_bf16 v[156:159], a[140:143], a[172:175], v[156:159]
 buffer_load_dwordx4 v28, s[24:27], s47 offen lds
 v_mfma_f32_16x16x32_bf16 v[216:219], a[140:143], a[176:179], v[216:219]
 v_mfma_f32_16x16x32_bf16 v[220:223], a[140:143], a[180:183], v[220:223]
 buffer_load_dwordx4 v29, s[24:27], s47 offen offset:1024 lds
 v_mfma_f32_16x16x32_bf16 v[96:99], a[144:147], a[160:163], v[96:99]
 ds_read_b64_tr_b16 a[140:141], v17 offset:49152
 v_mfma_f32_16x16x32_bf16 v[100:103], a[144:147], a[164:167], v[100:103]
 ds_read_b64_tr_b16 a[142:143], v17 offset:50176
 v_mfma_f32_16x16x32_bf16 v[160:163], a[144:147], a[168:171], v[160:163]
 v_mfma_f32_16x16x32_bf16 v[164:167], a[144:147], a[172:175], v[164:167]
 buffer_load_dwordx4 v30, s[24:27], s47 offen offset:2048 lds
 v_mfma_f32_16x16x32_bf16 v[224:227], a[144:147], a[176:179], v[224:227]
 v_mfma_f32_16x16x32_bf16 v[228:231], a[144:147], a[180:183], v[228:231]
 buffer_load_dwordx4 v31, s[24:27], s47 offen offset:3072 lds
 v_mfma_f32_16x16x32_bf16 v[104:107], a[148:151], a[160:163], v[104:107]
 ds_read_b64_tr_b16 a[144:145], v18 offset:49152
 v_mfma_f32_16x16x32_bf16 v[108:111], a[148:151], a[164:167], v[108:111]
 ds_read_b64_tr_b16 a[146:147], v18 offset:50176
 v_mfma_f32_16x16x32_bf16 v[168:171], a[148:151], a[168:171], v[168:171]
 v_mfma_f32_16x16x32_bf16 v[172:175], a[148:151], a[172:175], v[172:175]
 s_add_u32 m0, s48, 3072
 s_movk_i32 s46, 512
 v_mfma_f32_16x16x32_bf16 v[232:235], a[148:151], a[176:179], v[232:235]
 buffer_load_dwordx4 v25, s[20:23], s46 offen lds
 v_mfma_f32_16x16x32_bf16 v[236:239], a[148:151], a[180:183], v[236:239]
 v_mfma_f32_16x16x32_bf16 v[112:115], a[152:155], a[160:163], v[112:115]
 ds_read_b64_tr_b16 a[148:149], v19 offset:49152
 v_mfma_f32_16x16x32_bf16 v[116:119], a[152:155], a[164:167], v[116:119]
 ds_read_b64_tr_b16 a[150:151], v19 offset:50176
 v_mfma_f32_16x16x32_bf16 v[176:179], a[152:155], a[168:171], v[176:179]
 buffer_load_dwordx4 v26, s[20:23], s46 offen offset:1024 lds
 v_mfma_f32_16x16x32_bf16 v[180:183], a[152:155], a[172:175], v[180:183]
 v_mfma_f32_16x16x32_bf16 v[240:243], a[152:155], a[176:179], v[240:243]
 buffer_load_dwordx4 v27, s[20:23], s46 offen offset:2048 lds
 v_mfma_f32_16x16x32_bf16 v[244:247], a[152:155], a[180:183], v[244:247]
 v_mfma_f32_16x16x32_bf16 v[120:123], a[156:159], a[160:163], v[120:123]
 ds_read_b64_tr_b16 a[152:153], v20 offset:49152
 v_mfma_f32_16x16x32_bf16 v[124:127], a[156:159], a[164:167], v[124:127]
 ds_read_b64_tr_b16 a[154:155], v20 offset:50176
 v_mfma_f32_16x16x32_bf16 v[184:187], a[156:159], a[168:171], v[184:187]
 buffer_load_dwordx4 a[12:15], v51, s[28:31], s39 offen offset:3072 nt
 v_mfma_f32_16x16x32_bf16 v[188:191], a[156:159], a[172:175], v[188:191]
 v_mfma_f32_16x16x32_bf16 v[248:251], a[156:159], a[176:179], v[248:251]
 buffer_load_dword v63, v0, s[84:87], s73 offen sc1
 v_mfma_f32_16x16x32_bf16 v[252:255], a[156:159], a[180:183], v[252:255]
 s_waitcnt lgkmcnt(2)
 v_mfma_f32_16x16x32_bf16 v[64:67], a[128:131], a[224:227], v[64:67]
 ds_read_b64_tr_b16 a[156:157], v21 offset:49152
 v_mfma_f32_16x16x32_bf16 v[68:71], a[128:131], a[228:231], v[68:71]
 ds_read_b64_tr_b16 a[158:159], v21 offset:50176
 v_mfma_f32_16x16x32_bf16 v[128:131], a[128:131], a[232:235], v[128:131]
 v_mfma_f32_16x16x32_bf16 v[132:135], a[128:131], a[236:239], v[132:135]
 v_mfma_f32_16x16x32_bf16 v[192:195], a[128:131], a[240:243], v[192:195]
 v_mfma_f32_16x16x32_bf16 v[196:199], a[128:131], a[244:247], v[196:199]
 v_mfma_f32_16x16x32_bf16 v[72:75], a[132:135], a[224:227], v[72:75]
 v_mfma_f32_16x16x32_bf16 v[76:79], a[132:135], a[228:231], v[76:79]
 s_waitcnt vmcnt(19) lgkmcnt(0)
 s_barrier
 v_mfma_f32_16x16x32_bf16 v[136:139], a[132:135], a[232:235], v[136:139]
 ds_read_b64_tr_b16 a[128:129], v14
 v_mfma_f32_16x16x32_bf16 v[140:143], a[132:135], a[236:239], v[140:143]
 ds_read_b64_tr_b16 a[130:131], v14 offset:1024
 v_mfma_f32_16x16x32_bf16 v[200:203], a[132:135], a[240:243], v[200:203]
 ds_read_b128 a[160:163], v12
 v_mfma_f32_16x16x32_bf16 v[204:207], a[132:135], a[244:247], v[204:207]
 ds_read_b128 a[164:167], v12 offset:2048
 v_mfma_f32_16x16x32_bf16 v[80:83], a[136:139], a[224:227], v[80:83]
 ds_read_b64_tr_b16 a[132:133], v15
 v_mfma_f32_16x16x32_bf16 v[84:87], a[136:139], a[228:231], v[84:87]
 ds_read_b64_tr_b16 a[134:135], v15 offset:1024
 v_mfma_f32_16x16x32_bf16 v[144:147], a[136:139], a[232:235], v[144:147]
 ds_read_b128 a[168:171], v12 offset:4096
 v_mfma_f32_16x16x32_bf16 v[148:151], a[136:139], a[236:239], v[148:151]
 ds_read_b128 a[172:175], v12 offset:6144
 v_mfma_f32_16x16x32_bf16 v[208:211], a[136:139], a[240:243], v[208:211]
 ds_read_b128 a[176:179], v12 offset:8192
 v_mfma_f32_16x16x32_bf16 v[212:215], a[136:139], a[244:247], v[212:215]
 ds_read_b128 a[180:183], v12 offset:10240
 v_mfma_f32_16x16x32_bf16 v[88:91], a[140:143], a[224:227], v[88:91]
 ds_read_b64_tr_b16 a[136:137], v16
 v_mfma_f32_16x16x32_bf16 v[92:95], a[140:143], a[228:231], v[92:95]
 ds_read_b64_tr_b16 a[138:139], v16 offset:1024
 v_mfma_f32_16x16x32_bf16 v[152:155], a[140:143], a[232:235], v[152:155]
 s_add_u32 m0, s49, 49152
 s_mov_b32 s47, 1835008
 v_mfma_f32_16x16x32_bf16 v[156:159], a[140:143], a[236:239], v[156:159]
 buffer_load_dwordx4 v28, s[24:27], s47 offen lds
 v_mfma_f32_16x16x32_bf16 v[216:219], a[140:143], a[240:243], v[216:219]
 v_mfma_f32_16x16x32_bf16 v[220:223], a[140:143], a[244:247], v[220:223]
 buffer_load_dwordx4 v29, s[24:27], s47 offen offset:1024 lds
 v_mfma_f32_16x16x32_bf16 v[96:99], a[144:147], a[224:227], v[96:99]
 ds_read_b64_tr_b16 a[140:141], v17
 v_mfma_f32_16x16x32_bf16 v[100:103], a[144:147], a[228:231], v[100:103]
 ds_read_b64_tr_b16 a[142:143], v17 offset:1024
 v_mfma_f32_16x16x32_bf16 v[160:163], a[144:147], a[232:235], v[160:163]
 v_mfma_f32_16x16x32_bf16 v[164:167], a[144:147], a[236:239], v[164:167]
 buffer_load_dwordx4 v30, s[24:27], s47 offen offset:2048 lds
 v_mfma_f32_16x16x32_bf16 v[224:227], a[144:147], a[240:243], v[224:227]
 v_mfma_f32_16x16x32_bf16 v[228:231], a[144:147], a[244:247], v[228:231]
 buffer_load_dwordx4 v31, s[24:27], s47 offen offset:3072 lds
 v_mfma_f32_16x16x32_bf16 v[104:107], a[148:151], a[224:227], v[104:107]
 ds_read_b64_tr_b16 a[144:145], v18
 v_mfma_f32_16x16x32_bf16 v[108:111], a[148:151], a[228:231], v[108:111]
 ds_read_b64_tr_b16 a[146:147], v18 offset:1024
 v_mfma_f32_16x16x32_bf16 v[168:171], a[148:151], a[232:235], v[168:171]
 v_mfma_f32_16x16x32_bf16 v[172:175], a[148:151], a[236:239], v[172:175]
 s_add_u32 m0, s48, 24576
 s_movk_i32 s46, 640
 v_mfma_f32_16x16x32_bf16 v[232:235], a[148:151], a[240:243], v[232:235]
 buffer_load_dwordx4 v22, s[20:23], s46 offen lds
 v_mfma_f32_16x16x32_bf16 v[236:239], a[148:151], a[244:247], v[236:239]
 v_mfma_f32_16x16x32_bf16 v[112:115], a[152:155], a[224:227], v[112:115]
 ds_read_b64_tr_b16 a[148:149], v19
 v_mfma_f32_16x16x32_bf16 v[116:119], a[152:155], a[228:231], v[116:119]
 ds_read_b64_tr_b16 a[150:151], v19 offset:1024
 v_mfma_f32_16x16x32_bf16 v[176:179], a[152:155], a[232:235], v[176:179]
 buffer_load_dwordx4 v23, s[20:23], s46 offen offset:1024 lds
 v_mfma_f32_16x16x32_bf16 v[180:183], a[152:155], a[236:239], v[180:183]
 v_mfma_f32_16x16x32_bf16 v[240:243], a[152:155], a[240:243], v[240:243]
 buffer_load_dwordx4 v24, s[20:23], s46 offen offset:2048 lds
 v_mfma_f32_16x16x32_bf16 v[244:247], a[152:155], a[244:247], v[244:247]
 v_mfma_f32_16x16x32_bf16 v[120:123], a[156:159], a[224:227], v[120:123]
 ds_read_b64_tr_b16 a[152:153], v20
 v_mfma_f32_16x16x32_bf16 v[124:127], a[156:159], a[228:231], v[124:127]
 ds_read_b64_tr_b16 a[154:155], v20 offset:1024
 v_mfma_f32_16x16x32_bf16 v[184:187], a[156:159], a[232:235], v[184:187]
 s_add_u32 s39, s58, 4096
 s_and_b32 s39, s39, 262143
 v_mfma_f32_16x16x32_bf16 v[188:191], a[156:159], a[236:239], v[188:191]
 v_mfma_f32_16x16x32_bf16 v[248:251], a[156:159], a[240:243], v[248:251]
 buffer_load_dwordx4 a[16:19], v48, s[28:31], s39 offen nt
 v_mfma_f32_16x16x32_bf16 v[252:255], a[156:159], a[244:247], v[252:255]
 s_waitcnt lgkmcnt(2)
 v_mfma_f32_16x16x32_bf16 v[64:67], a[128:131], a[160:163], v[64:67]
 ds_read_b64_tr_b16 a[156:157], v21
 v_mfma_f32_16x16x32_bf16 v[68:71], a[128:131], a[164:167], v[68:71]
 ds_read_b64_tr_b16 a[158:159], v21 offset:1024
 v_mfma_f32_16x16x32_bf16 v[128:131], a[128:131], a[168:171], v[128:131]
 v_mfma_f32_16x16x32_bf16 v[132:135], a[128:131], a[172:175], v[132:135]
 v_mfma_f32_16x16x32_bf16 v[192:195], a[128:131], a[176:179], v[192:195]
 v_mfma_f32_16x16x32_bf16 v[196:199], a[128:131], a[180:183], v[196:199]
 v_mfma_f32_16x16x32_bf16 v[72:75], a[132:135], a[160:163], v[72:75]
 v_mfma_f32_16x16x32_bf16 v[76:79], a[132:135], a[164:167], v[76:79]
 s_waitcnt vmcnt(21) lgkmcnt(0)
 s_barrier
 v_mfma_f32_16x16x32_bf16 v[136:139], a[132:135], a[168:171], v[136:139]
 ds_read_b64_tr_b16 a[128:129], v14 offset:16384
 v_mfma_f32_16x16x32_bf16 v[140:143], a[132:135], a[172:175], v[140:143]
 ds_read_b64_tr_b16 a[130:131], v14 offset:17408
 v_mfma_f32_16x16x32_bf16 v[200:203], a[132:135], a[176:179], v[200:203]
 ds_read_b128 a[224:227], v13
 v_mfma_f32_16x16x32_bf16 v[204:207], a[132:135], a[180:183], v[204:207]
 ds_read_b128 a[228:231], v13 offset:2048
 v_mfma_f32_16x16x32_bf16 v[80:83], a[136:139], a[160:163], v[80:83]
 ds_read_b64_tr_b16 a[132:133], v15 offset:16384
 v_mfma_f32_16x16x32_bf16 v[84:87], a[136:139], a[164:167], v[84:87]
 ds_read_b64_tr_b16 a[134:135], v15 offset:17408
 v_mfma_f32_16x16x32_bf16 v[144:147], a[136:139], a[168:171], v[144:147]
 ds_read_b128 a[232:235], v13 offset:4096
 v_mfma_f32_16x16x32_bf16 v[148:151], a[136:139], a[172:175], v[148:151]
 ds_read_b128 a[236:239], v13 offset:6144
 v_mfma_f32_16x16x32_bf16 v[208:211], a[136:139], a[176:179], v[208:211]
 ds_read_b128 a[240:243], v13 offset:8192
 v_mfma_f32_16x16x32_bf16 v[212:215], a[136:139], a[180:183], v[212:215]
 ds_read_b128 a[244:247], v13 offset:10240
 v_mfma_f32_16x16x32_bf16 v[88:91], a[140:143], a[160:163], v[88:91]
 ds_read_b64_tr_b16 a[136:137], v16 offset:16384
 v_mfma_f32_16x16x32_bf16 v[92:95], a[140:143], a[164:167], v[92:95]
 ds_read_b64_tr_b16 a[138:139], v16 offset:17408
 v_mfma_f32_16x16x32_bf16 v[152:155], a[140:143], a[168:171], v[152:155]
 s_add_u32 m0, s49, 0
 s_mov_b32 s47, 2097152
 v_mfma_f32_16x16x32_bf16 v[156:159], a[140:143], a[172:175], v[156:159]
 buffer_load_dwordx4 v28, s[24:27], s47 offen lds
 v_mfma_f32_16x16x32_bf16 v[216:219], a[140:143], a[176:179], v[216:219]
 v_mfma_f32_16x16x32_bf16 v[220:223], a[140:143], a[180:183], v[220:223]
 buffer_load_dwordx4 v29, s[24:27], s47 offen offset:1024 lds
 v_mfma_f32_16x16x32_bf16 v[96:99], a[144:147], a[160:163], v[96:99]
 ds_read_b64_tr_b16 a[140:141], v17 offset:16384
 v_mfma_f32_16x16x32_bf16 v[100:103], a[144:147], a[164:167], v[100:103]
 ds_read_b64_tr_b16 a[142:143], v17 offset:17408
 v_mfma_f32_16x16x32_bf16 v[160:163], a[144:147], a[168:171], v[160:163]
 v_mfma_f32_16x16x32_bf16 v[164:167], a[144:147], a[172:175], v[164:167]
 buffer_load_dwordx4 v30, s[24:27], s47 offen offset:2048 lds
 v_mfma_f32_16x16x32_bf16 v[224:227], a[144:147], a[176:179], v[224:227]
 v_mfma_f32_16x16x32_bf16 v[228:231], a[144:147], a[180:183], v[228:231]
 buffer_load_dwordx4 v31, s[24:27], s47 offen offset:3072 lds
 v_mfma_f32_16x16x32_bf16 v[104:107], a[148:151], a[160:163], v[104:107]
 ds_read_b64_tr_b16 a[144:145], v18 offset:16384
 v_mfma_f32_16x16x32_bf16 v[108:111], a[148:151], a[164:167], v[108:111]
 ds_read_b64_tr_b16 a[146:147], v18 offset:17408
 v_mfma_f32_16x16x32_bf16 v[168:171], a[148:151], a[168:171], v[168:171]
 v_mfma_f32_16x16x32_bf16 v[172:175], a[148:151], a[172:175], v[172:175]
 s_add_u32 m0, s48, 27648
 s_movk_i32 s46, 640
 v_mfma_f32_16x16x32_bf16 v[232:235], a[148:151], a[176:179], v[232:235]
 buffer_load_dwordx4 v25, s[20:23], s46 offen lds
 v_mfma_f32_16x16x32_bf16 v[236:239], a[148:151], a[180:183], v[236:239]
 v_mfma_f32_16x16x32_bf16 v[112:115], a[152:155], a[160:163], v[112:115]
 ds_read_b64_tr_b16 a[148:149], v19 offset:16384
 v_mfma_f32_16x16x32_bf16 v[116:119], a[152:155], a[164:167], v[116:119]
 ds_read_b64_tr_b16 a[150:151], v19 offset:17408
 v_mfma_f32_16x16x32_bf16 v[176:179], a[152:155], a[168:171], v[176:179]
 buffer_load_dwordx4 v26, s[20:23], s46 offen offset:1024 lds
 v_mfma_f32_16x16x32_bf16 v[180:183], a[152:155], a[172:175], v[180:183]
 v_mfma_f32_16x16x32_bf16 v[240:243], a[152:155], a[176:179], v[240:243]
 buffer_load_dwordx4 v27, s[20:23], s46 offen offset:2048 lds
 v_mfma_f32_16x16x32_bf16 v[244:247], a[152:155], a[180:183], v[244:247]
 v_mfma_f32_16x16x32_bf16 v[120:123], a[156:159], a[160:163], v[120:123]
 ds_read_b64_tr_b16 a[152:153], v20 offset:16384
 v_mfma_f32_16x16x32_bf16 v[124:127], a[156:159], a[164:167], v[124:127]
 ds_read_b64_tr_b16 a[154:155], v20 offset:17408
 v_mfma_f32_16x16x32_bf16 v[184:187], a[156:159], a[168:171], v[184:187]
 buffer_load_dwordx4 a[20:23], v49, s[28:31], s39 offen offset:1024 nt
 v_mfma_f32_16x16x32_bf16 v[188:191], a[156:159], a[172:175], v[188:191]
 v_mfma_f32_16x16x32_bf16 v[248:251], a[156:159], a[176:179], v[248:251]
 buffer_load_dwordx4 a[24:27], v50, s[28:31], s39 offen offset:2048 nt
 v_mfma_f32_16x16x32_bf16 v[252:255], a[156:159], a[180:183], v[252:255]
 s_waitcnt lgkmcnt(2)
 v_mfma_f32_16x16x32_bf16 v[64:67], a[128:131], a[224:227], v[64:67]
 ds_read_b64_tr_b16 a[156:157], v21 offset:16384
 v_mfma_f32_16x16x32_bf16 v[68:71], a[128:131], a[228:231], v[68:71]
 ds_read_b64_tr_b16 a[158:159], v21 offset:17408
 v_mfma_f32_16x16x32_bf16 v[128:131], a[128:131], a[232:235], v[128:131]
 v_mfma_f32_16x16x32_bf16 v[132:135], a[128:131], a[236:239], v[132:135]
 v_mfma_f32_16x16x32_bf16 v[192:195], a[128:131], a[240:243], v[192:195]
 v_mfma_f32_16x16x32_bf16 v[196:199], a[128:131], a[244:247], v[196:199]
 v_mfma_f32_16x16x32_bf16 v[72:75], a[132:135], a[224:227], v[72:75]
 v_mfma_f32_16x16x32_bf16 v[76:79], a[132:135], a[228:231], v[76:79]
 s_waitcnt vmcnt(22) lgkmcnt(0)
 s_barrier
 v_mfma_f32_16x16x32_bf16 v[136:139], a[132:135], a[232:235], v[136:139]
 ds_read_b64_tr_b16 a[128:129], v14 offset:32768
 v_mfma_f32_16x16x32_bf16 v[140:143], a[132:135], a[236:239], v[140:143]
 ds_read_b64_tr_b16 a[130:131], v14 offset:33792
 v_mfma_f32_16x16x32_bf16 v[200:203], a[132:135], a[240:243], v[200:203]
 ds_read_b128 a[160:163], v12 offset:24576
 v_mfma_f32_16x16x32_bf16 v[204:207], a[132:135], a[244:247], v[204:207]
 ds_read_b128 a[164:167], v12 offset:26624
 v_mfma_f32_16x16x32_bf16 v[80:83], a[136:139], a[224:227], v[80:83]
 ds_read_b64_tr_b16 a[132:133], v15 offset:32768
 v_mfma_f32_16x16x32_bf16 v[84:87], a[136:139], a[228:231], v[84:87]
 ds_read_b64_tr_b16 a[134:135], v15 offset:33792
 v_mfma_f32_16x16x32_bf16 v[144:147], a[136:139], a[232:235], v[144:147]
 ds_read_b128 a[168:171], v12 offset:28672
 v_mfma_f32_16x16x32_bf16 v[148:151], a[136:139], a[236:239], v[148:151]
 ds_read_b128 a[172:175], v12 offset:30720
 v_mfma_f32_16x16x32_bf16 v[208:211], a[136:139], a[240:243], v[208:211]
 ds_read_b128 a[176:179], v12 offset:32768
 v_mfma_f32_16x16x32_bf16 v[212:215], a[136:139], a[244:247], v[212:215]
 ds_read_b128 a[180:183], v12 offset:34816
 v_mfma_f32_16x16x32_bf16 v[88:91], a[140:143], a[224:227], v[88:91]
 ds_read_b64_tr_b16 a[136:137], v16 offset:32768
 v_mfma_f32_16x16x32_bf16 v[92:95], a[140:143], a[228:231], v[92:95]
 ds_read_b64_tr_b16 a[138:139], v16 offset:33792
 v_mfma_f32_16x16x32_bf16 v[152:155], a[140:143], a[232:235], v[152:155]
 s_add_u32 m0, s49, 16384
 s_mov_b32 s47, 2359296
 v_mfma_f32_16x16x32_bf16 v[156:159], a[140:143], a[236:239], v[156:159]
 v_mfma_f32_16x16x32_bf16 v[216:219], a[140:143], a[240:243], v[216:219]
 buffer_load_dwordx4 v28, s[24:27], s47 offen lds
 v_mfma_f32_16x16x32_bf16 v[220:223], a[140:143], a[244:247], v[220:223]
 v_mfma_f32_16x16x32_bf16 v[96:99], a[144:147], a[224:227], v[96:99]
 ds_read_b64_tr_b16 a[140:141], v17 offset:32768
 v_mfma_f32_16x16x32_bf16 v[100:103], a[144:147], a[228:231], v[100:103]
 ds_read_b64_tr_b16 a[142:143], v17 offset:33792
 v_mfma_f32_16x16x32_bf16 v[160:163], a[144:147], a[232:235], v[160:163]
 buffer_load_dwordx4 v29, s[24:27], s47 offen offset:1024 lds
 v_mfma_f32_16x16x32_bf16 v[164:167], a[144:147], a[236:239], v[164:167]
 v_mfma_f32_16x16x32_bf16 v[224:227], a[144:147], a[240:243], v[224:227]
 buffer_load_dwordx4 v30, s[24:27], s47 offen offset:2048 lds
 v_mfma_f32_16x16x32_bf16 v[228:231], a[144:147], a[244:247], v[228:231]
 v_mfma_f32_16x16x32_bf16 v[104:107], a[148:151], a[224:227], v[104:107]
 ds_read_b64_tr_b16 a[144:145], v18 offset:32768
 v_mfma_f32_16x16x32_bf16 v[108:111], a[148:151], a[228:231], v[108:111]
 ds_read_b64_tr_b16 a[146:147], v18 offset:33792
 v_mfma_f32_16x16x32_bf16 v[168:171], a[148:151], a[232:235], v[168:171]
 buffer_load_dwordx4 v31, s[24:27], s47 offen offset:3072 lds
 v_mfma_f32_16x16x32_bf16 v[172:175], a[148:151], a[236:239], v[172:175]
 v_mfma_f32_16x16x32_bf16 v[232:235], a[148:151], a[240:243], v[232:235]
 s_add_u32 m0, s48, 49152
 s_movk_i32 s46, 768
 v_mfma_f32_16x16x32_bf16 v[236:239], a[148:151], a[244:247], v[236:239]
 v_mfma_f32_16x16x32_bf16 v[112:115], a[152:155], a[224:227], v[112:115]
 ds_read_b64_tr_b16 a[148:149], v19 offset:32768
 v_mfma_f32_16x16x32_bf16 v[116:119], a[152:155], a[228:231], v[116:119]
 ds_read_b64_tr_b16 a[150:151], v19 offset:33792
 v_mfma_f32_16x16x32_bf16 v[176:179], a[152:155], a[232:235], v[176:179]
 buffer_load_dwordx4 v22, s[20:23], s46 offen lds
 v_mfma_f32_16x16x32_bf16 v[180:183], a[152:155], a[236:239], v[180:183]
 v_mfma_f32_16x16x32_bf16 v[240:243], a[152:155], a[240:243], v[240:243]
 buffer_load_dwordx4 v23, s[20:23], s46 offen offset:1024 lds
 v_mfma_f32_16x16x32_bf16 v[244:247], a[152:155], a[244:247], v[244:247]
 v_mfma_f32_16x16x32_bf16 v[120:123], a[156:159], a[224:227], v[120:123]
 ds_read_b64_tr_b16 a[152:153], v20 offset:32768
 v_mfma_f32_16x16x32_bf16 v[124:127], a[156:159], a[228:231], v[124:127]
 ds_read_b64_tr_b16 a[154:155], v20 offset:33792
 v_mfma_f32_16x16x32_bf16 v[184:187], a[156:159], a[232:235], v[184:187]
 buffer_load_dwordx4 v24, s[20:23], s46 offen offset:2048 lds
 v_mfma_f32_16x16x32_bf16 v[188:191], a[156:159], a[236:239], v[188:191]
 v_mfma_f32_16x16x32_bf16 v[248:251], a[156:159], a[240:243], v[248:251]
 buffer_load_dwordx4 a[28:31], v51, s[28:31], s39 offen offset:3072 nt
 v_mfma_f32_16x16x32_bf16 v[252:255], a[156:159], a[244:247], v[252:255]
 s_waitcnt lgkmcnt(2)
 v_mfma_f32_16x16x32_bf16 v[64:67], a[128:131], a[160:163], v[64:67]
 ds_read_b64_tr_b16 a[156:157], v21 offset:32768
 v_mfma_f32_16x16x32_bf16 v[68:71], a[128:131], a[164:167], v[68:71]
 ds_read_b64_tr_b16 a[158:159], v21 offset:33792
 v_mfma_f32_16x16x32_bf16 v[128:131], a[128:131], a[168:171], v[128:131]
 v_mfma_f32_16x16x32_bf16 v[132:135], a[128:131], a[172:175], v[132:135]
 v_mfma_f32_16x16x32_bf16 v[192:195], a[128:131], a[176:179], v[192:195]
 v_mfma_f32_16x16x32_bf16 v[196:199], a[128:131], a[180:183], v[196:199]
 v_mfma_f32_16x16x32_bf16 v[72:75], a[132:135], a[160:163], v[72:75]
 v_mfma_f32_16x16x32_bf16 v[76:79], a[132:135], a[164:167], v[76:79]
 s_waitcnt vmcnt(21) lgkmcnt(0)
 s_barrier
 v_mfma_f32_16x16x32_bf16 v[136:139], a[132:135], a[168:171], v[136:139]
 ds_read_b64_tr_b16 a[128:129], v14 offset:49152
 v_mfma_f32_16x16x32_bf16 v[140:143], a[132:135], a[172:175], v[140:143]
 ds_read_b64_tr_b16 a[130:131], v14 offset:50176
 v_mfma_f32_16x16x32_bf16 v[200:203], a[132:135], a[176:179], v[200:203]
 ds_read_b128 a[224:227], v13 offset:24576
 v_mfma_f32_16x16x32_bf16 v[204:207], a[132:135], a[180:183], v[204:207]
 ds_read_b128 a[228:231], v13 offset:26624
 v_mfma_f32_16x16x32_bf16 v[80:83], a[136:139], a[160:163], v[80:83]
 ds_read_b64_tr_b16 a[132:133], v15 offset:49152
 v_mfma_f32_16x16x32_bf16 v[84:87], a[136:139], a[164:167], v[84:87]
 ds_read_b64_tr_b16 a[134:135], v15 offset:50176
 v_mfma_f32_16x16x32_bf16 v[144:147], a[136:139], a[168:171], v[144:147]
 ds_read_b128 a[232:235], v13 offset:28672
 v_mfma_f32_16x16x32_bf16 v[148:151], a[136:139], a[172:175], v[148:151]
 ds_read_b128 a[236:239], v13 offset:30720
 v_mfma_f32_16x16x32_bf16 v[208:211], a[136:139], a[176:179], v[208:211]
 ds_read_b128 a[240:243], v13 offset:32768
 v_mfma_f32_16x16x32_bf16 v[212:215], a[136:139], a[180:183], v[212:215]
 ds_read_b128 a[244:247], v13 offset:34816
 v_mfma_f32_16x16x32_bf16 v[88:91], a[140:143], a[160:163], v[88:91]
 ds_read_b64_tr_b16 a[136:137], v16 offset:49152
 v_mfma_f32_16x16x32_bf16 v[92:95], a[140:143], a[164:167], v[92:95]
 ds_read_b64_tr_b16 a[138:139], v16 offset:50176
 v_mfma_f32_16x16x32_bf16 v[152:155], a[140:143], a[168:171], v[152:155]
 s_add_u32 m0, s49, 32768
 s_mov_b32 s47, 2621440
 v_mfma_f32_16x16x32_bf16 v[156:159], a[140:143], a[172:175], v[156:159]
 buffer_load_dwordx4 v28, s[24:27], s47 offen lds
 v_mfma_f32_16x16x32_bf16 v[216:219], a[140:143], a[176:179], v[216:219]
 v_mfma_f32_16x16x32_bf16 v[220:223], a[140:143], a[180:183], v[220:223]
 buffer_load_dwordx4 v29, s[24:27], s47 offen offset:1024 lds
 v_mfma_f32_16x16x32_bf16 v[96:99], a[144:147], a[160:163], v[96:99]
 ds_read_b64_tr_b16 a[140:141], v17 offset:49152
 v_mfma_f32_16x16x32_bf16 v[100:103], a[144:147], a[164:167], v[100:103]
 ds_read_b64_tr_b16 a[142:143], v17 offset:50176
 v_mfma_f32_16x16x32_bf16 v[160:163], a[144:147], a[168:171], v[160:163]
 v_mfma_f32_16x16x32_bf16 v[164:167], a[144:147], a[172:175], v[164:167]
 buffer_load_dwordx4 v30, s[24:27], s47 offen offset:2048 lds
 v_mfma_f32_16x16x32_bf16 v[224:227], a[144:147], a[176:179], v[224:227]
 v_mfma_f32_16x16x32_bf16 v[228:231], a[144:147], a[180:183], v[228:231]
 buffer_load_dwordx4 v31, s[24:27], s47 offen offset:3072 lds
 v_mfma_f32_16x16x32_bf16 v[104:107], a[148:151], a[160:163], v[104:107]
 ds_read_b64_tr_b16 a[144:145], v18 offset:49152
 v_mfma_f32_16x16x32_bf16 v[108:111], a[148:151], a[164:167], v[108:111]
 ds_read_b64_tr_b16 a[146:147], v18 offset:50176
 v_mfma_f32_16x16x32_bf16 v[168:171], a[148:151], a[168:171], v[168:171]
 v_mfma_f32_16x16x32_bf16 v[172:175], a[148:151], a[172:175], v[172:175]
 s_add_u32 m0, s48, 52224
 s_movk_i32 s46, 768
 v_mfma_f32_16x16x32_bf16 v[232:235], a[148:151], a[176:179], v[232:235]
 buffer_load_dwordx4 v25, s[20:23], s46 offen lds
 v_mfma_f32_16x16x32_bf16 v[236:239], a[148:151], a[180:183], v[236:239]
 v_mfma_f32_16x16x32_bf16 v[112:115], a[152:155], a[160:163], v[112:115]
 ds_read_b64_tr_b16 a[148:149], v19 offset:49152
 v_mfma_f32_16x16x32_bf16 v[116:119], a[152:155], a[164:167], v[116:119]
 ds_read_b64_tr_b16 a[150:151], v19 offset:50176
 v_mfma_f32_16x16x32_bf16 v[176:179], a[152:155], a[168:171], v[176:179]
 buffer_load_dwordx4 v26, s[20:23], s46 offen offset:1024 lds
 v_mfma_f32_16x16x32_bf16 v[180:183], a[152:155], a[172:175], v[180:183]
 v_mfma_f32_16x16x32_bf16 v[240:243], a[152:155], a[176:179], v[240:243]
 buffer_load_dwordx4 v27, s[20:23], s46 offen offset:2048 lds
 v_mfma_f32_16x16x32_bf16 v[244:247], a[152:155], a[180:183], v[244:247]
 v_mfma_f32_16x16x32_bf16 v[120:123], a[156:159], a[160:163], v[120:123]
 ds_read_b64_tr_b16 a[152:153], v20 offset:49152
 v_mfma_f32_16x16x32_bf16 v[124:127], a[156:159], a[164:167], v[124:127]
 ds_read_b64_tr_b16 a[154:155], v20 offset:50176
 v_mfma_f32_16x16x32_bf16 v[184:187], a[156:159], a[168:171], v[184:187]
 s_add_u32 s39, s58, 8192
 s_and_b32 s39, s39, 262143
 v_mfma_f32_16x16x32_bf16 v[188:191], a[156:159], a[172:175], v[188:191]
 v_mfma_f32_16x16x32_bf16 v[248:251], a[156:159], a[176:179], v[248:251]
 buffer_load_dwordx4 a[32:35], v48, s[28:31], s39 offen nt
 v_mfma_f32_16x16x32_bf16 v[252:255], a[156:159], a[180:183], v[252:255]
 s_waitcnt lgkmcnt(2)
 v_mfma_f32_16x16x32_bf16 v[64:67], a[128:131], a[224:227], v[64:67]
 ds_read_b64_tr_b16 a[156:157], v21 offset:49152
 v_mfma_f32_16x16x32_bf16 v[68:71], a[128:131], a[228:231], v[68:71]
 ds_read_b64_tr_b16 a[158:159], v21 offset:50176
 v_mfma_f32_16x16x32_bf16 v[128:131], a[128:131], a[232:235], v[128:131]
 v_mfma_f32_16x16x32_bf16 v[132:135], a[128:131], a[236:239], v[132:135]
 v_mfma_f32_16x16x32_bf16 v[192:195], a[128:131], a[240:243], v[192:195]
 v_mfma_f32_16x16x32_bf16 v[196:199], a[128:131], a[244:247], v[196:199]
 v_mfma_f32_16x16x32_bf16 v[72:75], a[132:135], a[224:227], v[72:75]
 v_mfma_f32_16x16x32_bf16 v[76:79], a[132:135], a[228:231], v[76:79]
 s_waitcnt vmcnt(21) lgkmcnt(0)
 s_barrier
 v_mfma_f32_16x16x32_bf16 v[136:139], a[132:135], a[232:235], v[136:139]
 ds_read_b64_tr_b16 a[128:129], v14
 v_mfma_f32_16x16x32_bf16 v[140:143], a[132:135], a[236:239], v[140:143]
 ds_read_b64_tr_b16 a[130:131], v14 offset:1024
 v_mfma_f32_16x16x32_bf16 v[200:203], a[132:135], a[240:243], v[200:203]
 ds_read_b128 a[160:163], v10
 v_mfma_f32_16x16x32_bf16 v[204:207], a[132:135], a[244:247], v[204:207]
 ds_read_b128 a[164:167], v10 offset:2048
 v_mfma_f32_16x16x32_bf16 v[80:83], a[136:139], a[224:227], v[80:83]
 ds_read_b64_tr_b16 a[132:133], v15
 v_mfma_f32_16x16x32_bf16 v[84:87], a[136:139], a[228:231], v[84:87]
 ds_read_b64_tr_b16 a[134:135], v15 offset:1024
 v_mfma_f32_16x16x32_bf16 v[144:147], a[136:139], a[232:235], v[144:147]
 ds_read_b128 a[168:171], v10 offset:4096
 v_mfma_f32_16x16x32_bf16 v[148:151], a[136:139], a[236:239], v[148:151]
 ds_read_b128 a[172:175], v10 offset:6144
 v_mfma_f32_16x16x32_bf16 v[208:211], a[136:139], a[240:243], v[208:211]
 ds_read_b128 a[176:179], v10 offset:8192
 v_mfma_f32_16x16x32_bf16 v[212:215], a[136:139], a[244:247], v[212:215]
 ds_read_b128 a[180:183], v10 offset:10240
 v_mfma_f32_16x16x32_bf16 v[88:91], a[140:143], a[224:227], v[88:91]
 ds_read_b64_tr_b16 a[136:137], v16
 v_mfma_f32_16x16x32_bf16 v[92:95], a[140:143], a[228:231], v[92:95]
 ds_read_b64_tr_b16 a[138:139], v16 offset:1024
 v_mfma_f32_16x16x32_bf16 v[152:155], a[140:143], a[232:235], v[152:155]
 s_add_u32 m0, s49, 49152
 s_mov_b32 s47, 2883584
 v_mfma_f32_16x16x32_bf16 v[156:159], a[140:143], a[236:239], v[156:159]
 v_mfma_f32_16x16x32_bf16 v[216:219], a[140:143], a[240:243], v[216:219]
 buffer_load_dwordx4 v28, s[24:27], s47 offen lds
 v_mfma_f32_16x16x32_bf16 v[220:223], a[140:143], a[244:247], v[220:223]
 v_mfma_f32_16x16x32_bf16 v[96:99], a[144:147], a[224:227], v[96:99]
 ds_read_b64_tr_b16 a[140:141], v17
 v_mfma_f32_16x16x32_bf16 v[100:103], a[144:147], a[228:231], v[100:103]
 ds_read_b64_tr_b16 a[142:143], v17 offset:1024
 v_mfma_f32_16x16x32_bf16 v[160:163], a[144:147], a[232:235], v[160:163]
 buffer_load_dwordx4 v29, s[24:27], s47 offen offset:1024 lds
 v_mfma_f32_16x16x32_bf16 v[164:167], a[144:147], a[236:239], v[164:167]
 v_mfma_f32_16x16x32_bf16 v[224:227], a[144:147], a[240:243], v[224:227]
 buffer_load_dwordx4 v30, s[24:27], s47 offen offset:2048 lds
 v_mfma_f32_16x16x32_bf16 v[228:231], a[144:147], a[244:247], v[228:231]
 v_mfma_f32_16x16x32_bf16 v[104:107], a[148:151], a[224:227], v[104:107]
 ds_read_b64_tr_b16 a[144:145], v18
 v_mfma_f32_16x16x32_bf16 v[108:111], a[148:151], a[228:231], v[108:111]
 ds_read_b64_tr_b16 a[146:147], v18 offset:1024
 v_mfma_f32_16x16x32_bf16 v[168:171], a[148:151], a[232:235], v[168:171]
 buffer_load_dwordx4 v31, s[24:27], s47 offen offset:3072 lds
 v_mfma_f32_16x16x32_bf16 v[172:175], a[148:151], a[236:239], v[172:175]
 v_mfma_f32_16x16x32_bf16 v[232:235], a[148:151], a[240:243], v[232:235]
 s_add_u32 m0, s48, 73728
 s_movk_i32 s46, 896
 v_mfma_f32_16x16x32_bf16 v[236:239], a[148:151], a[244:247], v[236:239]
 v_mfma_f32_16x16x32_bf16 v[112:115], a[152:155], a[224:227], v[112:115]
 ds_read_b64_tr_b16 a[148:149], v19
 v_mfma_f32_16x16x32_bf16 v[116:119], a[152:155], a[228:231], v[116:119]
 ds_read_b64_tr_b16 a[150:151], v19 offset:1024
 v_mfma_f32_16x16x32_bf16 v[176:179], a[152:155], a[232:235], v[176:179]
 buffer_load_dwordx4 v22, s[20:23], s46 offen lds
 v_mfma_f32_16x16x32_bf16 v[180:183], a[152:155], a[236:239], v[180:183]
 v_mfma_f32_16x16x32_bf16 v[240:243], a[152:155], a[240:243], v[240:243]
 buffer_load_dwordx4 v23, s[20:23], s46 offen offset:1024 lds
 v_mfma_f32_16x16x32_bf16 v[244:247], a[152:155], a[244:247], v[244:247]
 v_mfma_f32_16x16x32_bf16 v[120:123], a[156:159], a[224:227], v[120:123]
 ds_read_b64_tr_b16 a[152:153], v20
 v_mfma_f32_16x16x32_bf16 v[124:127], a[156:159], a[228:231], v[124:127]
 ds_read_b64_tr_b16 a[154:155], v20 offset:1024
 v_mfma_f32_16x16x32_bf16 v[184:187], a[156:159], a[232:235], v[184:187]
 buffer_load_dwordx4 v24, s[20:23], s46 offen offset:2048 lds
 v_mfma_f32_16x16x32_bf16 v[188:191], a[156:159], a[236:239], v[188:191]
 v_mfma_f32_16x16x32_bf16 v[248:251], a[156:159], a[240:243], v[248:251]
 buffer_load_dwordx4 a[36:39], v49, s[28:31], s39 offen offset:1024 nt
 v_mfma_f32_16x16x32_bf16 v[252:255], a[156:159], a[244:247], v[252:255]
 s_waitcnt lgkmcnt(2)
 v_mfma_f32_16x16x32_bf16 v[64:67], a[128:131], a[160:163], v[64:67]
 ds_read_b64_tr_b16 a[156:157], v21
 v_mfma_f32_16x16x32_bf16 v[68:71], a[128:131], a[164:167], v[68:71]
 ds_read_b64_tr_b16 a[158:159], v21 offset:1024
 v_mfma_f32_16x16x32_bf16 v[128:131], a[128:131], a[168:171], v[128:131]
 v_mfma_f32_16x16x32_bf16 v[132:135], a[128:131], a[172:175], v[132:135]
 v_mfma_f32_16x16x32_bf16 v[192:195], a[128:131], a[176:179], v[192:195]
 v_mfma_f32_16x16x32_bf16 v[196:199], a[128:131], a[180:183], v[196:199]
 v_mfma_f32_16x16x32_bf16 v[72:75], a[132:135], a[160:163], v[72:75]
 v_mfma_f32_16x16x32_bf16 v[76:79], a[132:135], a[164:167], v[76:79]
 s_waitcnt vmcnt(20) lgkmcnt(0)
 s_barrier
 v_mfma_f32_16x16x32_bf16 v[136:139], a[132:135], a[168:171], v[136:139]
 ds_read_b64_tr_b16 a[128:129], v14 offset:16384
 v_mfma_f32_16x16x32_bf16 v[140:143], a[132:135], a[172:175], v[140:143]
 ds_read_b64_tr_b16 a[130:131], v14 offset:17408
 v_mfma_f32_16x16x32_bf16 v[200:203], a[132:135], a[176:179], v[200:203]
 ds_read_b128 a[224:227], v11
 v_mfma_f32_16x16x32_bf16 v[204:207], a[132:135], a[180:183], v[204:207]
 ds_read_b128 a[228:231], v11 offset:2048
 v_mfma_f32_16x16x32_bf16 v[80:83], a[136:139], a[160:163], v[80:83]
 ds_read_b64_tr_b16 a[132:133], v15 offset:16384
 v_mfma_f32_16x16x32_bf16 v[84:87], a[136:139], a[164:167], v[84:87]
 ds_read_b64_tr_b16 a[134:135], v15 offset:17408
 v_mfma_f32_16x16x32_bf16 v[144:147], a[136:139], a[168:171], v[144:147]
 ds_read_b128 a[232:235], v11 offset:4096
 v_mfma_f32_16x16x32_bf16 v[148:151], a[136:139], a[172:175], v[148:151]
 ds_read_b128 a[236:239], v11 offset:6144
 v_mfma_f32_16x16x32_bf16 v[208:211], a[136:139], a[176:179], v[208:211]
 ds_read_b128 a[240:243], v11 offset:8192
 v_mfma_f32_16x16x32_bf16 v[212:215], a[136:139], a[180:183], v[212:215]
 ds_read_b128 a[244:247], v11 offset:10240
 v_mfma_f32_16x16x32_bf16 v[88:91], a[140:143], a[160:163], v[88:91]
 ds_read_b64_tr_b16 a[136:137], v16 offset:16384
 v_mfma_f32_16x16x32_bf16 v[92:95], a[140:143], a[164:167], v[92:95]
 ds_read_b64_tr_b16 a[138:139], v16 offset:17408
 v_mfma_f32_16x16x32_bf16 v[152:155], a[140:143], a[168:171], v[152:155]
 s_add_u32 m0, s49, 0
 s_mov_b32 s47, 3145728
 v_mfma_f32_16x16x32_bf16 v[156:159], a[140:143], a[172:175], v[156:159]
 buffer_load_dwordx4 v28, s[24:27], s47 offen lds
 v_mfma_f32_16x16x32_bf16 v[216:219], a[140:143], a[176:179], v[216:219]
 v_mfma_f32_16x16x32_bf16 v[220:223], a[140:143], a[180:183], v[220:223]
 buffer_load_dwordx4 v29, s[24:27], s47 offen offset:1024 lds
 v_mfma_f32_16x16x32_bf16 v[96:99], a[144:147], a[160:163], v[96:99]
 ds_read_b64_tr_b16 a[140:141], v17 offset:16384
 v_mfma_f32_16x16x32_bf16 v[100:103], a[144:147], a[164:167], v[100:103]
 ds_read_b64_tr_b16 a[142:143], v17 offset:17408
 v_mfma_f32_16x16x32_bf16 v[160:163], a[144:147], a[168:171], v[160:163]
 v_mfma_f32_16x16x32_bf16 v[164:167], a[144:147], a[172:175], v[164:167]
 buffer_load_dwordx4 v30, s[24:27], s47 offen offset:2048 lds
 v_mfma_f32_16x16x32_bf16 v[224:227], a[144:147], a[176:179], v[224:227]
 v_mfma_f32_16x16x32_bf16 v[228:231], a[144:147], a[180:183], v[228:231]
 buffer_load_dwordx4 v31, s[24:27], s47 offen offset:3072 lds
 v_mfma_f32_16x16x32_bf16 v[104:107], a[148:151], a[160:163], v[104:107]
 ds_read_b64_tr_b16 a[144:145], v18 offset:16384
 v_mfma_f32_16x16x32_bf16 v[108:111], a[148:151], a[164:167], v[108:111]
 ds_read_b64_tr_b16 a[146:147], v18 offset:17408
 v_mfma_f32_16x16x32_bf16 v[168:171], a[148:151], a[168:171], v[168:171]
 v_mfma_f32_16x16x32_bf16 v[172:175], a[148:151], a[172:175], v[172:175]
 s_add_u32 m0, s48, 76800
 s_movk_i32 s46, 896
 v_mfma_f32_16x16x32_bf16 v[232:235], a[148:151], a[176:179], v[232:235]
 buffer_load_dwordx4 v25, s[20:23], s46 offen lds
 v_mfma_f32_16x16x32_bf16 v[236:239], a[148:151], a[180:183], v[236:239]
 v_mfma_f32_16x16x32_bf16 v[112:115], a[152:155], a[160:163], v[112:115]
 ds_read_b64_tr_b16 a[148:149], v19 offset:16384
 v_mfma_f32_16x16x32_bf16 v[116:119], a[152:155], a[164:167], v[116:119]
 ds_read_b64_tr_b16 a[150:151], v19 offset:17408
 v_mfma_f32_16x16x32_bf16 v[176:179], a[152:155], a[168:171], v[176:179]
 buffer_load_dwordx4 v26, s[20:23], s46 offen offset:1024 lds
 v_mfma_f32_16x16x32_bf16 v[180:183], a[152:155], a[172:175], v[180:183]
 v_mfma_f32_16x16x32_bf16 v[240:243], a[152:155], a[176:179], v[240:243]
 buffer_load_dwordx4 v27, s[20:23], s46 offen offset:2048 lds
 v_mfma_f32_16x16x32_bf16 v[244:247], a[152:155], a[180:183], v[244:247]
 v_mfma_f32_16x16x32_bf16 v[120:123], a[156:159], a[160:163], v[120:123]
 ds_read_b64_tr_b16 a[152:153], v20 offset:16384
 v_mfma_f32_16x16x32_bf16 v[124:127], a[156:159], a[164:167], v[124:127]
 ds_read_b64_tr_b16 a[154:155], v20 offset:17408
 v_mfma_f32_16x16x32_bf16 v[184:187], a[156:159], a[168:171], v[184:187]
 buffer_load_dwordx4 a[40:43], v50, s[28:31], s39 offen offset:2048 nt
 v_mfma_f32_16x16x32_bf16 v[188:191], a[156:159], a[172:175], v[188:191]
 v_mfma_f32_16x16x32_bf16 v[248:251], a[156:159], a[176:179], v[248:251]
 buffer_load_dwordx4 a[44:47], v51, s[28:31], s39 offen offset:3072 nt
 v_mfma_f32_16x16x32_bf16 v[252:255], a[156:159], a[180:183], v[252:255]
 s_waitcnt lgkmcnt(2)
 v_mfma_f32_16x16x32_bf16 v[64:67], a[128:131], a[224:227], v[64:67]
 ds_read_b64_tr_b16 a[156:157], v21 offset:16384
 v_mfma_f32_16x16x32_bf16 v[68:71], a[128:131], a[228:231], v[68:71]
 ds_read_b64_tr_b16 a[158:159], v21 offset:17408
 v_mfma_f32_16x16x32_bf16 v[128:131], a[128:131], a[232:235], v[128:131]
 v_mfma_f32_16x16x32_bf16 v[132:135], a[128:131], a[236:239], v[132:135]
 v_mfma_f32_16x16x32_bf16 v[192:195], a[128:131], a[240:243], v[192:195]
 v_mfma_f32_16x16x32_bf16 v[196:199], a[128:131], a[244:247], v[196:199]
 v_mfma_f32_16x16x32_bf16 v[72:75], a[132:135], a[224:227], v[72:75]
 v_mfma_f32_16x16x32_bf16 v[76:79], a[132:135], a[228:231], v[76:79]
 s_waitcnt vmcnt(21) lgkmcnt(0)
 s_barrier
 v_mfma_f32_16x16x32_bf16 v[136:139], a[132:135], a[232:235], v[136:139]
 ds_read_b64_tr_b16 a[128:129], v14 offset:32768
 v_mfma_f32_16x16x32_bf16 v[140:143], a[132:135], a[236:239], v[140:143]
 ds_read_b64_tr_b16 a[130:131], v14 offset:33792
 v_mfma_f32_16x16x32_bf16 v[200:203], a[132:135], a[240:243], v[200:203]
 ds_read_b128 a[160:163], v10 offset:24576
 v_mfma_f32_16x16x32_bf16 v[204:207], a[132:135], a[244:247], v[204:207]
 ds_read_b128 a[164:167], v10 offset:26624
 v_mfma_f32_16x16x32_bf16 v[80:83], a[136:139], a[224:227], v[80:83]
 ds_read_b64_tr_b16 a[132:133], v15 offset:32768
 v_mfma_f32_16x16x32_bf16 v[84:87], a[136:139], a[228:231], v[84:87]
 ds_read_b64_tr_b16 a[134:135], v15 offset:33792
 v_mfma_f32_16x16x32_bf16 v[144:147], a[136:139], a[232:235], v[144:147]
 ds_read_b128 a[168:171], v10 offset:28672
 v_mfma_f32_16x16x32_bf16 v[148:151], a[136:139], a[236:239], v[148:151]
 ds_read_b128 a[172:175], v10 offset:30720
 v_mfma_f32_16x16x32_bf16 v[208:211], a[136:139], a[240:243], v[208:211]
 ds_read_b128 a[176:179], v10 offset:32768
 v_mfma_f32_16x16x32_bf16 v[212:215], a[136:139], a[244:247], v[212:215]
 ds_read_b128 a[180:183], v10 offset:34816
 v_mfma_f32_16x16x32_bf16 v[88:91], a[140:143], a[224:227], v[88:91]
 ds_read_b64_tr_b16 a[136:137], v16 offset:32768
 v_mfma_f32_16x16x32_bf16 v[92:95], a[140:143], a[228:231], v[92:95]
 ds_read_b64_tr_b16 a[138:139], v16 offset:33792
 v_mfma_f32_16x16x32_bf16 v[152:155], a[140:143], a[232:235], v[152:155]
 s_add_u32 m0, s49, 16384
 s_mov_b32 s47, 3407872
 v_mfma_f32_16x16x32_bf16 v[156:159], a[140:143], a[236:239], v[156:159]
 buffer_load_dwordx4 v28, s[24:27], s47 offen lds
 v_mfma_f32_16x16x32_bf16 v[216:219], a[140:143], a[240:243], v[216:219]
 v_mfma_f32_16x16x32_bf16 v[220:223], a[140:143], a[244:247], v[220:223]
 buffer_load_dwordx4 v29, s[24:27], s47 offen offset:1024 lds
 v_mfma_f32_16x16x32_bf16 v[96:99], a[144:147], a[224:227], v[96:99]
 ds_read_b64_tr_b16 a[140:141], v17 offset:32768
 v_mfma_f32_16x16x32_bf16 v[100:103], a[144:147], a[228:231], v[100:103]
 ds_read_b64_tr_b16 a[142:143], v17 offset:33792
 v_mfma_f32_16x16x32_bf16 v[160:163], a[144:147], a[232:235], v[160:163]
 v_mfma_f32_16x16x32_bf16 v[164:167], a[144:147], a[236:239], v[164:167]
 buffer_load_dwordx4 v30, s[24:27], s47 offen offset:2048 lds
 v_mfma_f32_16x16x32_bf16 v[224:227], a[144:147], a[240:243], v[224:227]
 v_mfma_f32_16x16x32_bf16 v[228:231], a[144:147], a[244:247], v[228:231]
 buffer_load_dwordx4 v31, s[24:27], s47 offen offset:3072 lds
 v_mfma_f32_16x16x32_bf16 v[104:107], a[148:151], a[224:227], v[104:107]
 ds_read_b64_tr_b16 a[144:145], v18 offset:32768
 v_mfma_f32_16x16x32_bf16 v[108:111], a[148:151], a[228:231], v[108:111]
 ds_read_b64_tr_b16 a[146:147], v18 offset:33792
 v_mfma_f32_16x16x32_bf16 v[168:171], a[148:151], a[232:235], v[168:171]
 v_mfma_f32_16x16x32_bf16 v[172:175], a[148:151], a[236:239], v[172:175]
 s_add_u32 m0, s48, 0
 s_movk_i32 s46, 1024
 v_mfma_f32_16x16x32_bf16 v[232:235], a[148:151], a[240:243], v[232:235]
 buffer_load_dwordx4 v22, s[20:23], s46 offen lds
 v_mfma_f32_16x16x32_bf16 v[236:239], a[148:151], a[244:247], v[236:239]
 v_mfma_f32_16x16x32_bf16 v[112:115], a[152:155], a[224:227], v[112:115]
 ds_read_b64_tr_b16 a[148:149], v19 offset:32768
 v_mfma_f32_16x16x32_bf16 v[116:119], a[152:155], a[228:231], v[116:119]
 ds_read_b64_tr_b16 a[150:151], v19 offset:33792
 v_mfma_f32_16x16x32_bf16 v[176:179], a[152:155], a[232:235], v[176:179]
 buffer_load_dwordx4 v23, s[20:23], s46 offen offset:1024 lds
 v_mfma_f32_16x16x32_bf16 v[180:183], a[152:155], a[236:239], v[180:183]
 v_mfma_f32_16x16x32_bf16 v[240:243], a[152:155], a[240:243], v[240:243]
 buffer_load_dwordx4 v24, s[20:23], s46 offen offset:2048 lds
 v_mfma_f32_16x16x32_bf16 v[244:247], a[152:155], a[244:247], v[244:247]
 v_mfma_f32_16x16x32_bf16 v[120:123], a[156:159], a[224:227], v[120:123]
 ds_read_b64_tr_b16 a[152:153], v20 offset:32768
 v_mfma_f32_16x16x32_bf16 v[124:127], a[156:159], a[228:231], v[124:127]
 ds_read_b64_tr_b16 a[154:155], v20 offset:33792
 v_mfma_f32_16x16x32_bf16 v[184:187], a[156:159], a[232:235], v[184:187]
 s_add_u32 s39, s58, 12288
 s_and_b32 s39, s39, 262143
 v_mfma_f32_16x16x32_bf16 v[188:191], a[156:159], a[236:239], v[188:191]
 v_mfma_f32_16x16x32_bf16 v[248:251], a[156:159], a[240:243], v[248:251]
 buffer_load_dwordx4 a[48:51], v48, s[28:31], s39 offen nt
 v_mfma_f32_16x16x32_bf16 v[252:255], a[156:159], a[244:247], v[252:255]
 s_waitcnt lgkmcnt(2)
 v_mfma_f32_16x16x32_bf16 v[64:67], a[128:131], a[160:163], v[64:67]
 ds_read_b64_tr_b16 a[156:157], v21 offset:32768
 v_mfma_f32_16x16x32_bf16 v[68:71], a[128:131], a[164:167], v[68:71]
 ds_read_b64_tr_b16 a[158:159], v21 offset:33792
 v_mfma_f32_16x16x32_bf16 v[128:131], a[128:131], a[168:171], v[128:131]
 v_mfma_f32_16x16x32_bf16 v[132:135], a[128:131], a[172:175], v[132:135]
 v_mfma_f32_16x16x32_bf16 v[192:195], a[128:131], a[176:179], v[192:195]
 v_mfma_f32_16x16x32_bf16 v[196:199], a[128:131], a[180:183], v[196:199]
 v_mfma_f32_16x16x32_bf16 v[72:75], a[132:135], a[160:163], v[72:75]
 v_mfma_f32_16x16x32_bf16 v[76:79], a[132:135], a[164:167], v[76:79]
 s_waitcnt vmcnt(21) lgkmcnt(0)
 s_barrier
 v_mfma_f32_16x16x32_bf16 v[136:139], a[132:135], a[168:171], v[136:139]
 ds_read_b64_tr_b16 a[128:129], v14 offset:49152
 v_mfma_f32_16x16x32_bf16 v[140:143], a[132:135], a[172:175], v[140:143]
 ds_read_b64_tr_b16 a[130:131], v14 offset:50176
 v_mfma_f32_16x16x32_bf16 v[200:203], a[132:135], a[176:179], v[200:203]
 ds_read_b128 a[224:227], v11 offset:24576
 v_mfma_f32_16x16x32_bf16 v[204:207], a[132:135], a[180:183], v[204:207]
 ds_read_b128 a[228:231], v11 offset:26624
 v_mfma_f32_16x16x32_bf16 v[80:83], a[136:139], a[160:163], v[80:83]
 ds_read_b64_tr_b16 a[132:133], v15 offset:49152
 v_mfma_f32_16x16x32_bf16 v[84:87], a[136:139], a[164:167], v[84:87]
 ds_read_b64_tr_b16 a[134:135], v15 offset:50176
 v_mfma_f32_16x16x32_bf16 v[144:147], a[136:139], a[168:171], v[144:147]
 ds_read_b128 a[232:235], v11 offset:28672
 v_mfma_f32_16x16x32_bf16 v[148:151], a[136:139], a[172:175], v[148:151]
 ds_read_b128 a[236:239], v11 offset:30720
 v_mfma_f32_16x16x32_bf16 v[208:211], a[136:139], a[176:179], v[208:211]
 ds_read_b128 a[240:243], v11 offset:32768
 v_mfma_f32_16x16x32_bf16 v[212:215], a[136:139], a[180:183], v[212:215]
 ds_read_b128 a[244:247], v11 offset:34816
 v_mfma_f32_16x16x32_bf16 v[88:91], a[140:143], a[160:163], v[88:91]
 ds_read_b64_tr_b16 a[136:137], v16 offset:49152
 v_mfma_f32_16x16x32_bf16 v[92:95], a[140:143], a[164:167], v[92:95]
 ds_read_b64_tr_b16 a[138:139], v16 offset:50176
 v_mfma_f32_16x16x32_bf16 v[152:155], a[140:143], a[168:171], v[152:155]
 s_add_u32 m0, s49, 32768
 s_mov_b32 s47, 3670016
 v_mfma_f32_16x16x32_bf16 v[156:159], a[140:143], a[172:175], v[156:159]
 buffer_load_dwordx4 v28, s[24:27], s47 offen lds
 v_mfma_f32_16x16x32_bf16 v[216:219], a[140:143], a[176:179], v[216:219]
 v_mfma_f32_16x16x32_bf16 v[220:223], a[140:143], a[180:183], v[220:223]
 buffer_load_dwordx4 v29, s[24:27], s47 offen offset:1024 lds
 v_mfma_f32_16x16x32_bf16 v[96:99], a[144:147], a[160:163], v[96:99]
 ds_read_b64_tr_b16 a[140:141], v17 offset:49152
 v_mfma_f32_16x16x32_bf16 v[100:103], a[144:147], a[164:167], v[100:103]
 ds_read_b64_tr_b16 a[142:143], v17 offset:50176
 v_mfma_f32_16x16x32_bf16 v[160:163], a[144:147], a[168:171], v[160:163]
 v_mfma_f32_16x16x32_bf16 v[164:167], a[144:147], a[172:175], v[164:167]
 buffer_load_dwordx4 v30, s[24:27], s47 offen offset:2048 lds
 v_mfma_f32_16x16x32_bf16 v[224:227], a[144:147], a[176:179], v[224:227]
 buffer_load_dwordx4 v31, s[24:27], s47 offen offset:3072 lds
 v_mfma_f32_16x16x32_bf16 v[228:231], a[144:147], a[180:183], v[228:231]
 v_mfma_f32_16x16x32_bf16 v[104:107], a[148:151], a[160:163], v[104:107]
 ds_read_b64_tr_b16 a[144:145], v18 offset:49152
 v_mfma_f32_16x16x32_bf16 v[108:111], a[148:151], a[164:167], v[108:111]
 ds_read_b64_tr_b16 a[146:147], v18 offset:50176
 v_mfma_f32_16x16x32_bf16 v[168:171], a[148:151], a[168:171], v[168:171]
 s_add_u32 m0, s48, 3072
 s_movk_i32 s46, 1024
 v_mfma_f32_16x16x32_bf16 v[172:175], a[148:151], a[172:175], v[172:175]
 v_mfma_f32_16x16x32_bf16 v[232:235], a[148:151], a[176:179], v[232:235]
 buffer_load_dwordx4 v25, s[20:23], s46 offen lds
 v_mfma_f32_16x16x32_bf16 v[236:239], a[148:151], a[180:183], v[236:239]
 buffer_load_dwordx4 v26, s[20:23], s46 offen offset:1024 lds
 v_mfma_f32_16x16x32_bf16 v[112:115], a[152:155], a[160:163], v[112:115]
 ds_read_b64_tr_b16 a[148:149], v19 offset:49152
 v_mfma_f32_16x16x32_bf16 v[116:119], a[152:155], a[164:167], v[116:119]
 ds_read_b64_tr_b16 a[150:151], v19 offset:50176
 v_mfma_f32_16x16x32_bf16 v[176:179], a[152:155], a[168:171], v[176:179]
 v_mfma_f32_16x16x32_bf16 v[180:183], a[152:155], a[172:175], v[180:183]
 buffer_load_dwordx4 v27, s[20:23], s46 offen offset:2048 lds
 v_mfma_f32_16x16x32_bf16 v[240:243], a[152:155], a[176:179], v[240:243]
 v_mfma_f32_16x16x32_bf16 v[244:247], a[152:155], a[180:183], v[244:247]
 buffer_load_dwordx4 a[52:55], v49, s[28:31], s39 offen offset:1024 nt
 v_mfma_f32_16x16x32_bf16 v[120:123], a[156:159], a[160:163], v[120:123]
 ds_read_b64_tr_b16 a[152:153], v20 offset:49152
 v_mfma_f32_16x16x32_bf16 v[124:127], a[156:159], a[164:167], v[124:127]
 ds_read_b64_tr_b16 a[154:155], v20 offset:50176
 v_mfma_f32_16x16x32_bf16 v[184:187], a[156:159], a[168:171], v[184:187]
 v_add_u32 v63, 0x9e3779b9, v63
 v_or_b32 v63, 1, v63
 v_mfma_f32_16x16x32_bf16 v[188:191], a[156:159], a[172:175], v[188:191]
 v_mfma_f32_16x16x32_bf16 v[248:251], a[156:159], a[176:179], v[248:251]
 buffer_store_dword v63, v0, s[88:91], 0 offen sc1
 v_mfma_f32_16x16x32_bf16 v[252:255], a[156:159], a[180:183], v[252:255]
 s_waitcnt lgkmcnt(2)
 v_mfma_f32_16x16x32_bf16 v[64:67], a[128:131], a[224:227], v[64:67]
 ds_read_b64_tr_b16 a[156:157], v21 offset:49152
 v_mfma_f32_16x16x32_bf16 v[68:71], a[128:131], a[228:231], v[68:71]
 ds_read_b64_tr_b16 a[158:159], v21 offset:50176
 v_mfma_f32_16x16x32_bf16 v[128:131], a[128:131], a[232:235], v[128:131]
 v_mfma_f32_16x16x32_bf16 v[132:135], a[128:131], a[236:239], v[132:135]
 v_mfma_f32_16x16x32_bf16 v[192:195], a[128:131], a[240:243], v[192:195]
 v_mfma_f32_16x16x32_bf16 v[196:199], a[128:131], a[244:247], v[196:199]
 v_mfma_f32_16x16x32_bf16 v[72:75], a[132:135], a[224:227], v[72:75]
 v_mfma_f32_16x16x32_bf16 v[76:79], a[132:135], a[228:231], v[76:79]
 s_waitcnt vmcnt(22) lgkmcnt(0)
 s_barrier
 v_mfma_f32_16x16x32_bf16 v[136:139], a[132:135], a[232:235], v[136:139]
 ds_read_b64_tr_b16 a[128:129], v14
 v_mfma_f32_16x16x32_bf16 v[140:143], a[132:135], a[236:239], v[140:143]
 ds_read_b64_tr_b16 a[130:131], v14 offset:1024
 v_mfma_f32_16x16x32_bf16 v[200:203], a[132:135], a[240:243], v[200:203]
 ds_read_b128 a[160:163], v12
 v_mfma_f32_16x16x32_bf16 v[204:207], a[132:135], a[244:247], v[204:207]
 ds_read_b128 a[164:167], v12 offset:2048
 v_mfma_f32_16x16x32_bf16 v[80:83], a[136:139], a[224:227], v[80:83]
 ds_read_b64_tr_b16 a[132:133], v15
 v_mfma_f32_16x16x32_bf16 v[84:87], a[136:139], a[228:231], v[84:87]
 ds_read_b64_tr_b16 a[134:135], v15 offset:1024
 v_mfma_f32_16x16x32_bf16 v[144:147], a[136:139], a[232:235], v[144:147]
 ds_read_b128 a[168:171], v12 offset:4096
 v_mfma_f32_16x16x32_bf16 v[148:151], a[136:139], a[236:239], v[148:151]
 ds_read_b128 a[172:175], v12 offset:6144
 v_mfma_f32_16x16x32_bf16 v[208:211], a[136:139], a[240:243], v[208:211]
 ds_read_b128 a[176:179], v12 offset:8192
 v_mfma_f32_16x16x32_bf16 v[212:215], a[136:139], a[244:247], v[212:215]
 ds_read_b128 a[180:183], v12 offset:10240
 v_mfma_f32_16x16x32_bf16 v[88:91], a[140:143], a[224:227], v[88:91]
 ds_read_b64_tr_b16 a[136:137], v16
 v_mfma_f32_16x16x32_bf16 v[92:95], a[140:143], a[228:231], v[92:95]
 ds_read_b64_tr_b16 a[138:139], v16 offset:1024
 v_mfma_f32_16x16x32_bf16 v[152:155], a[140:143], a[232:235], v[152:155]
 s_add_u32 m0, s49, 49152
 s_mov_b32 s47, 3932160
 v_mfma_f32_16x16x32_bf16 v[156:159], a[140:143], a[236:239], v[156:159]
 v_mfma_f32_16x16x32_bf16 v[216:219], a[140:143], a[240:243], v[216:219]
 buffer_load_dwordx4 v28, s[24:27], s47 offen lds
 v_mfma_f32_16x16x32_bf16 v[220:223], a[140:143], a[244:247], v[220:223]
 v_mfma_f32_16x16x32_bf16 v[96:99], a[144:147], a[224:227], v[96:99]
 ds_read_b64_tr_b16 a[140:141], v17
 v_mfma_f32_16x16x32_bf16 v[100:103], a[144:147], a[228:231], v[100:103]
 ds_read_b64_tr_b16 a[142:143], v17 offset:1024
 v_mfma_f32_16x16x32_bf16 v[160:163], a[144:147], a[232:235], v[160:163]
 buffer_load_dwordx4 v29, s[24:27], s47 offen offset:1024 lds
 v_mfma_f32_16x16x32_bf16 v[164:167], a[144:147], a[236:239], v[164:167]
 v_mfma_f32_16x16x32_bf16 v[224:227], a[144:147], a[240:243], v[224:227]
 buffer_load_dwordx4 v30, s[24:27], s47 offen offset:2048 lds
 v_mfma_f32_16x16x32_bf16 v[228:231], a[144:147], a[244:247], v[228:231]
 v_mfma_f32_16x16x32_bf16 v[104:107], a[148:151], a[224:227], v[104:107]
 ds_read_b64_tr_b16 a[144:145], v18
 v_mfma_f32_16x16x32_bf16 v[108:111], a[148:151], a[228:231], v[108:111]
 ds_read_b64_tr_b16 a[146:147], v18 offset:1024
 v_mfma_f32_16x16x32_bf16 v[168:171], a[148:151], a[232:235], v[168:171]
 buffer_load_dwordx4 v31, s[24:27], s47 offen offset:3072 lds
 v_mfma_f32_16x16x32_bf16 v[172:175], a[148:151], a[236:239], v[172:175]
 v_mfma_f32_16x16x32_bf16 v[232:235], a[148:151], a[240:243], v[232:235]
 s_add_u32 m0, s48, 24576
 s_movk_i32 s46, 1152
 v_mfma_f32_16x16x32_bf16 v[236:239], a[148:151], a[244:247], v[236:239]
 v_mfma_f32_16x16x32_bf16 v[112:115], a[152:155], a[224:227], v[112:115]
 ds_read_b64_tr_b16 a[148:149], v19
 v_mfma_f32_16x16x32_bf16 v[116:119], a[152:155], a[228:231], v[116:119]
 ds_read_b64_tr_b16 a[150:151], v19 offset:1024
 v_mfma_f32_16x16x32_bf16 v[176:179], a[152:155], a[232:235], v[176:179]
 buffer_load_dwordx4 v22, s[20:23], s46 offen lds
 v_mfma_f32_16x16x32_bf16 v[180:183], a[152:155], a[236:239], v[180:183]
 v_mfma_f32_16x16x32_bf16 v[240:243], a[152:155], a[240:243], v[240:243]
 buffer_load_dwordx4 v23, s[20:23], s46 offen offset:1024 lds
 v_mfma_f32_16x16x32_bf16 v[244:247], a[152:155], a[244:247], v[244:247]
 v_mfma_f32_16x16x32_bf16 v[120:123], a[156:159], a[224:227], v[120:123]
 ds_read_b64_tr_b16 a[152:153], v20
 v_mfma_f32_16x16x32_bf16 v[124:127], a[156:159], a[228:231], v[124:127]
 ds_read_b64_tr_b16 a[154:155], v20 offset:1024
 v_mfma_f32_16x16x32_bf16 v[184:187], a[156:159], a[232:235], v[184:187]
 buffer_load_dwordx4 v24, s[20:23], s46 offen offset:2048 lds
 v_mfma_f32_16x16x32_bf16 v[188:191], a[156:159], a[236:239], v[188:191]
 v_mfma_f32_16x16x32_bf16 v[248:251], a[156:159], a[240:243], v[248:251]
 buffer_load_dwordx4 a[56:59], v50, s[28:31], s39 offen offset:2048 nt
 v_mfma_f32_16x16x32_bf16 v[252:255], a[156:159], a[244:247], v[252:255]
 s_waitcnt lgkmcnt(2)
 v_mfma_f32_16x16x32_bf16 v[64:67], a[128:131], a[160:163], v[64:67]
 ds_read_b64_tr_b16 a[156:157], v21
 v_mfma_f32_16x16x32_bf16 v[68:71], a[128:131], a[164:167], v[68:71]
 ds_read_b64_tr_b16 a[158:159], v21 offset:1024
 v_mfma_f32_16x16x32_bf16 v[128:131], a[128:131], a[168:171], v[128:131]
 v_mfma_f32_16x16x32_bf16 v[132:135], a[128:131], a[172:175], v[132:135]
 v_mfma_f32_16x16x32_bf16 v[192:195], a[128:131], a[176:179], v[192:195]
 v_mfma_f32_16x16x32_bf16 v[196:199], a[128:131], a[180:183], v[196:199]
 v_mfma_f32_16x16x32_bf16 v[72:75], a[132:135], a[160:163], v[72:75]
 v_mfma_f32_16x16x32_bf16 v[76:79], a[132:135], a[164:167], v[76:79]
 s_waitcnt vmcnt(21) lgkmcnt(0)
 s_barrier
 v_mfma_f32_16x16x32_bf16 v[136:139], a[132:135], a[168:171], v[136:139]
 ds_read_b64_tr_b16 a[128:129], v14 offset:16384
 v_mfma_f32_16x16x32_bf16 v[140:143], a[132:135], a[172:175], v[140:143]
 ds_read_b64_tr_b16 a[130:131], v14 offset:17408
 v_mfma_f32_16x16x32_bf16 v[200:203], a[132:135], a[176:179], v[200:203]
 ds_read_b128 a[224:227], v13
 v_mfma_f32_16x16x32_bf16 v[204:207], a[132:135], a[180:183], v[204:207]
 ds_read_b128 a[228:231], v13 offset:2048
 v_mfma_f32_16x16x32_bf16 v[80:83], a[136:139], a[160:163], v[80:83]
 ds_read_b64_tr_b16 a[132:133], v15 offset:16384
 v_mfma_f32_16x16x32_bf16 v[84:87], a[136:139], a[164:167], v[84:87]
 ds_read_b64_tr_b16 a[134:135], v15 offset:17408
 v_mfma_f32_16x16x32_bf16 v[144:147], a[136:139], a[168:171], v[144:147]
 ds_read_b128 a[232:235], v13 offset:4096
 v_mfma_f32_16x16x32_bf16 v[148:151], a[136:139], a[172:175], v[148:151]
 ds_read_b128 a[236:239], v13 offset:6144
 v_mfma_f32_16x16x32_bf16 v[208:211], a[136:139], a[176:179], v[208:211]
 ds_read_b128 a[240:243], v13 offset:8192
 v_mfma_f32_16x16x32_bf16 v[212:215], a[136:139], a[180:183], v[212:215]
 ds_read_b128 a[244:247], v13 offset:10240
 v_mfma_f32_16x16x32_bf16 v[88:91], a[140:143], a[160:163], v[88:91]
 ds_read_b64_tr_b16 a[136:137], v16 offset:16384
 v_mfma_f32_16x16x32_bf16 v[92:95], a[140:143], a[164:167], v[92:95]
 ds_read_b64_tr_b16 a[138:139], v16 offset:17408
 v_mfma_f32_16x16x32_bf16 v[152:155], a[140:143], a[168:171], v[152:155]
 s_add_u32 m0, s49, 0
 s_mov_b32 s47, 4194304
 v_mfma_f32_16x16x32_bf16 v[156:159], a[140:143], a[172:175], v[156:159]
 buffer_load_dwordx4 v28, s[24:27], s47 offen lds
 v_mfma_f32_16x16x32_bf16 v[216:219], a[140:143], a[176:179], v[216:219]
 v_mfma_f32_16x16x32_bf16 v[220:223], a[140:143], a[180:183], v[220:223]
 buffer_load_dwordx4 v29, s[24:27], s47 offen offset:1024 lds
 v_mfma_f32_16x16x32_bf16 v[96:99], a[144:147], a[160:163], v[96:99]
 ds_read_b64_tr_b16 a[140:141], v17 offset:16384
 v_mfma_f32_16x16x32_bf16 v[100:103], a[144:147], a[164:167], v[100:103]
 ds_read_b64_tr_b16 a[142:143], v17 offset:17408
 v_mfma_f32_16x16x32_bf16 v[160:163], a[144:147], a[168:171], v[160:163]
 v_mfma_f32_16x16x32_bf16 v[164:167], a[144:147], a[172:175], v[164:167]
 buffer_load_dwordx4 v30, s[24:27], s47 offen offset:2048 lds
 v_mfma_f32_16x16x32_bf16 v[224:227], a[144:147], a[176:179], v[224:227]
 v_mfma_f32_16x16x32_bf16 v[228:231], a[144:147], a[180:183], v[228:231]
 buffer_load_dwordx4 v31, s[24:27], s47 offen offset:3072 lds
 v_mfma_f32_16x16x32_bf16 v[104:107], a[148:151], a[160:163], v[104:107]
 ds_read_b64_tr_b16 a[144:145], v18 offset:16384
 v_mfma_f32_16x16x32_bf16 v[108:111], a[148:151], a[164:167], v[108:111]
 ds_read_b64_tr_b16 a[146:147], v18 offset:17408
 v_mfma_f32_16x16x32_bf16 v[168:171], a[148:151], a[168:171], v[168:171]
 v_mfma_f32_16x16x32_bf16 v[172:175], a[148:151], a[172:175], v[172:175]
 s_add_u32 m0, s48, 27648
 s_movk_i32 s46, 1152
 v_mfma_f32_16x16x32_bf16 v[232:235], a[148:151], a[176:179], v[232:235]
 buffer_load_dwordx4 v25, s[20:23], s46 offen lds
 v_mfma_f32_16x16x32_bf16 v[236:239], a[148:151], a[180:183], v[236:239]
 v_mfma_f32_16x16x32_bf16 v[112:115], a[152:155], a[160:163], v[112:115]
 ds_read_b64_tr_b16 a[148:149], v19 offset:16384
 v_mfma_f32_16x16x32_bf16 v[116:119], a[152:155], a[164:167], v[116:119]
 ds_read_b64_tr_b16 a[150:151], v19 offset:17408
 v_mfma_f32_16x16x32_bf16 v[176:179], a[152:155], a[168:171], v[176:179]
 buffer_load_dwordx4 v26, s[20:23], s46 offen offset:1024 lds
 v_mfma_f32_16x16x32_bf16 v[180:183], a[152:155], a[172:175], v[180:183]
 v_mfma_f32_16x16x32_bf16 v[240:243], a[152:155], a[176:179], v[240:243]
 buffer_load_dwordx4 v27, s[20:23], s46 offen offset:2048 lds
 v_mfma_f32_16x16x32_bf16 v[244:247], a[152:155], a[180:183], v[244:247]
 v_mfma_f32_16x16x32_bf16 v[120:123], a[156:159], a[160:163], v[120:123]
 ds_read_b64_tr_b16 a[152:153], v20 offset:16384
 v_mfma_f32_16x16x32_bf16 v[124:127], a[156:159], a[164:167], v[124:127]
 ds_read_b64_tr_b16 a[154:155], v20 offset:17408
 v_mfma_f32_16x16x32_bf16 v[184:187], a[156:159], a[168:171], v[184:187]
 buffer_load_dwordx4 a[60:63], v51, s[28:31], s39 offen offset:3072 nt
 v_mfma_f32_16x16x32_bf16 v[188:191], a[156:159], a[172:175], v[188:191]
 v_mfma_f32_16x16x32_bf16 v[248:251], a[156:159], a[176:179], v[248:251]
 s_cmp_eq_u32 s36, 0
 s_cselect_b32 s90, 4, 0
 s_mov_b32 s86, 33619968
 v_mfma_f32_16x16x32_bf16 v[252:255], a[156:159], a[180:183], v[252:255]
 s_waitcnt lgkmcnt(2)
 v_mfma_f32_16x16x32_bf16 v[64:67], a[128:131], a[224:227], v[64:67]
 ds_read_b64_tr_b16 a[156:157], v21 offset:16384
 v_mfma_f32_16x16x32_bf16 v[68:71], a[128:131], a[228:231], v[68:71]
 ds_read_b64_tr_b16 a[158:159], v21 offset:17408
 v_mfma_f32_16x16x32_bf16 v[128:131], a[128:131], a[232:235], v[128:131]
 v_mfma_f32_16x16x32_bf16 v[132:135], a[128:131], a[236:239], v[132:135]
 v_mfma_f32_16x16x32_bf16 v[192:195], a[128:131], a[240:243], v[192:195]
 v_mfma_f32_16x16x32_bf16 v[196:199], a[128:131], a[244:247], v[196:199]
 v_mfma_f32_16x16x32_bf16 v[72:75], a[132:135], a[224:227], v[72:75]
 v_mfma_f32_16x16x32_bf16 v[76:79], a[132:135], a[228:231], v[76:79]
 s_waitcnt vmcnt(21) lgkmcnt(0)
 s_barrier
 v_mfma_f32_16x16x32_bf16 v[136:139], a[132:135], a[232:235], v[136:139]
 ds_read_b64_tr_b16 a[128:129], v14 offset:32768
 v_mfma_f32_16x16x32_bf16 v[140:143], a[132:135], a[236:239], v[140:143]
 ds_read_b64_tr_b16 a[130:131], v14 offset:33792
 v_mfma_f32_16x16x32_bf16 v[200:203], a[132:135], a[240:243], v[200:203]
 ds_read_b128 a[160:163], v12 offset:24576
 v_mfma_f32_16x16x32_bf16 v[204:207], a[132:135], a[244:247], v[204:207]
 ds_read_b128 a[164:167], v12 offset:26624
 v_mfma_f32_16x16x32_bf16 v[80:83], a[136:139], a[224:227], v[80:83]
 ds_read_b64_tr_b16 a[132:133], v15 offset:32768
 v_mfma_f32_16x16x32_bf16 v[84:87], a[136:139], a[228:231], v[84:87]
 ds_read_b64_tr_b16 a[134:135], v15 offset:33792
 v_mfma_f32_16x16x32_bf16 v[144:147], a[136:139], a[232:235], v[144:147]
 ds_read_b128 a[168:171], v12 offset:28672
 v_mfma_f32_16x16x32_bf16 v[148:151], a[136:139], a[236:239], v[148:151]
 ds_read_b128 a[172:175], v12 offset:30720
 v_mfma_f32_16x16x32_bf16 v[208:211], a[136:139], a[240:243], v[208:211]
 ds_read_b128 a[176:179], v12 offset:32768
 v_mfma_f32_16x16x32_bf16 v[212:215], a[136:139], a[244:247], v[212:215]
 ds_read_b128 a[180:183], v12 offset:34816
 v_mfma_f32_16x16x32_bf16 v[88:91], a[140:143], a[224:227], v[88:91]
 ds_read_b64_tr_b16 a[136:137], v16 offset:32768
 v_mfma_f32_16x16x32_bf16 v[92:95], a[140:143], a[228:231], v[92:95]
 ds_read_b64_tr_b16 a[138:139], v16 offset:33792
 v_mfma_f32_16x16x32_bf16 v[152:155], a[140:143], a[232:235], v[152:155]
 s_add_u32 m0, s49, 16384
 s_mov_b32 s47, 4456448
 v_mfma_f32_16x16x32_bf16 v[156:159], a[140:143], a[236:239], v[156:159]
 buffer_load_dwordx4 v28, s[24:27], s47 offen lds
 v_mfma_f32_16x16x32_bf16 v[216:219], a[140:143], a[240:243], v[216:219]
 v_mfma_f32_16x16x32_bf16 v[220:223], a[140:143], a[244:247], v[220:223]
 buffer_load_dwordx4 v29, s[24:27], s47 offen offset:1024 lds
 v_mfma_f32_16x16x32_bf16 v[96:99], a[144:147], a[224:227], v[96:99]
 ds_read_b64_tr_b16 a[140:141], v17 offset:32768
 v_mfma_f32_16x16x32_bf16 v[100:103], a[144:147], a[228:231], v[100:103]
 ds_read_b64_tr_b16 a[142:143], v17 offset:33792
 v_mfma_f32_16x16x32_bf16 v[160:163], a[144:147], a[232:235], v[160:163]
 v_mfma_f32_16x16x32_bf16 v[164:167], a[144:147], a[236:239], v[164:167]
 buffer_load_dwordx4 v30, s[24:27], s47 offen offset:2048 lds
 v_mfma_f32_16x16x32_bf16 v[224:227], a[144:147], a[240:243], v[224:227]
 buffer_load_dwordx4 v31, s[24:27], s47 offen offset:3072 lds
 v_mfma_f32_16x16x32_bf16 v[228:231], a[144:147], a[244:247], v[228:231]
 v_mfma_f32_16x16x32_bf16 v[104:107], a[148:151], a[224:227], v[104:107]
 ds_read_b64_tr_b16 a[144:145], v18 offset:32768
 v_mfma_f32_16x16x32_bf16 v[108:111], a[148:151], a[228:231], v[108:111]
 ds_read_b64_tr_b16 a[146:147], v18 offset:33792
 v_mfma_f32_16x16x32_bf16 v[168:171], a[148:151], a[232:235], v[168:171]
 s_add_u32 m0, s48, 49152
 s_movk_i32 s46, 1280
 v_mfma_f32_16x16x32_bf16 v[172:175], a[148:151], a[236:239], v[172:175]
 v_mfma_f32_16x16x32_bf16 v[232:235], a[148:151], a[240:243], v[232:235]
 buffer_load_dwordx4 v22, s[20:23], s46 offen lds
 v_mfma_f32_16x16x32_bf16 v[236:239], a[148:151], a[244:247], v[236:239]
 buffer_load_dwordx4 v23, s[20:23], s46 offen offset:1024 lds
 v_mfma_f32_16x16x32_bf16 v[112:115], a[152:155], a[224:227], v[112:115]
 ds_read_b64_tr_b16 a[148:149], v19 offset:32768
 v_mfma_f32_16x16x32_bf16 v[116:119], a[152:155], a[228:231], v[116:119]
 ds_read_b64_tr_b16 a[150:151], v19 offset:33792
 v_mfma_f32_16x16x32_bf16 v[176:179], a[152:155], a[232:235], v[176:179]
 v_mfma_f32_16x16x32_bf16 v[180:183], a[152:155], a[236:239], v[180:183]
 buffer_load_dwordx4 v24, s[20:23], s46 offen offset:2048 lds
 v_mfma_f32_16x16x32_bf16 v[240:243], a[152:155], a[240:243], v[240:243]
 v_mfma_f32_16x16x32_bf16 v[244:247], a[152:155], a[244:247], v[244:247]
 s_add_u32 s39, s58, 16384
 s_and_b32 s39, s39, 262143
 v_mfma_f32_16x16x32_bf16 v[120:123], a[156:159], a[224:227], v[120:123]
 ds_read_b64_tr_b16 a[152:153], v20 offset:32768
 v_mfma_f32_16x16x32_bf16 v[124:127], a[156:159], a[228:231], v[124:127]
 ds_read_b64_tr_b16 a[154:155], v20 offset:33792
 v_mfma_f32_16x16x32_bf16 v[184:187], a[156:159], a[232:235], v[184:187]
 buffer_load_dwordx4 a[64:67], v48, s[28:31], s39 offen nt
 v_mfma_f32_16x16x32_bf16 v[188:191], a[156:159], a[236:239], v[188:191]
 v_mfma_f32_16x16x32_bf16 v[248:251], a[156:159], a[240:243], v[248:251]
 buffer_load_dwordx4 a[68:71], v49, s[28:31], s39 offen offset:1024 nt
 v_mfma_f32_16x16x32_bf16 v[252:255], a[156:159], a[244:247], v[252:255]
 s_waitcnt lgkmcnt(2)
 v_mfma_f32_16x16x32_bf16 v[64:67], a[128:131], a[160:163], v[64:67]
 ds_read_b64_tr_b16 a[156:157], v21 offset:32768
 v_mfma_f32_16x16x32_bf16 v[68:71], a[128:131], a[164:167], v[68:71]
 ds_read_b64_tr_b16 a[158:159], v21 offset:33792
 v_mfma_f32_16x16x32_bf16 v[128:131], a[128:131], a[168:171], v[128:131]
 v_mfma_f32_16x16x32_bf16 v[132:135], a[128:131], a[172:175], v[132:135]
 v_mfma_f32_16x16x32_bf16 v[192:195], a[128:131], a[176:179], v[192:195]
 v_mfma_f32_16x16x32_bf16 v[196:199], a[128:131], a[180:183], v[196:199]
 v_mfma_f32_16x16x32_bf16 v[72:75], a[132:135], a[160:163], v[72:75]
 v_mfma_f32_16x16x32_bf16 v[76:79], a[132:135], a[164:167], v[76:79]
 s_waitcnt vmcnt(21) lgkmcnt(0)
 s_barrier
 v_mfma_f32_16x16x32_bf16 v[136:139], a[132:135], a[168:171], v[136:139]
 ds_read_b64_tr_b16 a[128:129], v14 offset:49152
 v_mfma_f32_16x16x32_bf16 v[140:143], a[132:135], a[172:175], v[140:143]
 ds_read_b64_tr_b16 a[130:131], v14 offset:50176
 v_mfma_f32_16x16x32_bf16 v[200:203], a[132:135], a[176:179], v[200:203]
 ds_read_b128 a[224:227], v13 offset:24576
 v_mfma_f32_16x16x32_bf16 v[204:207], a[132:135], a[180:183], v[204:207]
 ds_read_b128 a[228:231], v13 offset:26624
 v_mfma_f32_16x16x32_bf16 v[80:83], a[136:139], a[160:163], v[80:83]
 ds_read_b64_tr_b16 a[132:133], v15 offset:49152
 v_mfma_f32_16x16x32_bf16 v[84:87], a[136:139], a[164:167], v[84:87]
 ds_read_b64_tr_b16 a[134:135], v15 offset:50176
 v_mfma_f32_16x16x32_bf16 v[144:147], a[136:139], a[168:171], v[144:147]
 ds_read_b128 a[232:235], v13 offset:28672
 v_mfma_f32_16x16x32_bf16 v[148:151], a[136:139], a[172:175], v[148:151]
 ds_read_b128 a[236:239], v13 offset:30720
 v_mfma_f32_16x16x32_bf16 v[208:211], a[136:139], a[176:179], v[208:211]
 ds_read_b128 a[240:243], v13 offset:32768
 v_mfma_f32_16x16x32_bf16 v[212:215], a[136:139], a[180:183], v[212:215]
 ds_read_b128 a[244:247], v13 offset:34816
 v_mfma_f32_16x16x32_bf16 v[88:91], a[140:143], a[160:163], v[88:91]
 ds_read_b64_tr_b16 a[136:137], v16 offset:49152
 v_mfma_f32_16x16x32_bf16 v[92:95], a[140:143], a[164:167], v[92:95]
 ds_read_b64_tr_b16 a[138:139], v16 offset:50176
 v_mfma_f32_16x16x32_bf16 v[152:155], a[140:143], a[168:171], v[152:155]
 s_add_u32 m0, s49, 32768
 s_mov_b32 s47, 4718592
 v_mfma_f32_16x16x32_bf16 v[156:159], a[140:143], a[172:175], v[156:159]
 v_mfma_f32_16x16x32_bf16 v[216:219], a[140:143], a[176:179], v[216:219]
 buffer_load_dwordx4 v28, s[24:27], s47 offen lds
 v_mfma_f32_16x16x32_bf16 v[220:223], a[140:143], a[180:183], v[220:223]
 v_mfma_f32_16x16x32_bf16 v[96:99], a[144:147], a[160:163], v[96:99]
 ds_read_b64_tr_b16 a[140:141], v17 offset:49152
 v_mfma_f32_16x16x32_bf16 v[100:103], a[144:147], a[164:167], v[100:103]
 ds_read_b64_tr_b16 a[142:143], v17 offset:50176
 v_mfma_f32_16x16x32_bf16 v[160:163], a[144:147], a[168:171], v[160:163]
 buffer_load_dwordx4 v29, s[24:27], s47 offen offset:1024 lds
 v_mfma_f32_16x16x32_bf16 v[164:167], a[144:147], a[172:175], v[164:167]
 v_mfma_f32_16x16x32_bf16 v[224:227], a[144:147], a[176:179], v[224:227]
 buffer_load_dwordx4 v30, s[24:27], s47 offen offset:2048 lds
 v_mfma_f32_16x16x32_bf16 v[228:231], a[144:147], a[180:183], v[228:231]
 v_mfma_f32_16x16x32_bf16 v[104:107], a[148:151], a[160:163], v[104:107]
 ds_read_b64_tr_b16 a[144:145], v18 offset:49152
 v_mfma_f32_16x16x32_bf16 v[108:111], a[148:151], a[164:167], v[108:111]
 ds_read_b64_tr_b16 a[146:147], v18 offset:50176
 v_mfma_f32_16x16x32_bf16 v[168:171], a[148:151], a[168:171], v[168:171]
 buffer_load_dwordx4 v31, s[24:27], s47 offen offset:3072 lds
 v_mfma_f32_16x16x32_bf16 v[172:175], a[148:151], a[172:175], v[172:175]
 v_mfma_f32_16x16x32_bf16 v[232:235], a[148:151], a[176:179], v[232:235]
 s_add_u32 m0, s48, 52224
 s_movk_i32 s46, 1280
 v_mfma_f32_16x16x32_bf16 v[236:239], a[148:151], a[180:183], v[236:239]
 v_mfma_f32_16x16x32_bf16 v[112:115], a[152:155], a[160:163], v[112:115]
 ds_read_b64_tr_b16 a[148:149], v19 offset:49152
 v_mfma_f32_16x16x32_bf16 v[116:119], a[152:155], a[164:167], v[116:119]
 ds_read_b64_tr_b16 a[150:151], v19 offset:50176
 v_mfma_f32_16x16x32_bf16 v[176:179], a[152:155], a[168:171], v[176:179]
 buffer_load_dwordx4 v25, s[20:23], s46 offen lds
 v_mfma_f32_16x16x32_bf16 v[180:183], a[152:155], a[172:175], v[180:183]
 v_mfma_f32_16x16x32_bf16 v[240:243], a[152:155], a[176:179], v[240:243]
 buffer_load_dwordx4 v26, s[20:23], s46 offen offset:1024 lds
 v_mfma_f32_16x16x32_bf16 v[244:247], a[152:155], a[180:183], v[244:247]
 v_mfma_f32_16x16x32_bf16 v[120:123], a[156:159], a[160:163], v[120:123]
 ds_read_b64_tr_b16 a[152:153], v20 offset:49152
 v_mfma_f32_16x16x32_bf16 v[124:127], a[156:159], a[164:167], v[124:127]
 ds_read_b64_tr_b16 a[154:155], v20 offset:50176
 v_mfma_f32_16x16x32_bf16 v[184:187], a[156:159], a[168:171], v[184:187]
 buffer_load_dwordx4 v27, s[20:23], s46 offen offset:2048 lds
 v_mfma_f32_16x16x32_bf16 v[188:191], a[156:159], a[172:175], v[188:191]
 v_mfma_f32_16x16x32_bf16 v[248:251], a[156:159], a[176:179], v[248:251]
 buffer_load_dwordx4 a[72:75], v50, s[28:31], s39 offen offset:2048 nt
 v_mfma_f32_16x16x32_bf16 v[252:255], a[156:159], a[180:183], v[252:255]
 s_waitcnt lgkmcnt(2)
 v_mfma_f32_16x16x32_bf16 v[64:67], a[128:131], a[224:227], v[64:67]
 ds_read_b64_tr_b16 a[156:157], v21 offset:49152
 v_mfma_f32_16x16x32_bf16 v[68:71], a[128:131], a[228:231], v[68:71]
 ds_read_b64_tr_b16 a[158:159], v21 offset:50176
 v_mfma_f32_16x16x32_bf16 v[128:131], a[128:131], a[232:235], v[128:131]
 v_mfma_f32_16x16x32_bf16 v[132:135], a[128:131], a[236:239], v[132:135]
 v_mfma_f32_16x16x32_bf16 v[192:195], a[128:131], a[240:243], v[192:195]
 v_mfma_f32_16x16x32_bf16 v[196:199], a[128:131], a[244:247], v[196:199]
 v_mfma_f32_16x16x32_bf16 v[72:75], a[132:135], a[224:227], v[72:75]
 v_mfma_f32_16x16x32_bf16 v[76:79], a[132:135], a[228:231], v[76:79]
 s_waitcnt vmcnt(21) lgkmcnt(0)
 s_barrier
 v_mfma_f32_16x16x32_bf16 v[136:139], a[132:135], a[232:235], v[136:139]
 ds_read_b64_tr_b16 a[128:129], v14
 v_mfma_f32_16x16x32_bf16 v[140:143], a[132:135], a[236:239], v[140:143]
 ds_read_b64_tr_b16 a[130:131], v14 offset:1024
 v_mfma_f32_16x16x32_bf16 v[200:203], a[132:135], a[240:243], v[200:203]
 ds_read_b128 a[160:163], v10
 v_mfma_f32_16x16x32_bf16 v[204:207], a[132:135], a[244:247], v[204:207]
 ds_read_b128 a[164:167], v10 offset:2048
 v_mfma_f32_16x16x32_bf16 v[80:83], a[136:139], a[224:227], v[80:83]
 ds_read_b64_tr_b16 a[132:133], v15
 v_mfma_f32_16x16x32_bf16 v[84:87], a[136:139], a[228:231], v[84:87]
 ds_read_b64_tr_b16 a[134:135], v15 offset:1024
 v_mfma_f32_16x16x32_bf16 v[144:147], a[136:139], a[232:235], v[144:147]
 ds_read_b128 a[168:171], v10 offset:4096
 v_mfma_f32_16x16x32_bf16 v[148:151], a[136:139], a[236:239], v[148:151]
 ds_read_b128 a[172:175], v10 offset:6144
 v_mfma_f32_16x16x32_bf16 v[208:211], a[136:139], a[240:243], v[208:211]
 ds_read_b128 a[176:179], v10 offset:8192
 v_mfma_f32_16x16x32_bf16 v[212:215], a[136:139], a[244:247], v[212:215]
 ds_read_b128 a[180:183], v10 offset:10240
 v_mfma_f32_16x16x32_bf16 v[88:91], a[140:143], a[224:227], v[88:91]
 ds_read_b64_tr_b16 a[136:137], v16
 v_mfma_f32_16x16x32_bf16 v[92:95], a[140:143], a[228:231], v[92:95]
 ds_read_b64_tr_b16 a[138:139], v16 offset:1024
 v_mfma_f32_16x16x32_bf16 v[152:155], a[140:143], a[232:235], v[152:155]
 s_add_u32 m0, s49, 49152
 s_mov_b32 s47, 4980736
 v_mfma_f32_16x16x32_bf16 v[156:159], a[140:143], a[236:239], v[156:159]
 v_mfma_f32_16x16x32_bf16 v[216:219], a[140:143], a[240:243], v[216:219]
 buffer_load_dwordx4 v28, s[24:27], s47 offen lds
 v_mfma_f32_16x16x32_bf16 v[220:223], a[140:143], a[244:247], v[220:223]
 v_mfma_f32_16x16x32_bf16 v[96:99], a[144:147], a[224:227], v[96:99]
 ds_read_b64_tr_b16 a[140:141], v17
 v_mfma_f32_16x16x32_bf16 v[100:103], a[144:147], a[228:231], v[100:103]
 ds_read_b64_tr_b16 a[142:143], v17 offset:1024
 v_mfma_f32_16x16x32_bf16 v[160:163], a[144:147], a[232:235], v[160:163]
 buffer_load_dwordx4 v29, s[24:27], s47 offen offset:1024 lds
 v_mfma_f32_16x16x32_bf16 v[164:167], a[144:147], a[236:239], v[164:167]
 v_mfma_f32_16x16x32_bf16 v[224:227], a[144:147], a[240:243], v[224:227]
 buffer_load_dwordx4 v30, s[24:27], s47 offen offset:2048 lds
 v_mfma_f32_16x16x32_bf16 v[228:231], a[144:147], a[244:247], v[228:231]
 v_mfma_f32_16x16x32_bf16 v[104:107], a[148:151], a[224:227], v[104:107]
 ds_read_b64_tr_b16 a[144:145], v18
 v_mfma_f32_16x16x32_bf16 v[108:111], a[148:151], a[228:231], v[108:111]
 ds_read_b64_tr_b16 a[146:147], v18 offset:1024
 v_mfma_f32_16x16x32_bf16 v[168:171], a[148:151], a[232:235], v[168:171]
 buffer_load_dwordx4 v31, s[24:27], s47 offen offset:3072 lds
 v_mfma_f32_16x16x32_bf16 v[172:175], a[148:151], a[236:239], v[172:175]
 v_mfma_f32_16x16x32_bf16 v[232:235], a[148:151], a[240:243], v[232:235]
 s_add_u32 m0, s48, 73728
 s_movk_i32 s46, 1408
 v_mfma_f32_16x16x32_bf16 v[236:239], a[148:151], a[244:247], v[236:239]
 v_mfma_f32_16x16x32_bf16 v[112:115], a[152:155], a[224:227], v[112:115]
 ds_read_b64_tr_b16 a[148:149], v19
 v_mfma_f32_16x16x32_bf16 v[116:119], a[152:155], a[228:231], v[116:119]
 ds_read_b64_tr_b16 a[150:151], v19 offset:1024
 v_mfma_f32_16x16x32_bf16 v[176:179], a[152:155], a[232:235], v[176:179]
 buffer_load_dwordx4 v22, s[20:23], s46 offen lds
 v_mfma_f32_16x16x32_bf16 v[180:183], a[152:155], a[236:239], v[180:183]
 v_mfma_f32_16x16x32_bf16 v[240:243], a[152:155], a[240:243], v[240:243]
 buffer_load_dwordx4 v23, s[20:23], s46 offen offset:1024 lds
 v_mfma_f32_16x16x32_bf16 v[244:247], a[152:155], a[244:247], v[244:247]
 v_mfma_f32_16x16x32_bf16 v[120:123], a[156:159], a[224:227], v[120:123]
 ds_read_b64_tr_b16 a[152:153], v20
 v_mfma_f32_16x16x32_bf16 v[124:127], a[156:159], a[228:231], v[124:127]
 ds_read_b64_tr_b16 a[154:155], v20 offset:1024
 v_mfma_f32_16x16x32_bf16 v[184:187], a[156:159], a[232:235], v[184:187]
 buffer_load_dwordx4 v24, s[20:23], s46 offen offset:2048 lds
 v_mfma_f32_16x16x32_bf16 v[188:191], a[156:159], a[236:239], v[188:191]
 v_mfma_f32_16x16x32_bf16 v[248:251], a[156:159], a[240:243], v[248:251]
 buffer_load_dwordx4 a[76:79], v51, s[28:31], s39 offen offset:3072 nt
 v_mfma_f32_16x16x32_bf16 v[252:255], a[156:159], a[244:247], v[252:255]
 s_waitcnt lgkmcnt(2)
 v_mfma_f32_16x16x32_bf16 v[64:67], a[128:131], a[160:163], v[64:67]
 ds_read_b64_tr_b16 a[156:157], v21
 v_mfma_f32_16x16x32_bf16 v[68:71], a[128:131], a[164:167], v[68:71]
 ds_read_b64_tr_b16 a[158:159], v21 offset:1024
 v_mfma_f32_16x16x32_bf16 v[128:131], a[128:131], a[168:171], v[128:131]
 v_mfma_f32_16x16x32_bf16 v[132:135], a[128:131], a[172:175], v[132:135]
 v_mfma_f32_16x16x32_bf16 v[192:195], a[128:131], a[176:179], v[192:195]
 v_mfma_f32_16x16x32_bf16 v[196:199], a[128:131], a[180:183], v[196:199]
 v_mfma_f32_16x16x32_bf16 v[72:75], a[132:135], a[160:163], v[72:75]
 v_mfma_f32_16x16x32_bf16 v[76:79], a[132:135], a[164:167], v[76:79]
 s_waitcnt vmcnt(21) lgkmcnt(0)
 s_barrier
 v_mfma_f32_16x16x32_bf16 v[136:139], a[132:135], a[168:171], v[136:139]
 ds_read_b64_tr_b16 a[128:129], v14 offset:16384
 v_mfma_f32_16x16x32_bf16 v[140:143], a[132:135], a[172:175], v[140:143]
 ds_read_b64_tr_b16 a[130:131], v14 offset:17408
 v_mfma_f32_16x16x32_bf16 v[200:203], a[132:135], a[176:179], v[200:203]
 ds_read_b128 a[224:227], v11
 v_mfma_f32_16x16x32_bf16 v[204:207], a[132:135], a[180:183], v[204:207]
 ds_read_b128 a[228:231], v11 offset:2048
 v_mfma_f32_16x16x32_bf16 v[80:83], a[136:139], a[160:163], v[80:83]
 ds_read_b64_tr_b16 a[132:133], v15 offset:16384
 v_mfma_f32_16x16x32_bf16 v[84:87], a[136:139], a[164:167], v[84:87]
 ds_read_b64_tr_b16 a[134:135], v15 offset:17408
 v_mfma_f32_16x16x32_bf16 v[144:147], a[136:139], a[168:171], v[144:147]
 ds_read_b128 a[232:235], v11 offset:4096
 v_mfma_f32_16x16x32_bf16 v[148:151], a[136:139], a[172:175], v[148:151]
 ds_read_b128 a[236:239], v11 offset:6144
 v_mfma_f32_16x16x32_bf16 v[208:211], a[136:139], a[176:179], v[208:211]
 ds_read_b128 a[240:243], v11 offset:8192
 v_mfma_f32_16x16x32_bf16 v[212:215], a[136:139], a[180:183], v[212:215]
 ds_read_b128 a[244:247], v11 offset:10240
 v_mfma_f32_16x16x32_bf16 v[88:91], a[140:143], a[160:163], v[88:91]
 ds_read_b64_tr_b16 a[136:137], v16 offset:16384
 v_mfma_f32_16x16x32_bf16 v[92:95], a[140:143], a[164:167], v[92:95]
 ds_read_b64_tr_b16 a[138:139], v16 offset:17408
 v_mfma_f32_16x16x32_bf16 v[152:155], a[140:143], a[168:171], v[152:155]
 s_add_u32 m0, s49, 0
 s_mov_b32 s47, 5242880
 v_mfma_f32_16x16x32_bf16 v[156:159], a[140:143], a[172:175], v[156:159]
 buffer_load_dwordx4 v28, s[24:27], s47 offen lds
 v_mfma_f32_16x16x32_bf16 v[216:219], a[140:143], a[176:179], v[216:219]
 v_mfma_f32_16x16x32_bf16 v[220:223], a[140:143], a[180:183], v[220:223]
 buffer_load_dwordx4 v29, s[24:27], s47 offen offset:1024 lds
 v_mfma_f32_16x16x32_bf16 v[96:99], a[144:147], a[160:163], v[96:99]
 ds_read_b64_tr_b16 a[140:141], v17 offset:16384
 v_mfma_f32_16x16x32_bf16 v[100:103], a[144:147], a[164:167], v[100:103]
 ds_read_b64_tr_b16 a[142:143], v17 offset:17408
 v_mfma_f32_16x16x32_bf16 v[160:163], a[144:147], a[168:171], v[160:163]
 v_mfma_f32_16x16x32_bf16 v[164:167], a[144:147], a[172:175], v[164:167]
 buffer_load_dwordx4 v30, s[24:27], s47 offen offset:2048 lds
 v_mfma_f32_16x16x32_bf16 v[224:227], a[144:147], a[176:179], v[224:227]
 v_mfma_f32_16x16x32_bf16 v[228:231], a[144:147], a[180:183], v[228:231]
 buffer_load_dwordx4 v31, s[24:27], s47 offen offset:3072 lds
 v_mfma_f32_16x16x32_bf16 v[104:107], a[148:151], a[160:163], v[104:107]
 ds_read_b64_tr_b16 a[144:145], v18 offset:16384
 v_mfma_f32_16x16x32_bf16 v[108:111], a[148:151], a[164:167], v[108:111]
 ds_read_b64_tr_b16 a[146:147], v18 offset:17408
 v_mfma_f32_16x16x32_bf16 v[168:171], a[148:151], a[168:171], v[168:171]
 v_mfma_f32_16x16x32_bf16 v[172:175], a[148:151], a[172:175], v[172:175]
 s_add_u32 m0, s48, 76800
 s_movk_i32 s46, 1408
 v_mfma_f32_16x16x32_bf16 v[232:235], a[148:151], a[176:179], v[232:235]
 buffer_load_dwordx4 v25, s[20:23], s46 offen lds
 v_mfma_f32_16x16x32_bf16 v[236:239], a[148:151], a[180:183], v[236:239]
 v_mfma_f32_16x16x32_bf16 v[112:115], a[152:155], a[160:163], v[112:115]
 ds_read_b64_tr_b16 a[148:149], v19 offset:16384
 v_mfma_f32_16x16x32_bf16 v[116:119], a[152:155], a[164:167], v[116:119]
 ds_read_b64_tr_b16 a[150:151], v19 offset:17408
 v_mfma_f32_16x16x32_bf16 v[176:179], a[152:155], a[168:171], v[176:179]
 buffer_load_dwordx4 v26, s[20:23], s46 offen offset:1024 lds
 v_mfma_f32_16x16x32_bf16 v[180:183], a[152:155], a[172:175], v[180:183]
 v_mfma_f32_16x16x32_bf16 v[240:243], a[152:155], a[176:179], v[240:243]
 buffer_load_dwordx4 v27, s[20:23], s46 offen offset:2048 lds
 v_mfma_f32_16x16x32_bf16 v[244:247], a[152:155], a[180:183], v[244:247]
 v_mfma_f32_16x16x32_bf16 v[120:123], a[156:159], a[160:163], v[120:123]
 ds_read_b64_tr_b16 a[152:153], v20 offset:16384
 v_mfma_f32_16x16x32_bf16 v[124:127], a[156:159], a[164:167], v[124:127]
 ds_read_b64_tr_b16 a[154:155], v20 offset:17408
 v_mfma_f32_16x16x32_bf16 v[184:187], a[156:159], a[168:171], v[184:187]
 s_add_u32 s39, s58, 20480
 s_and_b32 s39, s39, 262143
 v_mfma_f32_16x16x32_bf16 v[188:191], a[156:159], a[172:175], v[188:191]
 v_mfma_f32_16x16x32_bf16 v[248:251], a[156:159], a[176:179], v[248:251]
 buffer_load_dwordx4 a[80:83], v48, s[28:31], s39 offen nt
 v_mfma_f32_16x16x32_bf16 v[252:255], a[156:159], a[180:183], v[252:255]
 s_waitcnt lgkmcnt(2)
 v_mfma_f32_16x16x32_bf16 v[64:67], a[128:131], a[224:227], v[64:67]
 ds_read_b64_tr_b16 a[156:157], v21 offset:16384
 v_mfma_f32_16x16x32_bf16 v[68:71], a[128:131], a[228:231], v[68:71]
 ds_read_b64_tr_b16 a[158:159], v21 offset:17408
 v_mfma_f32_16x16x32_bf16 v[128:131], a[128:131], a[232:235], v[128:131]
 v_mfma_f32_16x16x32_bf16 v[132:135], a[128:131], a[236:239], v[132:135]
 v_mfma_f32_16x16x32_bf16 v[192:195], a[128:131], a[240:243], v[192:195]
 v_mfma_f32_16x16x32_bf16 v[196:199], a[128:131], a[244:247], v[196:199]
 v_mfma_f32_16x16x32_bf16 v[72:75], a[132:135], a[224:227], v[72:75]
 v_mfma_f32_16x16x32_bf16 v[76:79], a[132:135], a[228:231], v[76:79]
 s_waitcnt vmcnt(20) lgkmcnt(0)
 s_barrier
 v_mfma_f32_16x16x32_bf16 v[136:139], a[132:135], a[232:235], v[136:139]
 ds_read_b64_tr_b16 a[128:129], v14 offset:32768
 v_mfma_f32_16x16x32_bf16 v[140:143], a[132:135], a[236:239], v[140:143]
 ds_read_b64_tr_b16 a[130:131], v14 offset:33792
 v_mfma_f32_16x16x32_bf16 v[200:203], a[132:135], a[240:243], v[200:203]
 ds_read_b128 a[160:163], v10 offset:24576
 v_mfma_f32_16x16x32_bf16 v[204:207], a[132:135], a[244:247], v[204:207]
 ds_read_b128 a[164:167], v10 offset:26624
 v_mfma_f32_16x16x32_bf16 v[80:83], a[136:139], a[224:227], v[80:83]
 ds_read_b64_tr_b16 a[132:133], v15 offset:32768
 v_mfma_f32_16x16x32_bf16 v[84:87], a[136:139], a[228:231], v[84:87]
 ds_read_b64_tr_b16 a[134:135], v15 offset:33792
 v_mfma_f32_16x16x32_bf16 v[144:147], a[136:139], a[232:235], v[144:147]
 ds_read_b128 a[168:171], v10 offset:28672
 v_mfma_f32_16x16x32_bf16 v[148:151], a[136:139], a[236:239], v[148:151]
 ds_read_b128 a[172:175], v10 offset:30720
 v_mfma_f32_16x16x32_bf16 v[208:211], a[136:139], a[240:243], v[208:211]
 ds_read_b128 a[176:179], v10 offset:32768
 v_mfma_f32_16x16x32_bf16 v[212:215], a[136:139], a[244:247], v[212:215]
 ds_read_b128 a[180:183], v10 offset:34816
 v_mfma_f32_16x16x32_bf16 v[88:91], a[140:143], a[224:227], v[88:91]
 ds_read_b64_tr_b16 a[136:137], v16 offset:32768
 v_mfma_f32_16x16x32_bf16 v[92:95], a[140:143], a[228:231], v[92:95]
 ds_read_b64_tr_b16 a[138:139], v16 offset:33792
 v_mfma_f32_16x16x32_bf16 v[152:155], a[140:143], a[232:235], v[152:155]
 s_add_u32 m0, s49, 16384
 s_mov_b32 s47, 5505024
 v_mfma_f32_16x16x32_bf16 v[156:159], a[140:143], a[236:239], v[156:159]
 buffer_load_dwordx4 v28, s[24:27], s47 offen lds
 v_mfma_f32_16x16x32_bf16 v[216:219], a[140:143], a[240:243], v[216:219]
 v_mfma_f32_16x16x32_bf16 v[220:223], a[140:143], a[244:247], v[220:223]
 buffer_load_dwordx4 v29, s[24:27], s47 offen offset:1024 lds
 v_mfma_f32_16x16x32_bf16 v[96:99], a[144:147], a[224:227], v[96:99]
 ds_read_b64_tr_b16 a[140:141], v17 offset:32768
 v_mfma_f32_16x16x32_bf16 v[100:103], a[144:147], a[228:231], v[100:103]
 ds_read_b64_tr_b16 a[142:143], v17 offset:33792
 v_mfma_f32_16x16x32_bf16 v[160:163], a[144:147], a[232:235], v[160:163]
 v_mfma_f32_16x16x32_bf16 v[164:167], a[144:147], a[236:239], v[164:167]
 buffer_load_dwordx4 v30, s[24:27], s47 offen offset:2048 lds
 v_mfma_f32_16x16x32_bf16 v[224:227], a[144:147], a[240:243], v[224:227]
 v_mfma_f32_16x16x32_bf16 v[228:231], a[144:147], a[244:247], v[228:231]
 buffer_load_dwordx4 v31, s[24:27], s47 offen offset:3072 lds
 v_mfma_f32_16x16x32_bf16 v[104:107], a[148:151], a[224:227], v[104:107]
 ds_read_b64_tr_b16 a[144:145], v18 offset:32768
 v_mfma_f32_16x16x32_bf16 v[108:111], a[148:151], a[228:231], v[108:111]
 ds_read_b64_tr_b16 a[146:147], v18 offset:33792
 v_mfma_f32_16x16x32_bf16 v[168:171], a[148:151], a[232:235], v[168:171]
 v_mfma_f32_16x16x32_bf16 v[172:175], a[148:151], a[236:239], v[172:175]
 s_add_u32 m0, s48, 0
 s_movk_i32 s46, 1536
 v_mfma_f32_16x16x32_bf16 v[232:235], a[148:151], a[240:243], v[232:235]
 buffer_load_dwordx4 v22, s[20:23], s46 offen lds
 v_mfma_f32_16x16x32_bf16 v[236:239], a[148:151], a[244:247], v[236:239]
 v_mfma_f32_16x16x32_bf16 v[112:115], a[152:155], a[224:227], v[112:115]
 ds_read_b64_tr_b16 a[148:149], v19 offset:32768
 v_mfma_f32_16x16x32_bf16 v[116:119], a[152:155], a[228:231], v[116:119]
 ds_read_b64_tr_b16 a[150:151], v19 offset:33792
 v_mfma_f32_16x16x32_bf16 v[176:179], a[152:155], a[232:235], v[176:179]
 buffer_load_dwordx4 v23, s[20:23], s46 offen offset:1024 lds
 v_mfma_f32_16x16x32_bf16 v[180:183], a[152:155], a[236:239], v[180:183]
 v_mfma_f32_16x16x32_bf16 v[240:243], a[152:155], a[240:243], v[240:243]
 buffer_load_dwordx4 v24, s[20:23], s46 offen offset:2048 lds
 v_mfma_f32_16x16x32_bf16 v[244:247], a[152:155], a[244:247], v[244:247]
 v_mfma_f32_16x16x32_bf16 v[120:123], a[156:159], a[224:227], v[120:123]
 ds_read_b64_tr_b16 a[152:153], v20 offset:32768
 v_mfma_f32_16x16x32_bf16 v[124:127], a[156:159], a[228:231], v[124:127]
 ds_read_b64_tr_b16 a[154:155], v20 offset:33792
 v_mfma_f32_16x16x32_bf16 v[184:187], a[156:159], a[232:235], v[184:187]
 buffer_load_dwordx4 a[84:87], v49, s[28:31], s39 offen offset:1024 nt
 v_mfma_f32_16x16x32_bf16 v[188:191], a[156:159], a[236:239], v[188:191]
 v_mfma_f32_16x16x32_bf16 v[248:251], a[156:159], a[240:243], v[248:251]
 buffer_load_dwordx4 a[88:91], v50, s[28:31], s39 offen offset:2048 nt
 v_mfma_f32_16x16x32_bf16 v[252:255], a[156:159], a[244:247], v[252:255]
 s_waitcnt lgkmcnt(2)
 v_mfma_f32_16x16x32_bf16 v[64:67], a[128:131], a[160:163], v[64:67]
 ds_read_b64_tr_b16 a[156:157], v21 offset:32768
 v_mfma_f32_16x16x32_bf16 v[68:71], a[128:131], a[164:167], v[68:71]
 ds_read_b64_tr_b16 a[158:159], v21 offset:33792
 v_mfma_f32_16x16x32_bf16 v[128:131], a[128:131], a[168:171], v[128:131]
 v_mfma_f32_16x16x32_bf16 v[132:135], a[128:131], a[172:175], v[132:135]
 v_mfma_f32_16x16x32_bf16 v[192:195], a[128:131], a[176:179], v[192:195]
 v_mfma_f32_16x16x32_bf16 v[196:199], a[128:131], a[180:183], v[196:199]
 v_mfma_f32_16x16x32_bf16 v[72:75], a[132:135], a[160:163], v[72:75]
 v_mfma_f32_16x16x32_bf16 v[76:79], a[132:135], a[164:167], v[76:79]
 s_waitcnt vmcnt(21) lgkmcnt(0)
 s_barrier
 v_mfma_f32_16x16x32_bf16 v[136:139], a[132:135], a[168:171], v[136:139]
 ds_read_b64_tr_b16 a[128:129], v14 offset:49152
 v_mfma_f32_16x16x32_bf16 v[140:143], a[132:135], a[172:175], v[140:143]
 ds_read_b64_tr_b16 a[130:131], v14 offset:50176
 v_mfma_f32_16x16x32_bf16 v[200:203], a[132:135], a[176:179], v[200:203]
 ds_read_b128 a[224:227], v11 offset:24576
 v_mfma_f32_16x16x32_bf16 v[204:207], a[132:135], a[180:183], v[204:207]
 ds_read_b128 a[228:231], v11 offset:26624
 v_mfma_f32_16x16x32_bf16 v[80:83], a[136:139], a[160:163], v[80:83]
 ds_read_b64_tr_b16 a[132:133], v15 offset:49152
 v_mfma_f32_16x16x32_bf16 v[84:87], a[136:139], a[164:167], v[84:87]
 ds_read_b64_tr_b16 a[134:135], v15 offset:50176
 v_mfma_f32_16x16x32_bf16 v[144:147], a[136:139], a[168:171], v[144:147]
 ds_read_b128 a[232:235], v11 offset:28672
 v_mfma_f32_16x16x32_bf16 v[148:151], a[136:139], a[172:175], v[148:151]
 ds_read_b128 a[236:239], v11 offset:30720
 v_mfma_f32_16x16x32_bf16 v[208:211], a[136:139], a[176:179], v[208:211]
 ds_read_b128 a[240:243], v11 offset:32768
 v_mfma_f32_16x16x32_bf16 v[212:215], a[136:139], a[180:183], v[212:215]
 ds_read_b128 a[244:247], v11 offset:34816
 v_mfma_f32_16x16x32_bf16 v[88:91], a[140:143], a[160:163], v[88:91]
 ds_read_b64_tr_b16 a[136:137], v16 offset:49152
 v_mfma_f32_16x16x32_bf16 v[92:95], a[140:143], a[164:167], v[92:95]
 ds_read_b64_tr_b16 a[138:139], v16 offset:50176
 v_mfma_f32_16x16x32_bf16 v[152:155], a[140:143], a[168:171], v[152:155]
 s_add_u32 m0, s49, 32768
 s_mov_b32 s47, 5767168
 v_mfma_f32_16x16x32_bf16 v[156:159], a[140:143], a[172:175], v[156:159]
 v_mfma_f32_16x16x32_bf16 v[216:219], a[140:143], a[176:179], v[216:219]
 buffer_load_dwordx4 v28, s[24:27], s47 offen lds
 v_mfma_f32_16x16x32_bf16 v[220:223], a[140:143], a[180:183], v[220:223]
 v_mfma_f32_16x16x32_bf16 v[96:99], a[144:147], a[160:163], v[96:99]
 ds_read_b64_tr_b16 a[140:141], v17 offset:49152
 v_mfma_f32_16x16x32_bf16 v[100:103], a[144:147], a[164:167], v[100:103]
 ds_read_b64_tr_b16 a[142:143], v17 offset:50176
 v_mfma_f32_16x16x32_bf16 v[160:163], a[144:147], a[168:171], v[160:163]
 buffer_load_dwordx4 v29, s[24:27], s47 offen offset:1024 lds
 v_mfma_f32_16x16x32_bf16 v[164:167], a[144:147], a[172:175], v[164:167]
 v_mfma_f32_16x16x32_bf16 v[224:227], a[144:147], a[176:179], v[224:227]
 buffer_load_dwordx4 v30, s[24:27], s47 offen offset:2048 lds
 v_mfma_f32_16x16x32_bf16 v[228:231], a[144:147], a[180:183], v[228:231]
 v_mfma_f32_16x16x32_bf16 v[104:107], a[148:151], a[160:163], v[104:107]
 ds_read_b64_tr_b16 a[144:145], v18 offset:49152
 v_mfma_f32_16x16x32_bf16 v[108:111], a[148:151], a[164:167], v[108:111]
 ds_read_b64_tr_b16 a[146:147], v18 offset:50176
 v_mfma_f32_16x16x32_bf16 v[168:171], a[148:151], a[168:171], v[168:171]
 buffer_load_dwordx4 v31, s[24:27], s47 offen offset:3072 lds
 v_mfma_f32_16x16x32_bf16 v[172:175], a[148:151], a[172:175], v[172:175]
 v_mfma_f32_16x16x32_bf16 v[232:235], a[148:151], a[176:179], v[232:235]
 s_add_u32 m0, s48, 3072
 s_movk_i32 s46, 1536
 v_mfma_f32_16x16x32_bf16 v[236:239], a[148:151], a[180:183], v[236:239]
 v_mfma_f32_16x16x32_bf16 v[112:115], a[152:155], a[160:163], v[112:115]
 ds_read_b64_tr_b16 a[148:149], v19 offset:49152
 v_mfma_f32_16x16x32_bf16 v[116:119], a[152:155], a[164:167], v[116:119]
 ds_read_b64_tr_b16 a[150:151], v19 offset:50176
 v_mfma_f32_16x16x32_bf16 v[176:179], a[152:155], a[168:171], v[176:179]
 buffer_load_dwordx4 v25, s[20:23], s46 offen lds
 v_mfma_f32_16x16x32_bf16 v[180:183], a[152:155], a[172:175], v[180:183]
 v_mfma_f32_16x16x32_bf16 v[240:243], a[152:155], a[176:179], v[240:243]
 buffer_load_dwordx4 v26, s[20:23], s46 offen offset:1024 lds
 v_mfma_f32_16x16x32_bf16 v[244:247], a[152:155], a[180:183], v[244:247]
 v_mfma_f32_16x16x32_bf16 v[120:123], a[156:159], a[160:163], v[120:123]
 ds_read_b64_tr_b16 a[152:153], v20 offset:49152
 v_mfma_f32_16x16x32_bf16 v[124:127], a[156:159], a[164:167], v[124:127]
 ds_read_b64_tr_b16 a[154:155], v20 offset:50176
 v_mfma_f32_16x16x32_bf16 v[184:187], a[156:159], a[168:171], v[184:187]
 buffer_load_dwordx4 v27, s[20:23], s46 offen offset:2048 lds
 v_mfma_f32_16x16x32_bf16 v[188:191], a[156:159], a[172:175], v[188:191]
 v_mfma_f32_16x16x32_bf16 v[248:251], a[156:159], a[176:179], v[248:251]
 buffer_load_dwordx4 a[92:95], v51, s[28:31], s39 offen offset:3072 nt
 v_mfma_f32_16x16x32_bf16 v[252:255], a[156:159], a[180:183], v[252:255]
 s_waitcnt lgkmcnt(2)
 v_mfma_f32_16x16x32_bf16 v[64:67], a[128:131], a[224:227], v[64:67]
 ds_read_b64_tr_b16 a[156:157], v21 offset:49152
 v_mfma_f32_16x16x32_bf16 v[68:71], a[128:131], a[228:231], v[68:71]
 ds_read_b64_tr_b16 a[158:159], v21 offset:50176
 v_mfma_f32_16x16x32_bf16 v[128:131], a[128:131], a[232:235], v[128:131]
 v_mfma_f32_16x16x32_bf16 v[132:135], a[128:131], a[236:239], v[132:135]
 v_mfma_f32_16x16x32_bf16 v[192:195], a[128:131], a[240:243], v[192:195]
 v_mfma_f32_16x16x32_bf16 v[196:199], a[128:131], a[244:247], v[196:199]
 v_mfma_f32_16x16x32_bf16 v[72:75], a[132:135], a[224:227], v[72:75]
 v_mfma_f32_16x16x32_bf16 v[76:79], a[132:135], a[228:231], v[76:79]
 s_waitcnt vmcnt(21) lgkmcnt(0)
 s_barrier
 v_mfma_f32_16x16x32_bf16 v[136:139], a[132:135], a[232:235], v[136:139]
 ds_read_b64_tr_b16 a[128:129], v14
 v_mfma_f32_16x16x32_bf16 v[140:143], a[132:135], a[236:239], v[140:143]
 ds_read_b64_tr_b16 a[130:131], v14 offset:1024
 v_mfma_f32_16x16x32_bf16 v[200:203], a[132:135], a[240:243], v[200:203]
 ds_read_b128 a[160:163], v12
 v_mfma_f32_16x16x32_bf16 v[204:207], a[132:135], a[244:247], v[204:207]
 ds_read_b128 a[164:167], v12 offset:2048
 v_mfma_f32_16x16x32_bf16 v[80:83], a[136:139], a[224:227], v[80:83]
 ds_read_b64_tr_b16 a[132:133], v15
 v_mfma_f32_16x16x32_bf16 v[84:87], a[136:139], a[228:231], v[84:87]
 ds_read_b64_tr_b16 a[134:135], v15 offset:1024
 v_mfma_f32_16x16x32_bf16 v[144:147], a[136:139], a[232:235], v[144:147]
 ds_read_b128 a[168:171], v12 offset:4096
 v_mfma_f32_16x16x32_bf16 v[148:151], a[136:139], a[236:239], v[148:151]
 ds_read_b128 a[172:175], v12 offset:6144
 v_mfma_f32_16x16x32_bf16 v[208:211], a[136:139], a[240:243], v[208:211]
 ds_read_b128 a[176:179], v12 offset:8192
 v_mfma_f32_16x16x32_bf16 v[212:215], a[136:139], a[244:247], v[212:215]
 ds_read_b128 a[180:183], v12 offset:10240
 v_mfma_f32_16x16x32_bf16 v[88:91], a[140:143], a[224:227], v[88:91]
 ds_read_b64_tr_b16 a[136:137], v16
 v_mfma_f32_16x16x32_bf16 v[92:95], a[140:143], a[228:231], v[92:95]
 ds_read_b64_tr_b16 a[138:139], v16 offset:1024
 v_mfma_f32_16x16x32_bf16 v[152:155], a[140:143], a[232:235], v[152:155]
 s_add_u32 m0, s49, 49152
 s_mov_b32 s47, 6029312
 v_mfma_f32_16x16x32_bf16 v[156:159], a[140:143], a[236:239], v[156:159]
 buffer_load_dwordx4 v28, s[24:27], s47 offen lds
 v_mfma_f32_16x16x32_bf16 v[216:219], a[140:143], a[240:243], v[216:219]
 v_mfma_f32_16x16x32_bf16 v[220:223], a[140:143], a[244:247], v[220:223]
 buffer_load_dwordx4 v29, s[24:27], s47 offen offset:1024 lds
 v_mfma_f32_16x16x32_bf16 v[96:99], a[144:147], a[224:227], v[96:99]
 ds_read_b64_tr_b16 a[140:141], v17
 v_mfma_f32_16x16x32_bf16 v[100:103], a[144:147], a[228:231], v[100:103]
 ds_read_b64_tr_b16 a[142:143], v17 offset:1024
 v_mfma_f32_16x16x32_bf16 v[160:163], a[144:147], a[232:235], v[160:163]
 v_mfma_f32_16x16x32_bf16 v[164:167], a[144:147], a[236:239], v[164:167]
 buffer_load_dwordx4 v30, s[24:27], s47 offen offset:2048 lds
 v_mfma_f32_16x16x32_bf16 v[224:227], a[144:147], a[240:243], v[224:227]
 v_mfma_f32_16x16x32_bf16 v[228:231], a[144:147], a[244:247], v[228:231]
 buffer_load_dwordx4 v31, s[24:27], s47 offen offset:3072 lds
 v_mfma_f32_16x16x32_bf16 v[104:107], a[148:151], a[224:227], v[104:107]
 ds_read_b64_tr_b16 a[144:145], v18
 v_mfma_f32_16x16x32_bf16 v[108:111], a[148:151], a[228:231], v[108:111]
 ds_read_b64_tr_b16 a[146:147], v18 offset:1024
 v_mfma_f32_16x16x32_bf16 v[168:171], a[148:151], a[232:235], v[168:171]
 v_mfma_f32_16x16x32_bf16 v[172:175], a[148:151], a[236:239], v[172:175]
 s_add_u32 m0, s48, 24576
 s_movk_i32 s46, 1664
 v_mfma_f32_16x16x32_bf16 v[232:235], a[148:151], a[240:243], v[232:235]
 buffer_load_dwordx4 v22, s[20:23], s46 offen lds
 v_mfma_f32_16x16x32_bf16 v[236:239], a[148:151], a[244:247], v[236:239]
 v_mfma_f32_16x16x32_bf16 v[112:115], a[152:155], a[224:227], v[112:115]
 ds_read_b64_tr_b16 a[148:149], v19
 v_mfma_f32_16x16x32_bf16 v[116:119], a[152:155], a[228:231], v[116:119]
 ds_read_b64_tr_b16 a[150:151], v19 offset:1024
 v_mfma_f32_16x16x32_bf16 v[176:179], a[152:155], a[232:235], v[176:179]
 buffer_load_dwordx4 v23, s[20:23], s46 offen offset:1024 lds
 v_mfma_f32_16x16x32_bf16 v[180:183], a[152:155], a[236:239], v[180:183]
 v_mfma_f32_16x16x32_bf16 v[240:243], a[152:155], a[240:243], v[240:243]
 buffer_load_dwordx4 v24, s[20:23], s46 offen offset:2048 lds
 v_mfma_f32_16x16x32_bf16 v[244:247], a[152:155], a[244:247], v[244:247]
 v_mfma_f32_16x16x32_bf16 v[120:123], a[156:159], a[224:227], v[120:123]
 ds_read_b64_tr_b16 a[152:153], v20
 v_mfma_f32_16x16x32_bf16 v[124:127], a[156:159], a[228:231], v[124:127]
 ds_read_b64_tr_b16 a[154:155], v20 offset:1024
 v_mfma_f32_16x16x32_bf16 v[184:187], a[156:159], a[232:235], v[184:187]
 s_add_u32 s39, s58, 24576
 s_and_b32 s39, s39, 262143
 v_mfma_f32_16x16x32_bf16 v[188:191], a[156:159], a[236:239], v[188:191]
 v_mfma_f32_16x16x32_bf16 v[248:251], a[156:159], a[240:243], v[248:251]
 buffer_load_dwordx4 a[96:99], v48, s[28:31], s39 offen nt
 v_mfma_f32_16x16x32_bf16 v[252:255], a[156:159], a[244:247], v[252:255]
 s_waitcnt lgkmcnt(2)
 v_mfma_f32_16x16x32_bf16 v[64:67], a[128:131], a[160:163], v[64:67]
 ds_read_b64_tr_b16 a[156:157], v21
 v_mfma_f32_16x16x32_bf16 v[68:71], a[128:131], a[164:167], v[68:71]
 ds_read_b64_tr_b16 a[158:159], v21 offset:1024
 v_mfma_f32_16x16x32_bf16 v[128:131], a[128:131], a[168:171], v[128:131]
 v_mfma_f32_16x16x32_bf16 v[132:135], a[128:131], a[172:175], v[132:135]
 v_mfma_f32_16x16x32_bf16 v[192:195], a[128:131], a[176:179], v[192:195]
 v_mfma_f32_16x16x32_bf16 v[196:199], a[128:131], a[180:183], v[196:199]
 v_mfma_f32_16x16x32_bf16 v[72:75], a[132:135], a[160:163], v[72:75]
 v_mfma_f32_16x16x32_bf16 v[76:79], a[132:135], a[164:167], v[76:79]
 s_waitcnt vmcnt(21) lgkmcnt(0)
 s_barrier
 v_mfma_f32_16x16x32_bf16 v[136:139], a[132:135], a[168:171], v[136:139]
 ds_read_b64_tr_b16 a[128:129], v14 offset:16384
 v_mfma_f32_16x16x32_bf16 v[140:143], a[132:135], a[172:175], v[140:143]
 ds_read_b64_tr_b16 a[130:131], v14 offset:17408
 v_mfma_f32_16x16x32_bf16 v[200:203], a[132:135], a[176:179], v[200:203]
 ds_read_b128 a[224:227], v13
 v_mfma_f32_16x16x32_bf16 v[204:207], a[132:135], a[180:183], v[204:207]
 ds_read_b128 a[228:231], v13 offset:2048
 v_mfma_f32_16x16x32_bf16 v[80:83], a[136:139], a[160:163], v[80:83]
 ds_read_b64_tr_b16 a[132:133], v15 offset:16384
 v_mfma_f32_16x16x32_bf16 v[84:87], a[136:139], a[164:167], v[84:87]
 ds_read_b64_tr_b16 a[134:135], v15 offset:17408
 v_mfma_f32_16x16x32_bf16 v[144:147], a[136:139], a[168:171], v[144:147]
 ds_read_b128 a[232:235], v13 offset:4096
 v_mfma_f32_16x16x32_bf16 v[148:151], a[136:139], a[172:175], v[148:151]
 ds_read_b128 a[236:239], v13 offset:6144
 v_mfma_f32_16x16x32_bf16 v[208:211], a[136:139], a[176:179], v[208:211]
 ds_read_b128 a[240:243], v13 offset:8192
 v_mfma_f32_16x16x32_bf16 v[212:215], a[136:139], a[180:183], v[212:215]
 ds_read_b128 a[244:247], v13 offset:10240
 v_mfma_f32_16x16x32_bf16 v[88:91], a[140:143], a[160:163], v[88:91]
 ds_read_b64_tr_b16 a[136:137], v16 offset:16384
 v_mfma_f32_16x16x32_bf16 v[92:95], a[140:143], a[164:167], v[92:95]
 ds_read_b64_tr_b16 a[138:139], v16 offset:17408
 v_mfma_f32_16x16x32_bf16 v[152:155], a[140:143], a[168:171], v[152:155]
 s_add_u32 m0, s49, 0
 s_mov_b32 s47, 6291456
 v_mfma_f32_16x16x32_bf16 v[156:159], a[140:143], a[172:175], v[156:159]
 v_mfma_f32_16x16x32_bf16 v[216:219], a[140:143], a[176:179], v[216:219]
 buffer_load_dwordx4 v28, s[24:27], s47 offen lds
 v_mfma_f32_16x16x32_bf16 v[220:223], a[140:143], a[180:183], v[220:223]
 v_mfma_f32_16x16x32_bf16 v[96:99], a[144:147], a[160:163], v[96:99]
 ds_read_b64_tr_b16 a[140:141], v17 offset:16384
 v_mfma_f32_16x16x32_bf16 v[100:103], a[144:147], a[164:167], v[100:103]
 ds_read_b64_tr_b16 a[142:143], v17 offset:17408
 v_mfma_f32_16x16x32_bf16 v[160:163], a[144:147], a[168:171], v[160:163]
 buffer_load_dwordx4 v29, s[24:27], s47 offen offset:1024 lds
 v_mfma_f32_16x16x32_bf16 v[164:167], a[144:147], a[172:175], v[164:167]
 v_mfma_f32_16x16x32_bf16 v[224:227], a[144:147], a[176:179], v[224:227]
 buffer_load_dwordx4 v30, s[24:27], s47 offen offset:2048 lds
 v_mfma_f32_16x16x32_bf16 v[228:231], a[144:147], a[180:183], v[228:231]
 v_mfma_f32_16x16x32_bf16 v[104:107], a[148:151], a[160:163], v[104:107]
 ds_read_b64_tr_b16 a[144:145], v18 offset:16384
 v_mfma_f32_16x16x32_bf16 v[108:111], a[148:151], a[164:167], v[108:111]
 ds_read_b64_tr_b16 a[146:147], v18 offset:17408
 v_mfma_f32_16x16x32_bf16 v[168:171], a[148:151], a[168:171], v[168:171]
 buffer_load_dwordx4 v31, s[24:27], s47 offen offset:3072 lds
 v_mfma_f32_16x16x32_bf16 v[172:175], a[148:151], a[172:175], v[172:175]
 v_mfma_f32_16x16x32_bf16 v[232:235], a[148:151], a[176:179], v[232:235]
 s_add_u32 m0, s48, 27648
 s_movk_i32 s46, 1664
 v_mfma_f32_16x16x32_bf16 v[236:239], a[148:151], a[180:183], v[236:239]
 v_mfma_f32_16x16x32_bf16 v[112:115], a[152:155], a[160:163], v[112:115]
 ds_read_b64_tr_b16 a[148:149], v19 offset:16384
 v_mfma_f32_16x16x32_bf16 v[116:119], a[152:155], a[164:167], v[116:119]
 ds_read_b64_tr_b16 a[150:151], v19 offset:17408
 v_mfma_f32_16x16x32_bf16 v[176:179], a[152:155], a[168:171], v[176:179]
 buffer_load_dwordx4 v25, s[20:23], s46 offen lds
 v_mfma_f32_16x16x32_bf16 v[180:183], a[152:155], a[172:175], v[180:183]
 v_mfma_f32_16x16x32_bf16 v[240:243], a[152:155], a[176:179], v[240:243]
 buffer_load_dwordx4 v26, s[20:23], s46 offen offset:1024 lds
 v_mfma_f32_16x16x32_bf16 v[244:247], a[152:155], a[180:183], v[244:247]
 v_mfma_f32_16x16x32_bf16 v[120:123], a[156:159], a[160:163], v[120:123]
 ds_read_b64_tr_b16 a[152:153], v20 offset:16384
 v_mfma_f32_16x16x32_bf16 v[124:127], a[156:159], a[164:167], v[124:127]
 ds_read_b64_tr_b16 a[154:155], v20 offset:17408
 v_mfma_f32_16x16x32_bf16 v[184:187], a[156:159], a[168:171], v[184:187]
 buffer_load_dwordx4 v27, s[20:23], s46 offen offset:2048 lds
 v_mfma_f32_16x16x32_bf16 v[188:191], a[156:159], a[172:175], v[188:191]
 v_mfma_f32_16x16x32_bf16 v[248:251], a[156:159], a[176:179], v[248:251]
 buffer_load_dwordx4 a[100:103], v49, s[28:31], s39 offen offset:1024 nt
 v_mfma_f32_16x16x32_bf16 v[252:255], a[156:159], a[180:183], v[252:255]
 s_waitcnt lgkmcnt(2)
 v_mfma_f32_16x16x32_bf16 v[64:67], a[128:131], a[224:227], v[64:67]
 ds_read_b64_tr_b16 a[156:157], v21 offset:16384
 v_mfma_f32_16x16x32_bf16 v[68:71], a[128:131], a[228:231], v[68:71]
 ds_read_b64_tr_b16 a[158:159], v21 offset:17408
 v_mfma_f32_16x16x32_bf16 v[128:131], a[128:131], a[232:235], v[128:131]
 v_mfma_f32_16x16x32_bf16 v[132:135], a[128:131], a[236:239], v[132:135]
 v_mfma_f32_16x16x32_bf16 v[192:195], a[128:131], a[240:243], v[192:195]
 v_mfma_f32_16x16x32_bf16 v[196:199], a[128:131], a[244:247], v[196:199]
 v_mfma_f32_16x16x32_bf16 v[72:75], a[132:135], a[224:227], v[72:75]
 v_mfma_f32_16x16x32_bf16 v[76:79], a[132:135], a[228:231], v[76:79]
 s_waitcnt vmcnt(20) lgkmcnt(0)
 s_barrier
 v_mfma_f32_16x16x32_bf16 v[136:139], a[132:135], a[232:235], v[136:139]
 ds_read_b64_tr_b16 a[128:129], v14 offset:32768
 v_mfma_f32_16x16x32_bf16 v[140:143], a[132:135], a[236:239], v[140:143]
 ds_read_b64_tr_b16 a[130:131], v14 offset:33792
 v_mfma_f32_16x16x32_bf16 v[200:203], a[132:135], a[240:243], v[200:203]
 ds_read_b128 a[160:163], v12 offset:24576
 v_mfma_f32_16x16x32_bf16 v[204:207], a[132:135], a[244:247], v[204:207]
 ds_read_b128 a[164:167], v12 offset:26624
 v_mfma_f32_16x16x32_bf16 v[80:83], a[136:139], a[224:227], v[80:83]
 ds_read_b64_tr_b16 a[132:133], v15 offset:32768
 v_mfma_f32_16x16x32_bf16 v[84:87], a[136:139], a[228:231], v[84:87]
 ds_read_b64_tr_b16 a[134:135], v15 offset:33792
 v_mfma_f32_16x16x32_bf16 v[144:147], a[136:139], a[232:235], v[144:147]
 ds_read_b128 a[168:171], v12 offset:28672
 v_mfma_f32_16x16x32_bf16 v[148:151], a[136:139], a[236:239], v[148:151]
 ds_read_b128 a[172:175], v12 offset:30720
 v_mfma_f32_16x16x32_bf16 v[208:211], a[136:139], a[240:243], v[208:211]
 ds_read_b128 a[176:179], v12 offset:32768
 v_mfma_f32_16x16x32_bf16 v[212:215], a[136:139], a[244:247], v[212:215]
 ds_read_b128 a[180:183], v12 offset:34816
 v_mfma_f32_16x16x32_bf16 v[88:91], a[140:143], a[224:227], v[88:91]
 ds_read_b64_tr_b16 a[136:137], v16 offset:32768
 v_mfma_f32_16x16x32_bf16 v[92:95], a[140:143], a[228:231], v[92:95]
 ds_read_b64_tr_b16 a[138:139], v16 offset:33792
 v_mfma_f32_16x16x32_bf16 v[152:155], a[140:143], a[232:235], v[152:155]
 s_add_u32 m0, s49, 16384
 s_mov_b32 s47, 6553600
 v_mfma_f32_16x16x32_bf16 v[156:159], a[140:143], a[236:239], v[156:159]
 buffer_load_dwordx4 v28, s[24:27], s47 offen lds
 v_mfma_f32_16x16x32_bf16 v[216:219], a[140:143], a[240:243], v[216:219]
 v_mfma_f32_16x16x32_bf16 v[220:223], a[140:143], a[244:247], v[220:223]
 buffer_load_dwordx4 v29, s[24:27], s47 offen offset:1024 lds
 v_mfma_f32_16x16x32_bf16 v[96:99], a[144:147], a[224:227], v[96:99]
 ds_read_b64_tr_b16 a[140:141], v17 offset:32768
 v_mfma_f32_16x16x32_bf16 v[100:103], a[144:147], a[228:231], v[100:103]
 ds_read_b64_tr_b16 a[142:143], v17 offset:33792
 v_mfma_f32_16x16x32_bf16 v[160:163], a[144:147], a[232:235], v[160:163]
 v_mfma_f32_16x16x32_bf16 v[164:167], a[144:147], a[236:239], v[164:167]
 buffer_load_dwordx4 v30, s[24:27], s47 offen offset:2048 lds
 v_mfma_f32_16x16x32_bf16 v[224:227], a[144:147], a[240:243], v[224:227]
 v_mfma_f32_16x16x32_bf16 v[228:231], a[144:147], a[244:247], v[228:231]
 buffer_load_dwordx4 v31, s[24:27], s47 offen offset:3072 lds
 v_mfma_f32_16x16x32_bf16 v[104:107], a[148:151], a[224:227], v[104:107]
 ds_read_b64_tr_b16 a[144:145], v18 offset:32768
 v_mfma_f32_16x16x32_bf16 v[108:111], a[148:151], a[228:231], v[108:111]
 ds_read_b64_tr_b16 a[146:147], v18 offset:33792
 v_mfma_f32_16x16x32_bf16 v[168:171], a[148:151], a[232:235], v[168:171]
 v_mfma_f32_16x16x32_bf16 v[172:175], a[148:151], a[236:239], v[172:175]
 s_add_u32 m0, s48, 49152
 s_movk_i32 s46, 1792
 v_mfma_f32_16x16x32_bf16 v[232:235], a[148:151], a[240:243], v[232:235]
 buffer_load_dwordx4 v22, s[20:23], s46 offen lds
 v_mfma_f32_16x16x32_bf16 v[236:239], a[148:151], a[244:247], v[236:239]
 v_mfma_f32_16x16x32_bf16 v[112:115], a[152:155], a[224:227], v[112:115]
 ds_read_b64_tr_b16 a[148:149], v19 offset:32768
 v_mfma_f32_16x16x32_bf16 v[116:119], a[152:155], a[228:231], v[116:119]
 ds_read_b64_tr_b16 a[150:151], v19 offset:33792
 v_mfma_f32_16x16x32_bf16 v[176:179], a[152:155], a[232:235], v[176:179]
 buffer_load_dwordx4 v23, s[20:23], s46 offen offset:1024 lds
 v_mfma_f32_16x16x32_bf16 v[180:183], a[152:155], a[236:239], v[180:183]
 v_mfma_f32_16x16x32_bf16 v[240:243], a[152:155], a[240:243], v[240:243]
 buffer_load_dwordx4 v24, s[20:23], s46 offen offset:2048 lds
 v_mfma_f32_16x16x32_bf16 v[244:247], a[152:155], a[244:247], v[244:247]
 v_mfma_f32_16x16x32_bf16 v[120:123], a[156:159], a[224:227], v[120:123]
 ds_read_b64_tr_b16 a[152:153], v20 offset:32768
 v_mfma_f32_16x16x32_bf16 v[124:127], a[156:159], a[228:231], v[124:127]
 ds_read_b64_tr_b16 a[154:155], v20 offset:33792
 v_mfma_f32_16x16x32_bf16 v[184:187], a[156:159], a[232:235], v[184:187]
 buffer_load_dwordx4 a[104:107], v50, s[28:31], s39 offen offset:2048 nt
 v_mfma_f32_16x16x32_bf16 v[188:191], a[156:159], a[236:239], v[188:191]
 v_mfma_f32_16x16x32_bf16 v[248:251], a[156:159], a[240:243], v[248:251]
 buffer_load_dwordx4 a[108:111], v51, s[28:31], s39 offen offset:3072 nt
 v_mfma_f32_16x16x32_bf16 v[252:255], a[156:159], a[244:247], v[252:255]
 s_waitcnt lgkmcnt(2)
 v_mfma_f32_16x16x32_bf16 v[64:67], a[128:131], a[160:163], v[64:67]
 ds_read_b64_tr_b16 a[156:157], v21 offset:32768
 v_mfma_f32_16x16x32_bf16 v[68:71], a[128:131], a[164:167], v[68:71]
 ds_read_b64_tr_b16 a[158:159], v21 offset:33792
 v_mfma_f32_16x16x32_bf16 v[128:131], a[128:131], a[168:171], v[128:131]
 v_mfma_f32_16x16x32_bf16 v[132:135], a[128:131], a[172:175], v[132:135]
 v_mfma_f32_16x16x32_bf16 v[192:195], a[128:131], a[176:179], v[192:195]
 v_mfma_f32_16x16x32_bf16 v[196:199], a[128:131], a[180:183], v[196:199]
 v_mfma_f32_16x16x32_bf16 v[72:75], a[132:135], a[160:163], v[72:75]
 v_mfma_f32_16x16x32_bf16 v[76:79], a[132:135], a[164:167], v[76:79]
 s_waitcnt vmcnt(21) lgkmcnt(0)
 s_barrier
 v_mfma_f32_16x16x32_bf16 v[136:139], a[132:135], a[168:171], v[136:139]
 ds_read_b64_tr_b16 a[128:129], v14 offset:49152
 v_mfma_f32_16x16x32_bf16 v[140:143], a[132:135], a[172:175], v[140:143]
 ds_read_b64_tr_b16 a[130:131], v14 offset:50176
 v_mfma_f32_16x16x32_bf16 v[200:203], a[132:135], a[176:179], v[200:203]
 ds_read_b128 a[224:227], v13 offset:24576
 v_mfma_f32_16x16x32_bf16 v[204:207], a[132:135], a[180:183], v[204:207]
 ds_read_b128 a[228:231], v13 offset:26624
 v_mfma_f32_16x16x32_bf16 v[80:83], a[136:139], a[160:163], v[80:83]
 ds_read_b64_tr_b16 a[132:133], v15 offset:49152
 v_mfma_f32_16x16x32_bf16 v[84:87], a[136:139], a[164:167], v[84:87]
 ds_read_b64_tr_b16 a[134:135], v15 offset:50176
 v_mfma_f32_16x16x32_bf16 v[144:147], a[136:139], a[168:171], v[144:147]
 ds_read_b128 a[232:235], v13 offset:28672
 v_mfma_f32_16x16x32_bf16 v[148:151], a[136:139], a[172:175], v[148:151]
 ds_read_b128 a[236:239], v13 offset:30720
 v_mfma_f32_16x16x32_bf16 v[208:211], a[136:139], a[176:179], v[208:211]
 ds_read_b128 a[240:243], v13 offset:32768
 v_mfma_f32_16x16x32_bf16 v[212:215], a[136:139], a[180:183], v[212:215]
 ds_read_b128 a[244:247], v13 offset:34816
 v_mfma_f32_16x16x32_bf16 v[88:91], a[140:143], a[160:163], v[88:91]
 ds_read_b64_tr_b16 a[136:137], v16 offset:49152
 v_mfma_f32_16x16x32_bf16 v[92:95], a[140:143], a[164:167], v[92:95]
 ds_read_b64_tr_b16 a[138:139], v16 offset:50176
 v_mfma_f32_16x16x32_bf16 v[152:155], a[140:143], a[168:171], v[152:155]
 s_add_u32 m0, s49, 32768
 s_mov_b32 s47, 6815744
 v_mfma_f32_16x16x32_bf16 v[156:159], a[140:143], a[172:175], v[156:159]
 buffer_load_dwordx4 v28, s[24:27], s47 offen lds
 v_mfma_f32_16x16x32_bf16 v[216:219], a[140:143], a[176:179], v[216:219]
 v_mfma_f32_16x16x32_bf16 v[220:223], a[140:143], a[180:183], v[220:223]
 buffer_load_dwordx4 v29, s[24:27], s47 offen offset:1024 lds
 v_mfma_f32_16x16x32_bf16 v[96:99], a[144:147], a[160:163], v[96:99]
 ds_read_b64_tr_b16 a[140:141], v17 offset:49152
 v_mfma_f32_16x16x32_bf16 v[100:103], a[144:147], a[164:167], v[100:103]
 ds_read_b64_tr_b16 a[142:143], v17 offset:50176
 v_mfma_f32_16x16x32_bf16 v[160:163], a[144:147], a[168:171], v[160:163]
 v_mfma_f32_16x16x32_bf16 v[164:167], a[144:147], a[172:175], v[164:167]
 buffer_load_dwordx4 v30, s[24:27], s47 offen offset:2048 lds
 v_mfma_f32_16x16x32_bf16 v[224:227], a[144:147], a[176:179], v[224:227]
 v_mfma_f32_16x16x32_bf16 v[228:231], a[144:147], a[180:183], v[228:231]
 buffer_load_dwordx4 v31, s[24:27], s47 offen offset:3072 lds
 v_mfma_f32_16x16x32_bf16 v[104:107], a[148:151], a[160:163], v[104:107]
 ds_read_b64_tr_b16 a[144:145], v18 offset:49152
 v_mfma_f32_16x16x32_bf16 v[108:111], a[148:151], a[164:167], v[108:111]
 ds_read_b64_tr_b16 a[146:147], v18 offset:50176
 v_mfma_f32_16x16x32_bf16 v[168:171], a[148:151], a[168:171], v[168:171]
 v_mfma_f32_16x16x32_bf16 v[172:175], a[148:151], a[172:175], v[172:175]
 s_add_u32 m0, s48, 52224
 s_movk_i32 s46, 1792
 v_mfma_f32_16x16x32_bf16 v[232:235], a[148:151], a[176:179], v[232:235]
 buffer_load_dwordx4 v25, s[20:23], s46 offen lds
 v_mfma_f32_16x16x32_bf16 v[236:239], a[148:151], a[180:183], v[236:239]
 v_mfma_f32_16x16x32_bf16 v[112:115], a[152:155], a[160:163], v[112:115]
 ds_read_b64_tr_b16 a[148:149], v19 offset:49152
 v_mfma_f32_16x16x32_bf16 v[116:119], a[152:155], a[164:167], v[116:119]
 ds_read_b64_tr_b16 a[150:151], v19 offset:50176
 v_mfma_f32_16x16x32_bf16 v[176:179], a[152:155], a[168:171], v[176:179]
 buffer_load_dwordx4 v26, s[20:23], s46 offen offset:1024 lds
 v_mfma_f32_16x16x32_bf16 v[180:183], a[152:155], a[172:175], v[180:183]
 v_mfma_f32_16x16x32_bf16 v[240:243], a[152:155], a[176:179], v[240:243]
 buffer_load_dwordx4 v27, s[20:23], s46 offen offset:2048 lds
 v_mfma_f32_16x16x32_bf16 v[244:247], a[152:155], a[180:183], v[244:247]
 v_mfma_f32_16x16x32_bf16 v[120:123], a[156:159], a[160:163], v[120:123]
 ds_read_b64_tr_b16 a[152:153], v20 offset:49152
 v_mfma_f32_16x16x32_bf16 v[124:127], a[156:159], a[164:167], v[124:127]
 ds_read_b64_tr_b16 a[154:155], v20 offset:50176
 v_mfma_f32_16x16x32_bf16 v[184:187], a[156:159], a[168:171], v[184:187]
 s_add_u32 s39, s58, 28672
 s_and_b32 s39, s39, 262143
 v_mfma_f32_16x16x32_bf16 v[188:191], a[156:159], a[172:175], v[188:191]
 v_mfma_f32_16x16x32_bf16 v[248:251], a[156:159], a[176:179], v[248:251]
 buffer_load_dwordx4 a[112:115], v48, s[28:31], s39 offen nt
 v_mfma_f32_16x16x32_bf16 v[252:255], a[156:159], a[180:183], v[252:255]
 s_waitcnt lgkmcnt(2)
 v_mfma_f32_16x16x32_bf16 v[64:67], a[128:131], a[224:227], v[64:67]
 ds_read_b64_tr_b16 a[156:157], v21 offset:49152
 v_mfma_f32_16x16x32_bf16 v[68:71], a[128:131], a[228:231], v[68:71]
 ds_read_b64_tr_b16 a[158:159], v21 offset:50176
 v_mfma_f32_16x16x32_bf16 v[128:131], a[128:131], a[232:235], v[128:131]
 v_mfma_f32_16x16x32_bf16 v[132:135], a[128:131], a[236:239], v[132:135]
 v_mfma_f32_16x16x32_bf16 v[192:195], a[128:131], a[240:243], v[192:195]
 v_mfma_f32_16x16x32_bf16 v[196:199], a[128:131], a[244:247], v[196:199]
 v_mfma_f32_16x16x32_bf16 v[72:75], a[132:135], a[224:227], v[72:75]
 v_mfma_f32_16x16x32_bf16 v[76:79], a[132:135], a[228:231], v[76:79]
 s_waitcnt vmcnt(21) lgkmcnt(0)
 s_barrier
 v_mfma_f32_16x16x32_bf16 v[136:139], a[132:135], a[232:235], v[136:139]
 ds_read_b64_tr_b16 a[128:129], v14
 v_mfma_f32_16x16x32_bf16 v[140:143], a[132:135], a[236:239], v[140:143]
 ds_read_b64_tr_b16 a[130:131], v14 offset:1024
 v_mfma_f32_16x16x32_bf16 v[200:203], a[132:135], a[240:243], v[200:203]
 ds_read_b128 a[160:163], v10
 v_mfma_f32_16x16x32_bf16 v[204:207], a[132:135], a[244:247], v[204:207]
 ds_read_b128 a[164:167], v10 offset:2048
 v_mfma_f32_16x16x32_bf16 v[80:83], a[136:139], a[224:227], v[80:83]
 ds_read_b64_tr_b16 a[132:133], v15
 v_mfma_f32_16x16x32_bf16 v[84:87], a[136:139], a[228:231], v[84:87]
 ds_read_b64_tr_b16 a[134:135], v15 offset:1024
 v_mfma_f32_16x16x32_bf16 v[144:147], a[136:139], a[232:235], v[144:147]
 ds_read_b128 a[168:171], v10 offset:4096
 v_mfma_f32_16x16x32_bf16 v[148:151], a[136:139], a[236:239], v[148:151]
 ds_read_b128 a[172:175], v10 offset:6144
 v_mfma_f32_16x16x32_bf16 v[208:211], a[136:139], a[240:243], v[208:211]
 ds_read_b128 a[176:179], v10 offset:8192
 v_mfma_f32_16x16x32_bf16 v[212:215], a[136:139], a[244:247], v[212:215]
 ds_read_b128 a[180:183], v10 offset:10240
 v_mfma_f32_16x16x32_bf16 v[88:91], a[140:143], a[224:227], v[88:91]
 ds_read_b64_tr_b16 a[136:137], v16
 v_mfma_f32_16x16x32_bf16 v[92:95], a[140:143], a[228:231], v[92:95]
 ds_read_b64_tr_b16 a[138:139], v16 offset:1024
 v_mfma_f32_16x16x32_bf16 v[152:155], a[140:143], a[232:235], v[152:155]
 s_add_u32 m0, s49, 49152
 s_mov_b32 s47, 7077888
 v_mfma_f32_16x16x32_bf16 v[156:159], a[140:143], a[236:239], v[156:159]
 v_mfma_f32_16x16x32_bf16 v[216:219], a[140:143], a[240:243], v[216:219]
 buffer_load_dwordx4 v28, s[24:27], s47 offen lds
 v_mfma_f32_16x16x32_bf16 v[220:223], a[140:143], a[244:247], v[220:223]
 v_mfma_f32_16x16x32_bf16 v[96:99], a[144:147], a[224:227], v[96:99]
 ds_read_b64_tr_b16 a[140:141], v17
 v_mfma_f32_16x16x32_bf16 v[100:103], a[144:147], a[228:231], v[100:103]
 ds_read_b64_tr_b16 a[142:143], v17 offset:1024
 v_mfma_f32_16x16x32_bf16 v[160:163], a[144:147], a[232:235], v[160:163]
 buffer_load_dwordx4 v29, s[24:27], s47 offen offset:1024 lds
 v_mfma_f32_16x16x32_bf16 v[164:167], a[144:147], a[236:239], v[164:167]
 v_mfma_f32_16x16x32_bf16 v[224:227], a[144:147], a[240:243], v[224:227]
 buffer_load_dwordx4 v30, s[24:27], s47 offen offset:2048 lds
 v_mfma_f32_16x16x32_bf16 v[228:231], a[144:147], a[244:247], v[228:231]
 v_mfma_f32_16x16x32_bf16 v[104:107], a[148:151], a[224:227], v[104:107]
 ds_read_b64_tr_b16 a[144:145], v18
 v_mfma_f32_16x16x32_bf16 v[108:111], a[148:151], a[228:231], v[108:111]
 ds_read_b64_tr_b16 a[146:147], v18 offset:1024
 v_mfma_f32_16x16x32_bf16 v[168:171], a[148:151], a[232:235], v[168:171]
 buffer_load_dwordx4 v31, s[24:27], s47 offen offset:3072 lds
 v_mfma_f32_16x16x32_bf16 v[172:175], a[148:151], a[236:239], v[172:175]
 v_mfma_f32_16x16x32_bf16 v[232:235], a[148:151], a[240:243], v[232:235]
 s_add_u32 m0, s48, 73728
 s_movk_i32 s46, 1920
 v_mfma_f32_16x16x32_bf16 v[236:239], a[148:151], a[244:247], v[236:239]
 v_mfma_f32_16x16x32_bf16 v[112:115], a[152:155], a[224:227], v[112:115]
 ds_read_b64_tr_b16 a[148:149], v19
 v_mfma_f32_16x16x32_bf16 v[116:119], a[152:155], a[228:231], v[116:119]
 ds_read_b64_tr_b16 a[150:151], v19 offset:1024
 v_mfma_f32_16x16x32_bf16 v[176:179], a[152:155], a[232:235], v[176:179]
 buffer_load_dwordx4 v22, s[20:23], s46 offen lds
 v_mfma_f32_16x16x32_bf16 v[180:183], a[152:155], a[236:239], v[180:183]
 v_mfma_f32_16x16x32_bf16 v[240:243], a[152:155], a[240:243], v[240:243]
 buffer_load_dwordx4 v23, s[20:23], s46 offen offset:1024 lds
 v_mfma_f32_16x16x32_bf16 v[244:247], a[152:155], a[244:247], v[244:247]
 v_mfma_f32_16x16x32_bf16 v[120:123], a[156:159], a[224:227], v[120:123]
 ds_read_b64_tr_b16 a[152:153], v20
 v_mfma_f32_16x16x32_bf16 v[124:127], a[156:159], a[228:231], v[124:127]
 ds_read_b64_tr_b16 a[154:155], v20 offset:1024
 v_mfma_f32_16x16x32_bf16 v[184:187], a[156:159], a[232:235], v[184:187]
 buffer_load_dwordx4 v24, s[20:23], s46 offen offset:2048 lds
 v_mfma_f32_16x16x32_bf16 v[188:191], a[156:159], a[236:239], v[188:191]
 v_mfma_f32_16x16x32_bf16 v[248:251], a[156:159], a[240:243], v[248:251]
 buffer_load_dwordx4 a[116:119], v49, s[28:31], s39 offen offset:1024 nt
 v_mfma_f32_16x16x32_bf16 v[252:255], a[156:159], a[244:247], v[252:255]
 s_waitcnt lgkmcnt(2)
 v_mfma_f32_16x16x32_bf16 v[64:67], a[128:131], a[160:163], v[64:67]
 ds_read_b64_tr_b16 a[156:157], v21
 v_mfma_f32_16x16x32_bf16 v[68:71], a[128:131], a[164:167], v[68:71]
 ds_read_b64_tr_b16 a[158:159], v21 offset:1024
 v_mfma_f32_16x16x32_bf16 v[128:131], a[128:131], a[168:171], v[128:131]
 v_mfma_f32_16x16x32_bf16 v[132:135], a[128:131], a[172:175], v[132:135]
 v_mfma_f32_16x16x32_bf16 v[192:195], a[128:131], a[176:179], v[192:195]
 v_mfma_f32_16x16x32_bf16 v[196:199], a[128:131], a[180:183], v[196:199]
 v_mfma_f32_16x16x32_bf16 v[72:75], a[132:135], a[160:163], v[72:75]
 v_mfma_f32_16x16x32_bf16 v[76:79], a[132:135], a[164:167], v[76:79]
 s_waitcnt vmcnt(21) lgkmcnt(0)
 s_barrier
 v_mfma_f32_16x16x32_bf16 v[136:139], a[132:135], a[168:171], v[136:139]
 ds_read_b64_tr_b16 a[128:129], v14 offset:16384
 v_mfma_f32_16x16x32_bf16 v[140:143], a[132:135], a[172:175], v[140:143]
 ds_read_b64_tr_b16 a[130:131], v14 offset:17408
 v_mfma_f32_16x16x32_bf16 v[200:203], a[132:135], a[176:179], v[200:203]
 ds_read_b128 a[224:227], v11
 v_mfma_f32_16x16x32_bf16 v[204:207], a[132:135], a[180:183], v[204:207]
 ds_read_b128 a[228:231], v11 offset:2048
 v_mfma_f32_16x16x32_bf16 v[80:83], a[136:139], a[160:163], v[80:83]
 ds_read_b64_tr_b16 a[132:133], v15 offset:16384
 v_mfma_f32_16x16x32_bf16 v[84:87], a[136:139], a[164:167], v[84:87]
 ds_read_b64_tr_b16 a[134:135], v15 offset:17408
 v_mfma_f32_16x16x32_bf16 v[144:147], a[136:139], a[168:171], v[144:147]
 ds_read_b128 a[232:235], v11 offset:4096
 v_mfma_f32_16x16x32_bf16 v[148:151], a[136:139], a[172:175], v[148:151]
 ds_read_b128 a[236:239], v11 offset:6144
 v_mfma_f32_16x16x32_bf16 v[208:211], a[136:139], a[176:179], v[208:211]
 ds_read_b128 a[240:243], v11 offset:8192
 v_mfma_f32_16x16x32_bf16 v[212:215], a[136:139], a[180:183], v[212:215]
 ds_read_b128 a[244:247], v11 offset:10240
 v_mfma_f32_16x16x32_bf16 v[88:91], a[140:143], a[160:163], v[88:91]
 ds_read_b64_tr_b16 a[136:137], v16 offset:16384
 v_mfma_f32_16x16x32_bf16 v[92:95], a[140:143], a[164:167], v[92:95]
 ds_read_b64_tr_b16 a[138:139], v16 offset:17408
 v_mfma_f32_16x16x32_bf16 v[152:155], a[140:143], a[168:171], v[152:155]
 s_add_u32 m0, s49, 0
 s_mov_b32 s47, 7340032
 v_mfma_f32_16x16x32_bf16 v[156:159], a[140:143], a[172:175], v[156:159]
 v_mfma_f32_16x16x32_bf16 v[216:219], a[140:143], a[176:179], v[216:219]
 buffer_load_dwordx4 v28, s[24:27], s47 offen lds
 v_mfma_f32_16x16x32_bf16 v[220:223], a[140:143], a[180:183], v[220:223]
 v_mfma_f32_16x16x32_bf16 v[96:99], a[144:147], a[160:163], v[96:99]
 ds_read_b64_tr_b16 a[140:141], v17 offset:16384
 v_mfma_f32_16x16x32_bf16 v[100:103], a[144:147], a[164:167], v[100:103]
 ds_read_b64_tr_b16 a[142:143], v17 offset:17408
 v_mfma_f32_16x16x32_bf16 v[160:163], a[144:147], a[168:171], v[160:163]
 buffer_load_dwordx4 v29, s[24:27], s47 offen offset:1024 lds
 v_mfma_f32_16x16x32_bf16 v[164:167], a[144:147], a[172:175], v[164:167]
 v_mfma_f32_16x16x32_bf16 v[224:227], a[144:147], a[176:179], v[224:227]
 buffer_load_dwordx4 v30, s[24:27], s47 offen offset:2048 lds
 v_mfma_f32_16x16x32_bf16 v[228:231], a[144:147], a[180:183], v[228:231]
 v_mfma_f32_16x16x32_bf16 v[104:107], a[148:151], a[160:163], v[104:107]
 ds_read_b64_tr_b16 a[144:145], v18 offset:16384
 v_mfma_f32_16x16x32_bf16 v[108:111], a[148:151], a[164:167], v[108:111]
 ds_read_b64_tr_b16 a[146:147], v18 offset:17408
 v_mfma_f32_16x16x32_bf16 v[168:171], a[148:151], a[168:171], v[168:171]
 buffer_load_dwordx4 v31, s[24:27], s47 offen offset:3072 lds
 v_mfma_f32_16x16x32_bf16 v[172:175], a[148:151], a[172:175], v[172:175]
 v_mfma_f32_16x16x32_bf16 v[232:235], a[148:151], a[176:179], v[232:235]
 s_add_u32 m0, s48, 76800
 s_movk_i32 s46, 1920
 v_mfma_f32_16x16x32_bf16 v[236:239], a[148:151], a[180:183], v[236:239]
 v_mfma_f32_16x16x32_bf16 v[112:115], a[152:155], a[160:163], v[112:115]
 ds_read_b64_tr_b16 a[148:149], v19 offset:16384
 v_mfma_f32_16x16x32_bf16 v[116:119], a[152:155], a[164:167], v[116:119]
 ds_read_b64_tr_b16 a[150:151], v19 offset:17408
 v_mfma_f32_16x16x32_bf16 v[176:179], a[152:155], a[168:171], v[176:179]
 buffer_load_dwordx4 v25, s[20:23], s46 offen lds
 v_mfma_f32_16x16x32_bf16 v[180:183], a[152:155], a[172:175], v[180:183]
 v_mfma_f32_16x16x32_bf16 v[240:243], a[152:155], a[176:179], v[240:243]
 buffer_load_dwordx4 v26, s[20:23], s46 offen offset:1024 lds
 v_mfma_f32_16x16x32_bf16 v[244:247], a[152:155], a[180:183], v[244:247]
 v_mfma_f32_16x16x32_bf16 v[120:123], a[156:159], a[160:163], v[120:123]
 ds_read_b64_tr_b16 a[152:153], v20 offset:16384
 v_mfma_f32_16x16x32_bf16 v[124:127], a[156:159], a[164:167], v[124:127]
 ds_read_b64_tr_b16 a[154:155], v20 offset:17408
 v_mfma_f32_16x16x32_bf16 v[184:187], a[156:159], a[168:171], v[184:187]
 buffer_load_dwordx4 v27, s[20:23], s46 offen offset:2048 lds
 v_mfma_f32_16x16x32_bf16 v[188:191], a[156:159], a[172:175], v[188:191]
 v_mfma_f32_16x16x32_bf16 v[248:251], a[156:159], a[176:179], v[248:251]
 buffer_load_dwordx4 a[120:123], v50, s[28:31], s39 offen offset:2048 nt
 v_mfma_f32_16x16x32_bf16 v[252:255], a[156:159], a[180:183], v[252:255]
 s_waitcnt lgkmcnt(2)
 v_mfma_f32_16x16x32_bf16 v[64:67], a[128:131], a[224:227], v[64:67]
 ds_read_b64_tr_b16 a[156:157], v21 offset:16384
 v_mfma_f32_16x16x32_bf16 v[68:71], a[128:131], a[228:231], v[68:71]
 ds_read_b64_tr_b16 a[158:159], v21 offset:17408
 v_mfma_f32_16x16x32_bf16 v[128:131], a[128:131], a[232:235], v[128:131]
 v_mfma_f32_16x16x32_bf16 v[132:135], a[128:131], a[236:239], v[132:135]
 v_mfma_f32_16x16x32_bf16 v[192:195], a[128:131], a[240:243], v[192:195]
 v_mfma_f32_16x16x32_bf16 v[196:199], a[128:131], a[244:247], v[196:199]
 v_mfma_f32_16x16x32_bf16 v[72:75], a[132:135], a[224:227], v[72:75]
 v_mfma_f32_16x16x32_bf16 v[76:79], a[132:135], a[228:231], v[76:79]
 s_waitcnt vmcnt(20) lgkmcnt(0)
 s_barrier
 v_mfma_f32_16x16x32_bf16 v[136:139], a[132:135], a[232:235], v[136:139]
 ds_read_b64_tr_b16 a[128:129], v14 offset:32768
 v_mfma_f32_16x16x32_bf16 v[140:143], a[132:135], a[236:239], v[140:143]
 ds_read_b64_tr_b16 a[130:131], v14 offset:33792
 v_mfma_f32_16x16x32_bf16 v[200:203], a[132:135], a[240:243], v[200:203]
 ds_read_b128 a[160:163], v10 offset:24576
 v_mfma_f32_16x16x32_bf16 v[204:207], a[132:135], a[244:247], v[204:207]
 ds_read_b128 a[164:167], v10 offset:26624
 v_mfma_f32_16x16x32_bf16 v[80:83], a[136:139], a[224:227], v[80:83]
 ds_read_b64_tr_b16 a[132:133], v15 offset:32768
 v_mfma_f32_16x16x32_bf16 v[84:87], a[136:139], a[228:231], v[84:87]
 ds_read_b64_tr_b16 a[134:135], v15 offset:33792
 v_mfma_f32_16x16x32_bf16 v[144:147], a[136:139], a[232:235], v[144:147]
 ds_read_b128 a[168:171], v10 offset:28672
 v_mfma_f32_16x16x32_bf16 v[148:151], a[136:139], a[236:239], v[148:151]
 ds_read_b128 a[172:175], v10 offset:30720
 v_mfma_f32_16x16x32_bf16 v[208:211], a[136:139], a[240:243], v[208:211]
 ds_read_b128 a[176:179], v10 offset:32768
 v_mfma_f32_16x16x32_bf16 v[212:215], a[136:139], a[244:247], v[212:215]
 ds_read_b128 a[180:183], v10 offset:34816
 v_mfma_f32_16x16x32_bf16 v[88:91], a[140:143], a[224:227], v[88:91]
 ds_read_b64_tr_b16 a[136:137], v16 offset:32768
 v_mfma_f32_16x16x32_bf16 v[92:95], a[140:143], a[228:231], v[92:95]
 ds_read_b64_tr_b16 a[138:139], v16 offset:33792
 v_mfma_f32_16x16x32_bf16 v[152:155], a[140:143], a[232:235], v[152:155]
 s_add_u32 m0, s49, 16384
 s_mov_b32 s47, 7602176
 v_mfma_f32_16x16x32_bf16 v[156:159], a[140:143], a[236:239], v[156:159]
 v_mfma_f32_16x16x32_bf16 v[216:219], a[140:143], a[240:243], v[216:219]
 v_mfma_f32_16x16x32_bf16 v[220:223], a[140:143], a[244:247], v[220:223]
 buffer_load_dwordx4 v28, s[24:27], s47 offen lds
 v_mfma_f32_16x16x32_bf16 v[96:99], a[144:147], a[224:227], v[96:99]
 ds_read_b64_tr_b16 a[140:141], v17 offset:32768
 v_mfma_f32_16x16x32_bf16 v[100:103], a[144:147], a[228:231], v[100:103]
 ds_read_b64_tr_b16 a[142:143], v17 offset:33792
 v_mfma_f32_16x16x32_bf16 v[160:163], a[144:147], a[232:235], v[160:163]
 v_mfma_f32_16x16x32_bf16 v[164:167], a[144:147], a[236:239], v[164:167]
 v_mfma_f32_16x16x32_bf16 v[224:227], a[144:147], a[240:243], v[224:227]
 buffer_load_dwordx4 v29, s[24:27], s47 offen offset:1024 lds
 v_mfma_f32_16x16x32_bf16 v[228:231], a[144:147], a[244:247], v[228:231]
 v_mfma_f32_16x16x32_bf16 v[104:107], a[148:151], a[224:227], v[104:107]
 ds_read_b64_tr_b16 a[144:145], v18 offset:32768
 v_mfma_f32_16x16x32_bf16 v[108:111], a[148:151], a[228:231], v[108:111]
 ds_read_b64_tr_b16 a[146:147], v18 offset:33792
 v_mfma_f32_16x16x32_bf16 v[168:171], a[148:151], a[232:235], v[168:171]
 v_mfma_f32_16x16x32_bf16 v[172:175], a[148:151], a[236:239], v[172:175]
 v_mfma_f32_16x16x32_bf16 v[232:235], a[148:151], a[240:243], v[232:235]
 buffer_load_dwordx4 v30, s[24:27], s47 offen offset:2048 lds
 v_mfma_f32_16x16x32_bf16 v[236:239], a[148:151], a[244:247], v[236:239]
 v_mfma_f32_16x16x32_bf16 v[112:115], a[152:155], a[224:227], v[112:115]
 ds_read_b64_tr_b16 a[148:149], v19 offset:32768
 v_mfma_f32_16x16x32_bf16 v[116:119], a[152:155], a[228:231], v[116:119]
 ds_read_b64_tr_b16 a[150:151], v19 offset:33792
 v_mfma_f32_16x16x32_bf16 v[176:179], a[152:155], a[232:235], v[176:179]
 v_mfma_f32_16x16x32_bf16 v[180:183], a[152:155], a[236:239], v[180:183]
 buffer_load_dwordx4 v31, s[24:27], s47 offen offset:3072 lds
 v_mfma_f32_16x16x32_bf16 v[240:243], a[152:155], a[240:243], v[240:243]
 v_mfma_f32_16x16x32_bf16 v[244:247], a[152:155], a[244:247], v[244:247]
 v_mfma_f32_16x16x32_bf16 v[120:123], a[156:159], a[224:227], v[120:123]
 ds_read_b64_tr_b16 a[152:153], v20 offset:32768
 v_mfma_f32_16x16x32_bf16 v[124:127], a[156:159], a[228:231], v[124:127]
 ds_read_b64_tr_b16 a[154:155], v20 offset:33792
 v_mfma_f32_16x16x32_bf16 v[184:187], a[156:159], a[232:235], v[184:187]
 buffer_load_dwordx4 a[124:127], v51, s[28:31], s39 offen offset:3072 nt
 v_mfma_f32_16x16x32_bf16 v[188:191], a[156:159], a[236:239], v[188:191]
 v_mfma_f32_16x16x32_bf16 v[248:251], a[156:159], a[240:243], v[248:251]
 v_mfma_f32_16x16x32_bf16 v[252:255], a[156:159], a[244:247], v[252:255]
 s_waitcnt lgkmcnt(2)
 v_mfma_f32_16x16x32_bf16 v[64:67], a[128:131], a[160:163], v[64:67]
 ds_read_b64_tr_b16 a[156:157], v21 offset:32768
 v_mfma_f32_16x16x32_bf16 v[68:71], a[128:131], a[164:167], v[68:71]
 ds_read_b64_tr_b16 a[158:159], v21 offset:33792
 v_mfma_f32_16x16x32_bf16 v[128:131], a[128:131], a[168:171], v[128:131]
 v_mfma_f32_16x16x32_bf16 v[132:135], a[128:131], a[172:175], v[132:135]
 v_mfma_f32_16x16x32_bf16 v[192:195], a[128:131], a[176:179], v[192:195]
 v_mfma_f32_16x16x32_bf16 v[196:199], a[128:131], a[180:183], v[196:199]
 v_mfma_f32_16x16x32_bf16 v[72:75], a[132:135], a[160:163], v[72:75]
 v_mfma_f32_16x16x32_bf16 v[76:79], a[132:135], a[164:167], v[76:79]
 s_waitcnt vmcnt(17) lgkmcnt(0)
 s_barrier
 v_mfma_f32_16x16x32_bf16 v[136:139], a[132:135], a[168:171], v[136:139]
 ds_read_b64_tr_b16 a[128:129], v14 offset:49152
 v_mfma_f32_16x16x32_bf16 v[140:143], a[132:135], a[172:175], v[140:143]
 ds_read_b64_tr_b16 a[130:131], v14 offset:50176
 v_mfma_f32_16x16x32_bf16 v[200:203], a[132:135], a[176:179], v[200:203]
 ds_read_b128 a[224:227], v11 offset:24576
 v_mfma_f32_16x16x32_bf16 v[204:207], a[132:135], a[180:183], v[204:207]
 ds_read_b128 a[228:231], v11 offset:26624
 v_mfma_f32_16x16x32_bf16 v[80:83], a[136:139], a[160:163], v[80:83]
 ds_read_b64_tr_b16 a[132:133], v15 offset:49152
 v_mfma_f32_16x16x32_bf16 v[84:87], a[136:139], a[164:167], v[84:87]
 ds_read_b64_tr_b16 a[134:135], v15 offset:50176
 v_mfma_f32_16x16x32_bf16 v[144:147], a[136:139], a[168:171], v[144:147]
 ds_read_b128 a[232:235], v11 offset:28672
 v_mfma_f32_16x16x32_bf16 v[148:151], a[136:139], a[172:175], v[148:151]
 ds_read_b128 a[236:239], v11 offset:30720
 v_mfma_f32_16x16x32_bf16 v[208:211], a[136:139], a[176:179], v[208:211]
 ds_read_b128 a[240:243], v11 offset:32768
 v_mfma_f32_16x16x32_bf16 v[212:215], a[136:139], a[180:183], v[212:215]
 ds_read_b128 a[244:247], v11 offset:34816
 v_mfma_f32_16x16x32_bf16 v[88:91], a[140:143], a[160:163], v[88:91]
 ds_read_b64_tr_b16 a[136:137], v16 offset:49152
 v_mfma_f32_16x16x32_bf16 v[92:95], a[140:143], a[164:167], v[92:95]
 ds_read_b64_tr_b16 a[138:139], v16 offset:50176
 v_mfma_f32_16x16x32_bf16 v[152:155], a[140:143], a[168:171], v[152:155]
 s_add_u32 m0, s49, 32768
 s_mov_b32 s47, 7864320
 v_mfma_f32_16x16x32_bf16 v[156:159], a[140:143], a[172:175], v[156:159]
 v_mfma_f32_16x16x32_bf16 v[216:219], a[140:143], a[176:179], v[216:219]
 v_mfma_f32_16x16x32_bf16 v[220:223], a[140:143], a[180:183], v[220:223]
 v_mfma_f32_16x16x32_bf16 v[96:99], a[144:147], a[160:163], v[96:99]
 ds_read_b64_tr_b16 a[140:141], v17 offset:49152
 v_mfma_f32_16x16x32_bf16 v[100:103], a[144:147], a[164:167], v[100:103]
 ds_read_b64_tr_b16 a[142:143], v17 offset:50176
 v_mfma_f32_16x16x32_bf16 v[160:163], a[144:147], a[168:171], v[160:163]
 buffer_load_dwordx4 v28, s[24:27], s47 offen lds
 v_mfma_f32_16x16x32_bf16 v[164:167], a[144:147], a[172:175], v[164:167]
 v_mfma_f32_16x16x32_bf16 v[224:227], a[144:147], a[176:179], v[224:227]
 v_mfma_f32_16x16x32_bf16 v[228:231], a[144:147], a[180:183], v[228:231]
 v_mfma_f32_16x16x32_bf16 v[104:107], a[148:151], a[160:163], v[104:107]
 ds_read_b64_tr_b16 a[144:145], v18 offset:49152
 v_mfma_f32_16x16x32_bf16 v[108:111], a[148:151], a[164:167], v[108:111]
 ds_read_b64_tr_b16 a[146:147], v18 offset:50176
 v_mfma_f32_16x16x32_bf16 v[168:171], a[148:151], a[168:171], v[168:171]
 buffer_load_dwordx4 v29, s[24:27], s47 offen offset:1024 lds
 v_mfma_f32_16x16x32_bf16 v[172:175], a[148:151], a[172:175], v[172:175]
 v_mfma_f32_16x16x32_bf16 v[232:235], a[148:151], a[176:179], v[232:235]
 v_mfma_f32_16x16x32_bf16 v[236:239], a[148:151], a[180:183], v[236:239]
 v_mfma_f32_16x16x32_bf16 v[112:115], a[152:155], a[160:163], v[112:115]
 ds_read_b64_tr_b16 a[148:149], v19 offset:49152
 v_mfma_f32_16x16x32_bf16 v[116:119], a[152:155], a[164:167], v[116:119]
 ds_read_b64_tr_b16 a[150:151], v19 offset:50176
 v_mfma_f32_16x16x32_bf16 v[176:179], a[152:155], a[168:171], v[176:179]
 buffer_load_dwordx4 v30, s[24:27], s47 offen offset:2048 lds
 v_mfma_f32_16x16x32_bf16 v[180:183], a[152:155], a[172:175], v[180:183]
 v_mfma_f32_16x16x32_bf16 v[240:243], a[152:155], a[176:179], v[240:243]
 v_mfma_f32_16x16x32_bf16 v[244:247], a[152:155], a[180:183], v[244:247]
 v_mfma_f32_16x16x32_bf16 v[120:123], a[156:159], a[160:163], v[120:123]
 ds_read_b64_tr_b16 a[152:153], v20 offset:49152
 v_mfma_f32_16x16x32_bf16 v[124:127], a[156:159], a[164:167], v[124:127]
 ds_read_b64_tr_b16 a[154:155], v20 offset:50176
 v_mfma_f32_16x16x32_bf16 v[184:187], a[156:159], a[168:171], v[184:187]
 buffer_load_dwordx4 v31, s[24:27], s47 offen offset:3072 lds
 v_mfma_f32_16x16x32_bf16 v[188:191], a[156:159], a[172:175], v[188:191]
 v_mfma_f32_16x16x32_bf16 v[248:251], a[156:159], a[176:179], v[248:251]
 v_mfma_f32_16x16x32_bf16 v[252:255], a[156:159], a[180:183], v[252:255]
 s_waitcnt lgkmcnt(2)
 v_mfma_f32_16x16x32_bf16 v[64:67], a[128:131], a[224:227], v[64:67]
 ds_read_b64_tr_b16 a[156:157], v21 offset:49152
 v_mfma_f32_16x16x32_bf16 v[68:71], a[128:131], a[228:231], v[68:71]
 ds_read_b64_tr_b16 a[158:159], v21 offset:50176
 v_mfma_f32_16x16x32_bf16 v[128:131], a[128:131], a[232:235], v[128:131]
 v_mfma_f32_16x16x32_bf16 v[132:135], a[128:131], a[236:239], v[132:135]
 v_mfma_f32_16x16x32_bf16 v[192:195], a[128:131], a[240:243], v[192:195]
 v_mfma_f32_16x16x32_bf16 v[196:199], a[128:131], a[244:247], v[196:199]
 v_mfma_f32_16x16x32_bf16 v[72:75], a[132:135], a[224:227], v[72:75]
 v_mfma_f32_16x16x32_bf16 v[76:79], a[132:135], a[228:231], v[76:79]
 s_waitcnt vmcnt(13) lgkmcnt(0)
 s_barrier
 v_mfma_f32_16x16x32_bf16 v[136:139], a[132:135], a[232:235], v[136:139]
 ds_read_b64_tr_b16 a[128:129], v14
 v_mfma_f32_16x16x32_bf16 v[140:143], a[132:135], a[236:239], v[140:143]
 ds_read_b64_tr_b16 a[130:131], v14 offset:1024
 v_mfma_f32_16x16x32_bf16 v[200:203], a[132:135], a[240:243], v[200:203]
 ds_read_b128 a[160:163], v12
 v_mfma_f32_16x16x32_bf16 v[204:207], a[132:135], a[244:247], v[204:207]
 ds_read_b128 a[164:167], v12 offset:2048
 v_mfma_f32_16x16x32_bf16 v[80:83], a[136:139], a[224:227], v[80:83]
 ds_read_b64_tr_b16 a[132:133], v15
 v_mfma_f32_16x16x32_bf16 v[84:87], a[136:139], a[228:231], v[84:87]
 ds_read_b64_tr_b16 a[134:135], v15 offset:1024
 v_mfma_f32_16x16x32_bf16 v[144:147], a[136:139], a[232:235], v[144:147]
 ds_read_b128 a[168:171], v12 offset:4096
 v_mfma_f32_16x16x32_bf16 v[148:151], a[136:139], a[236:239], v[148:151]
 ds_read_b128 a[172:175], v12 offset:6144
 v_mfma_f32_16x16x32_bf16 v[208:211], a[136:139], a[240:243], v[208:211]
 ds_read_b128 a[176:179], v12 offset:8192
 v_mfma_f32_16x16x32_bf16 v[212:215], a[136:139], a[244:247], v[212:215]
 ds_read_b128 a[180:183], v12 offset:10240
 v_mfma_f32_16x16x32_bf16 v[88:91], a[140:143], a[224:227], v[88:91]
 ds_read_b64_tr_b16 a[136:137], v16
 v_mfma_f32_16x16x32_bf16 v[92:95], a[140:143], a[228:231], v[92:95]
 ds_read_b64_tr_b16 a[138:139], v16 offset:1024
 v_mfma_f32_16x16x32_bf16 v[152:155], a[140:143], a[232:235], v[152:155]
 s_add_u32 m0, s49, 49152
 s_mov_b32 s47, 8126464
 v_mfma_f32_16x16x32_bf16 v[156:159], a[140:143], a[236:239], v[156:159]
 v_mfma_f32_16x16x32_bf16 v[216:219], a[140:143], a[240:243], v[216:219]
 v_mfma_f32_16x16x32_bf16 v[220:223], a[140:143], a[244:247], v[220:223]
 v_mfma_f32_16x16x32_bf16 v[96:99], a[144:147], a[224:227], v[96:99]
 ds_read_b64_tr_b16 a[140:141], v17
 v_mfma_f32_16x16x32_bf16 v[100:103], a[144:147], a[228:231], v[100:103]
 ds_read_b64_tr_b16 a[142:143], v17 offset:1024
 v_mfma_f32_16x16x32_bf16 v[160:163], a[144:147], a[232:235], v[160:163]
 buffer_load_dwordx4 v28, s[24:27], s47 offen lds
 v_mfma_f32_16x16x32_bf16 v[164:167], a[144:147], a[236:239], v[164:167]
 v_mfma_f32_16x16x32_bf16 v[224:227], a[144:147], a[240:243], v[224:227]
 v_mfma_f32_16x16x32_bf16 v[228:231], a[144:147], a[244:247], v[228:231]
 v_mfma_f32_16x16x32_bf16 v[104:107], a[148:151], a[224:227], v[104:107]
 ds_read_b64_tr_b16 a[144:145], v18
 v_mfma_f32_16x16x32_bf16 v[108:111], a[148:151], a[228:231], v[108:111]
 ds_read_b64_tr_b16 a[146:147], v18 offset:1024
 v_mfma_f32_16x16x32_bf16 v[168:171], a[148:151], a[232:235], v[168:171]
 buffer_load_dwordx4 v29, s[24:27], s47 offen offset:1024 lds
 v_mfma_f32_16x16x32_bf16 v[172:175], a[148:151], a[236:239], v[172:175]
 v_mfma_f32_16x16x32_bf16 v[232:235], a[148:151], a[240:243], v[232:235]
 v_mfma_f32_16x16x32_bf16 v[236:239], a[148:151], a[244:247], v[236:239]
 v_mfma_f32_16x16x32_bf16 v[112:115], a[152:155], a[224:227], v[112:115]
 ds_read_b64_tr_b16 a[148:149], v19
 v_mfma_f32_16x16x32_bf16 v[116:119], a[152:155], a[228:231], v[116:119]
 ds_read_b64_tr_b16 a[150:151], v19 offset:1024
 v_mfma_f32_16x16x32_bf16 v[176:179], a[152:155], a[232:235], v[176:179]
 buffer_load_dwordx4 v30, s[24:27], s47 offen offset:2048 lds
 v_mfma_f32_16x16x32_bf16 v[180:183], a[152:155], a[236:239], v[180:183]
 v_mfma_f32_16x16x32_bf16 v[240:243], a[152:155], a[240:243], v[240:243]
 v_mfma_f32_16x16x32_bf16 v[244:247], a[152:155], a[244:247], v[244:247]
 v_mfma_f32_16x16x32_bf16 v[120:123], a[156:159], a[224:227], v[120:123]
 ds_read_b64_tr_b16 a[152:153], v20
 v_mfma_f32_16x16x32_bf16 v[124:127], a[156:159], a[228:231], v[124:127]
 ds_read_b64_tr_b16 a[154:155], v20 offset:1024
 v_mfma_f32_16x16x32_bf16 v[184:187], a[156:159], a[232:235], v[184:187]
 buffer_load_dwordx4 v31, s[24:27], s47 offen offset:3072 lds
 v_mfma_f32_16x16x32_bf16 v[188:191], a[156:159], a[236:239], v[188:191]
 v_mfma_f32_16x16x32_bf16 v[248:251], a[156:159], a[240:243], v[248:251]
 v_mfma_f32_16x16x32_bf16 v[252:255], a[156:159], a[244:247], v[252:255]
 s_waitcnt lgkmcnt(2)
 v_mfma_f32_16x16x32_bf16 v[64:67], a[128:131], a[160:163], v[64:67]
 ds_read_b64_tr_b16 a[156:157], v21
 v_mfma_f32_16x16x32_bf16 v[68:71], a[128:131], a[164:167], v[68:71]
 ds_read_b64_tr_b16 a[158:159], v21 offset:1024
 v_mfma_f32_16x16x32_bf16 v[128:131], a[128:131], a[168:171], v[128:131]
 v_mfma_f32_16x16x32_bf16 v[132:135], a[128:131], a[172:175], v[132:135]
 v_mfma_f32_16x16x32_bf16 v[192:195], a[128:131], a[176:179], v[192:195]
 v_mfma_f32_16x16x32_bf16 v[196:199], a[128:131], a[180:183], v[196:199]
 v_mfma_f32_16x16x32_bf16 v[72:75], a[132:135], a[160:163], v[72:75]
 v_mfma_f32_16x16x32_bf16 v[76:79], a[132:135], a[164:167], v[76:79]
 s_waitcnt vmcnt(9) lgkmcnt(0)
 s_barrier
 v_mfma_f32_16x16x32_bf16 v[136:139], a[132:135], a[168:171], v[136:139]
 ds_read_b64_tr_b16 a[128:129], v14 offset:16384
 v_mfma_f32_16x16x32_bf16 v[140:143], a[132:135], a[172:175], v[140:143]
 ds_read_b64_tr_b16 a[130:131], v14 offset:17408
 v_mfma_f32_16x16x32_bf16 v[200:203], a[132:135], a[176:179], v[200:203]
 ds_read_b128 a[224:227], v13
 v_mfma_f32_16x16x32_bf16 v[204:207], a[132:135], a[180:183], v[204:207]
 ds_read_b128 a[228:231], v13 offset:2048
 v_mfma_f32_16x16x32_bf16 v[80:83], a[136:139], a[160:163], v[80:83]
 ds_read_b64_tr_b16 a[132:133], v15 offset:16384
 v_mfma_f32_16x16x32_bf16 v[84:87], a[136:139], a[164:167], v[84:87]
 ds_read_b64_tr_b16 a[134:135], v15 offset:17408
 v_mfma_f32_16x16x32_bf16 v[144:147], a[136:139], a[168:171], v[144:147]
 ds_read_b128 a[232:235], v13 offset:4096
 v_mfma_f32_16x16x32_bf16 v[148:151], a[136:139], a[172:175], v[148:151]
 ds_read_b128 a[236:239], v13 offset:6144
 v_mfma_f32_16x16x32_bf16 v[208:211], a[136:139], a[176:179], v[208:211]
 ds_read_b128 a[240:243], v13 offset:8192
 v_mfma_f32_16x16x32_bf16 v[212:215], a[136:139], a[180:183], v[212:215]
 ds_read_b128 a[244:247], v13 offset:10240
 v_mfma_f32_16x16x32_bf16 v[88:91], a[140:143], a[160:163], v[88:91]
 ds_read_b64_tr_b16 a[136:137], v16 offset:16384
 v_mfma_f32_16x16x32_bf16 v[92:95], a[140:143], a[164:167], v[92:95]
 ds_read_b64_tr_b16 a[138:139], v16 offset:17408
 v_mfma_f32_16x16x32_bf16 v[152:155], a[140:143], a[168:171], v[152:155]
 ds_write_b128 v58, a[0:3]
 v_mfma_f32_16x16x32_bf16 v[156:159], a[140:143], a[172:175], v[156:159]
 v_mfma_f32_16x16x32_bf16 v[216:219], a[140:143], a[176:179], v[216:219]
 ds_write_b128 v58, a[4:7] offset:1024
 v_mfma_f32_16x16x32_bf16 v[220:223], a[140:143], a[180:183], v[220:223]
 v_mfma_f32_16x16x32_bf16 v[96:99], a[144:147], a[160:163], v[96:99]
 ds_read_b64_tr_b16 a[140:141], v17 offset:16384
 v_mfma_f32_16x16x32_bf16 v[100:103], a[144:147], a[164:167], v[100:103]
 ds_read_b64_tr_b16 a[142:143], v17 offset:17408
 v_mfma_f32_16x16x32_bf16 v[160:163], a[144:147], a[168:171], v[160:163]
 v_mfma_f32_16x16x32_bf16 v[164:167], a[144:147], a[172:175], v[164:167]
 ds_write_b128 v58, a[8:11] offset:2048
 v_mfma_f32_16x16x32_bf16 v[224:227], a[144:147], a[176:179], v[224:227]
 v_mfma_f32_16x16x32_bf16 v[228:231], a[144:147], a[180:183], v[228:231]
 ds_write_b128 v58, a[12:15] offset:3072
 v_mfma_f32_16x16x32_bf16 v[104:107], a[148:151], a[160:163], v[104:107]
 ds_read_b64_tr_b16 a[144:145], v18 offset:16384
 v_mfma_f32_16x16x32_bf16 v[108:111], a[148:151], a[164:167], v[108:111]
 ds_read_b64_tr_b16 a[146:147], v18 offset:17408
 v_mfma_f32_16x16x32_bf16 v[168:171], a[148:151], a[168:171], v[168:171]
 v_mfma_f32_16x16x32_bf16 v[172:175], a[148:151], a[172:175], v[172:175]
 v_mfma_f32_16x16x32_bf16 v[232:235], a[148:151], a[176:179], v[232:235]
 ds_write_b128 v58, a[16:19] offset:4096
 v_mfma_f32_16x16x32_bf16 v[236:239], a[148:151], a[180:183], v[236:239]
 v_mfma_f32_16x16x32_bf16 v[112:115], a[152:155], a[160:163], v[112:115]
 ds_read_b64_tr_b16 a[148:149], v19 offset:16384
 v_mfma_f32_16x16x32_bf16 v[116:119], a[152:155], a[164:167], v[116:119]
 ds_read_b64_tr_b16 a[150:151], v19 offset:17408
 v_mfma_f32_16x16x32_bf16 v[176:179], a[152:155], a[168:171], v[176:179]
 ds_write_b128 v58, a[20:23] offset:5120
 v_mfma_f32_16x16x32_bf16 v[180:183], a[152:155], a[172:175], v[180:183]
 v_mfma_f32_16x16x32_bf16 v[240:243], a[152:155], a[176:179], v[240:243]
 v_mfma_f32_16x16x32_bf16 v[244:247], a[152:155], a[180:183], v[244:247]
 ds_write_b128 v58, a[24:27] offset:6144
 v_mfma_f32_16x16x32_bf16 v[120:123], a[156:159], a[160:163], v[120:123]
 ds_read_b64_tr_b16 a[152:153], v20 offset:16384
 v_mfma_f32_16x16x32_bf16 v[124:127], a[156:159], a[164:167], v[124:127]
 ds_read_b64_tr_b16 a[154:155], v20 offset:17408
 v_mfma_f32_16x16x32_bf16 v[184:187], a[156:159], a[168:171], v[184:187]
 v_mfma_f32_16x16x32_bf16 v[188:191], a[156:159], a[172:175], v[188:191]
 ds_write_b128 v58, a[28:31] offset:7168
 v_mfma_f32_16x16x32_bf16 v[248:251], a[156:159], a[176:179], v[248:251]
 v_mfma_f32_16x16x32_bf16 v[252:255], a[156:159], a[180:183], v[252:255]
 s_waitcnt lgkmcnt(2)
 v_mfma_f32_16x16x32_bf16 v[64:67], a[128:131], a[224:227], v[64:67]
 ds_read_b64_tr_b16 a[156:157], v21 offset:16384
 v_mfma_f32_16x16x32_bf16 v[68:71], a[128:131], a[228:231], v[68:71]
 ds_read_b64_tr_b16 a[158:159], v21 offset:17408
 v_mfma_f32_16x16x32_bf16 v[128:131], a[128:131], a[232:235], v[128:131]
 v_mfma_f32_16x16x32_bf16 v[132:135], a[128:131], a[236:239], v[132:135]
 v_mfma_f32_16x16x32_bf16 v[192:195], a[128:131], a[240:243], v[192:195]
 v_mfma_f32_16x16x32_bf16 v[196:199], a[128:131], a[244:247], v[196:199]
 v_mfma_f32_16x16x32_bf16 v[72:75], a[132:135], a[224:227], v[72:75]
 v_mfma_f32_16x16x32_bf16 v[76:79], a[132:135], a[228:231], v[76:79]
 s_waitcnt vmcnt(4) lgkmcnt(0)
 s_barrier
 v_mfma_f32_16x16x32_bf16 v[136:139], a[132:135], a[232:235], v[136:139]
 ds_read_b64_tr_b16 a[128:129], v14 offset:32768
 v_mfma_f32_16x16x32_bf16 v[140:143], a[132:135], a[236:239], v[140:143]
 ds_read_b64_tr_b16 a[130:131], v14 offset:33792
 v_mfma_f32_16x16x32_bf16 v[200:203], a[132:135], a[240:243], v[200:203]
 ds_read_b128 a[160:163], v12 offset:24576
 v_mfma_f32_16x16x32_bf16 v[204:207], a[132:135], a[244:247], v[204:207]
 ds_read_b128 a[164:167], v12 offset:26624
 v_mfma_f32_16x16x32_bf16 v[80:83], a[136:139], a[224:227], v[80:83]
 ds_read_b64_tr_b16 a[132:133], v15 offset:32768
 v_mfma_f32_16x16x32_bf16 v[84:87], a[136:139], a[228:231], v[84:87]
 ds_read_b64_tr_b16 a[134:135], v15 offset:33792
 v_mfma_f32_16x16x32_bf16 v[144:147], a[136:139], a[232:235], v[144:147]
 ds_read_b128 a[168:171], v12 offset:28672
 v_mfma_f32_16x16x32_bf16 v[148:151], a[136:139], a[236:239], v[148:151]
 ds_read_b128 a[172:175], v12 offset:30720
 v_mfma_f32_16x16x32_bf16 v[208:211], a[136:139], a[240:243], v[208:211]
 ds_read_b128 a[176:179], v12 offset:32768
 v_mfma_f32_16x16x32_bf16 v[212:215], a[136:139], a[244:247], v[212:215]
 ds_read_b128 a[180:183], v12 offset:34816
 v_mfma_f32_16x16x32_bf16 v[88:91], a[140:143], a[224:227], v[88:91]
 ds_read_b64_tr_b16 a[136:137], v16 offset:32768
 v_mfma_f32_16x16x32_bf16 v[92:95], a[140:143], a[228:231], v[92:95]
 ds_read_b64_tr_b16 a[138:139], v16 offset:33792
 v_mfma_f32_16x16x32_bf16 v[152:155], a[140:143], a[232:235], v[152:155]
 ds_write_b128 v58, a[32:35] offset:16384
 v_mfma_f32_16x16x32_bf16 v[156:159], a[140:143], a[236:239], v[156:159]
 v_mfma_f32_16x16x32_bf16 v[216:219], a[140:143], a[240:243], v[216:219]
 ds_write_b128 v58, a[36:39] offset:17408
 v_mfma_f32_16x16x32_bf16 v[220:223], a[140:143], a[244:247], v[220:223]
 v_mfma_f32_16x16x32_bf16 v[96:99], a[144:147], a[224:227], v[96:99]
 ds_read_b64_tr_b16 a[140:141], v17 offset:32768
 v_mfma_f32_16x16x32_bf16 v[100:103], a[144:147], a[228:231], v[100:103]
 ds_read_b64_tr_b16 a[142:143], v17 offset:33792
 v_mfma_f32_16x16x32_bf16 v[160:163], a[144:147], a[232:235], v[160:163]
 v_mfma_f32_16x16x32_bf16 v[164:167], a[144:147], a[236:239], v[164:167]
 ds_write_b128 v58, a[40:43] offset:18432
 v_mfma_f32_16x16x32_bf16 v[224:227], a[144:147], a[240:243], v[224:227]
 v_mfma_f32_16x16x32_bf16 v[228:231], a[144:147], a[244:247], v[228:231]
 ds_write_b128 v58, a[44:47] offset:19456
 v_mfma_f32_16x16x32_bf16 v[104:107], a[148:151], a[224:227], v[104:107]
 ds_read_b64_tr_b16 a[144:145], v18 offset:32768
 v_mfma_f32_16x16x32_bf16 v[108:111], a[148:151], a[228:231], v[108:111]
 ds_read_b64_tr_b16 a[146:147], v18 offset:33792
 v_mfma_f32_16x16x32_bf16 v[168:171], a[148:151], a[232:235], v[168:171]
 v_mfma_f32_16x16x32_bf16 v[172:175], a[148:151], a[236:239], v[172:175]
 v_mfma_f32_16x16x32_bf16 v[232:235], a[148:151], a[240:243], v[232:235]
 ds_write_b128 v58, a[48:51] offset:20480
 v_mfma_f32_16x16x32_bf16 v[236:239], a[148:151], a[244:247], v[236:239]
 v_mfma_f32_16x16x32_bf16 v[112:115], a[152:155], a[224:227], v[112:115]
 ds_read_b64_tr_b16 a[148:149], v19 offset:32768
 v_mfma_f32_16x16x32_bf16 v[116:119], a[152:155], a[228:231], v[116:119]
 ds_read_b64_tr_b16 a[150:151], v19 offset:33792
 v_mfma_f32_16x16x32_bf16 v[176:179], a[152:155], a[232:235], v[176:179]
 ds_write_b128 v58, a[52:55] offset:21504
 v_mfma_f32_16x16x32_bf16 v[180:183], a[152:155], a[236:239], v[180:183]
 v_mfma_f32_16x16x32_bf16 v[240:243], a[152:155], a[240:243], v[240:243]
 v_mfma_f32_16x16x32_bf16 v[244:247], a[152:155], a[244:247], v[244:247]
 ds_write_b128 v58, a[56:59] offset:22528
 v_mfma_f32_16x16x32_bf16 v[120:123], a[156:159], a[224:227], v[120:123]
 ds_read_b64_tr_b16 a[152:153], v20 offset:32768
 v_mfma_f32_16x16x32_bf16 v[124:127], a[156:159], a[228:231], v[124:127]
 ds_read_b64_tr_b16 a[154:155], v20 offset:33792
 v_mfma_f32_16x16x32_bf16 v[184:187], a[156:159], a[232:235], v[184:187]
 v_mfma_f32_16x16x32_bf16 v[188:191], a[156:159], a[236:239], v[188:191]
 ds_write_b128 v58, a[60:63] offset:23552
 v_mfma_f32_16x16x32_bf16 v[248:251], a[156:159], a[240:243], v[248:251]
 v_mfma_f32_16x16x32_bf16 v[252:255], a[156:159], a[244:247], v[252:255]
 s_waitcnt lgkmcnt(2)
 v_mfma_f32_16x16x32_bf16 v[64:67], a[128:131], a[160:163], v[64:67]
 ds_read_b64_tr_b16 a[156:157], v21 offset:32768
 v_mfma_f32_16x16x32_bf16 v[68:71], a[128:131], a[164:167], v[68:71]
 ds_read_b64_tr_b16 a[158:159], v21 offset:33792
 v_mfma_f32_16x16x32_bf16 v[128:131], a[128:131], a[168:171], v[128:131]
 v_mfma_f32_16x16x32_bf16 v[132:135], a[128:131], a[172:175], v[132:135]
 v_mfma_f32_16x16x32_bf16 v[192:195], a[128:131], a[176:179], v[192:195]
 v_mfma_f32_16x16x32_bf16 v[196:199], a[128:131], a[180:183], v[196:199]
 v_mfma_f32_16x16x32_bf16 v[72:75], a[132:135], a[160:163], v[72:75]
 v_mfma_f32_16x16x32_bf16 v[76:79], a[132:135], a[164:167], v[76:79]
 s_waitcnt vmcnt(0) lgkmcnt(0)
 s_barrier
 v_mfma_f32_16x16x32_bf16 v[136:139], a[132:135], a[168:171], v[136:139]
 ds_read_b64_tr_b16 a[128:129], v14 offset:49152
 v_mfma_f32_16x16x32_bf16 v[140:143], a[132:135], a[172:175], v[140:143]
 ds_read_b64_tr_b16 a[130:131], v14 offset:50176
 v_mfma_f32_16x16x32_bf16 v[200:203], a[132:135], a[176:179], v[200:203]
 ds_read_b128 a[224:227], v13 offset:24576
 v_mfma_f32_16x16x32_bf16 v[204:207], a[132:135], a[180:183], v[204:207]
 ds_read_b128 a[228:231], v13 offset:26624
 v_mfma_f32_16x16x32_bf16 v[80:83], a[136:139], a[160:163], v[80:83]
 ds_read_b64_tr_b16 a[132:133], v15 offset:49152
 v_mfma_f32_16x16x32_bf16 v[84:87], a[136:139], a[164:167], v[84:87]
 ds_read_b64_tr_b16 a[134:135], v15 offset:50176
 v_mfma_f32_16x16x32_bf16 v[144:147], a[136:139], a[168:171], v[144:147]
 ds_read_b128 a[232:235], v13 offset:28672
 v_mfma_f32_16x16x32_bf16 v[148:151], a[136:139], a[172:175], v[148:151]
 ds_read_b128 a[236:239], v13 offset:30720
 v_mfma_f32_16x16x32_bf16 v[208:211], a[136:139], a[176:179], v[208:211]
 ds_read_b128 a[240:243], v13 offset:32768
 v_mfma_f32_16x16x32_bf16 v[212:215], a[136:139], a[180:183], v[212:215]
 ds_read_b128 a[244:247], v13 offset:34816
 v_mfma_f32_16x16x32_bf16 v[88:91], a[140:143], a[160:163], v[88:91]
 ds_read_b64_tr_b16 a[136:137], v16 offset:49152
 v_mfma_f32_16x16x32_bf16 v[92:95], a[140:143], a[164:167], v[92:95]
 ds_read_b64_tr_b16 a[138:139], v16 offset:50176
 v_mfma_f32_16x16x32_bf16 v[152:155], a[140:143], a[168:171], v[152:155]
 ds_write_b128 v58, a[64:67] offset:32768
 v_mfma_f32_16x16x32_bf16 v[156:159], a[140:143], a[172:175], v[156:159]
 ds_write_b128 v58, a[68:71] offset:33792
 v_mfma_f32_16x16x32_bf16 v[216:219], a[140:143], a[176:179], v[216:219]
 ds_write_b128 v58, a[72:75] offset:34816
 v_mfma_f32_16x16x32_bf16 v[220:223], a[140:143], a[180:183], v[220:223]
 ds_write_b128 v58, a[76:79] offset:35840
 v_mfma_f32_16x16x32_bf16 v[96:99], a[144:147], a[160:163], v[96:99]
 ds_read_b64_tr_b16 a[140:141], v17 offset:49152
 v_mfma_f32_16x16x32_bf16 v[100:103], a[144:147], a[164:167], v[100:103]
 ds_read_b64_tr_b16 a[142:143], v17 offset:50176
 v_mfma_f32_16x16x32_bf16 v[160:163], a[144:147], a[168:171], v[160:163]
 v_mfma_f32_16x16x32_bf16 v[164:167], a[144:147], a[172:175], v[164:167]
 ds_write_b128 v58, a[80:83] offset:36864
 v_mfma_f32_16x16x32_bf16 v[224:227], a[144:147], a[176:179], v[224:227]
 ds_write_b128 v58, a[84:87] offset:37888
 v_mfma_f32_16x16x32_bf16 v[228:231], a[144:147], a[180:183], v[228:231]
 ds_write_b128 v58, a[88:91] offset:38912
 v_mfma_f32_16x16x32_bf16 v[104:107], a[148:151], a[160:163], v[104:107]
 ds_read_b64_tr_b16 a[144:145], v18 offset:49152
 v_mfma_f32_16x16x32_bf16 v[108:111], a[148:151], a[164:167], v[108:111]
 ds_read_b64_tr_b16 a[146:147], v18 offset:50176
 v_mfma_f32_16x16x32_bf16 v[168:171], a[148:151], a[168:171], v[168:171]
 ds_write_b128 v58, a[92:95] offset:39936
 v_mfma_f32_16x16x32_bf16 v[172:175], a[148:151], a[172:175], v[172:175]
 v_mfma_f32_16x16x32_bf16 v[232:235], a[148:151], a[176:179], v[232:235]
 ds_read_b64 a[192:193], v32
 v_mfma_f32_16x16x32_bf16 v[236:239], a[148:151], a[180:183], v[236:239]
 ds_read_b64 a[194:195], v33
 v_mfma_f32_16x16x32_bf16 v[112:115], a[152:155], a[160:163], v[112:115]
 ds_read_b64_tr_b16 a[148:149], v19 offset:49152
 v_mfma_f32_16x16x32_bf16 v[116:119], a[152:155], a[164:167], v[116:119]
 ds_read_b64_tr_b16 a[150:151], v19 offset:50176
 v_mfma_f32_16x16x32_bf16 v[176:179], a[152:155], a[168:171], v[176:179]
 ds_read_b64 a[196:197], v32 offset:4096
 v_mfma_f32_16x16x32_bf16 v[180:183], a[152:155], a[172:175], v[180:183]
 ds_read_b64 a[198:199], v33 offset:4096
 v_mfma_f32_16x16x32_bf16 v[240:243], a[152:155], a[176:179], v[240:243]
 v_mfma_f32_16x16x32_bf16 v[244:247], a[152:155], a[180:183], v[244:247]
 ds_read_b64 a[200:201], v34
 v_mfma_f32_16x16x32_bf16 v[120:123], a[156:159], a[160:163], v[120:123]
 ds_read_b64_tr_b16 a[152:153], v20 offset:49152
 v_mfma_f32_16x16x32_bf16 v[124:127], a[156:159], a[164:167], v[124:127]
 ds_read_b64_tr_b16 a[154:155], v20 offset:50176
 v_mfma_f32_16x16x32_bf16 v[184:187], a[156:159], a[168:171], v[184:187]
 ds_read_b64 a[202:203], v35
 v_mfma_f32_16x16x32_bf16 v[188:191], a[156:159], a[172:175], v[188:191]
 ds_read_b64 a[204:205], v34 offset:4096
 v_mfma_f32_16x16x32_bf16 v[248:251], a[156:159], a[176:179], v[248:251]
 ds_read_b64 a[206:207], v35 offset:4096
 v_mfma_f32_16x16x32_bf16 v[252:255], a[156:159], a[180:183], v[252:255]
 s_waitcnt lgkmcnt(2)
 v_mfma_f32_16x16x32_bf16 v[64:67], a[128:131], a[224:227], v[64:67]
 ds_read_b64_tr_b16 a[156:157], v21 offset:49152
 v_mfma_f32_16x16x32_bf16 v[72:75], a[132:135], a[224:227], v[72:75]
 ds_read_b64_tr_b16 a[158:159], v21 offset:50176
 v_mfma_f32_16x16x32_bf16 v[80:83], a[136:139], a[224:227], v[80:83]
 v_mfma_f32_16x16x32_bf16 v[88:91], a[140:143], a[224:227], v[88:91]
 v_mfma_f32_16x16x32_bf16 v[96:99], a[144:147], a[224:227], v[96:99]
 v_mov_b32 v10, 0
 v_mfma_f32_16x16x32_bf16 v[104:107], a[148:151], a[224:227], v[104:107]
 v_mov_b32 v11, 0
 v_mfma_f32_16x16x32_bf16 v[112:115], a[152:155], a[224:227], v[112:115]
 v_mov_b32 v12, 0
 s_waitcnt lgkmcnt(0)
 v_mfma_f32_16x16x32_bf16 v[120:123], a[156:159], a[224:227], v[120:123]
 s_barrier
 v_mov_b32 v13, 0
 v_mfma_f32_16x16x32_bf16 v[68:71], a[128:131], a[228:231], v[68:71]
 s_add_u32 s39, s58, 32768
 s_and_b32 s39, s39, 262143
 s_add_u32 m0, s72, 0
 v_mfma_f32_16x16x32_bf16 v[76:79], a[132:135], a[228:231], v[76:79]
 buffer_load_dwordx4 v48, s[28:31], s39 offen nt lds
 v_mfma_f32_16x16x32_bf16 v[84:87], a[136:139], a[228:231], v[84:87]
 buffer_load_dwordx4 v49, s[28:31], s39 offen offset:1024 nt lds
 v_mfma_f32_16x16x32_bf16 v[92:95], a[140:143], a[228:231], v[92:95]
 buffer_load_dwordx4 v50, s[28:31], s39 offen offset:2048 nt lds
 v_mfma_f32_16x16x32_bf16 v[100:103], a[144:147], a[228:231], v[100:103]
 buffer_load_dwordx4 v51, s[28:31], s39 offen offset:3072 nt lds
 v_mfma_f32_16x16x32_bf16 v[108:111], a[148:151], a[228:231], v[108:111]
 s_add_u32 s39, s58, 36864
 s_and_b32 s39, s39, 262143
 s_add_u32 m0, s72, 4096
 v_mfma_f32_16x16x32_bf16 v[116:119], a[152:155], a[228:231], v[116:119]
 buffer_load_dwordx4 v48, s[28:31], s39 offen nt lds
 v_mfma_f32_16x16x32_bf16 v[124:127], a[156:159], a[228:231], v[124:127]
 buffer_load_dwordx4 v49, s[28:31], s39 offen offset:1024 nt lds
 v_mfma_f32_16x16x32_bf16 v[128:131], a[128:131], a[232:235], v[128:131]
 buffer_load_dwordx4 v50, s[28:31], s39 offen offset:2048 nt lds
 v_mfma_f32_16x16x32_bf16 v[136:139], a[132:135], a[232:235], v[136:139]
 buffer_load_dwordx4 v51, s[28:31], s39 offen offset:3072 nt lds
 v_mfma_f32_16x16x32_bf16 v[144:147], a[136:139], a[232:235], v[144:147]
 ds_write_b128 v58, a[96:99] offset:49152
 v_mul_f32 v64, s54, v64
 v_mul_f32 v65, s54, v65
 v_mfma_f32_16x16x32_bf16 v[152:155], a[140:143], a[232:235], v[152:155]
 ds_write_b128 v58, a[100:103] offset:50176
 v_mul_f32 v66, s54, v66
 v_mul_f32 v67, s54, v67
 v_mfma_f32_16x16x32_bf16 v[160:163], a[144:147], a[232:235], v[160:163]
 ds_write_b128 v58, a[104:107] offset:51200
 v_mul_f32 v72, s54, v72
 v_mul_f32 v73, s54, v73
 v_mfma_f32_16x16x32_bf16 v[168:171], a[148:151], a[232:235], v[168:171]
 v_mul_f32 v74, s54, v74
 v_mul_f32 v75, s54, v75
 v_mfma_f32_16x16x32_bf16 v[176:179], a[152:155], a[232:235], v[176:179]
 ds_write_b128 v58, a[108:111] offset:52224
 v_cvt_pk_bf16_f32 v64, v64, v65
 v_cvt_pk_bf16_f32 v65, v66, v67
 v_mfma_f32_16x16x32_bf16 v[184:187], a[156:159], a[232:235], v[184:187]
 ds_write_b128 v58, a[112:115] offset:53248
 v_cvt_pk_bf16_f32 v66, v72, v73
 v_cvt_pk_bf16_f32 v67, v74, v75
 v_mfma_f32_16x16x32_bf16 v[132:135], a[128:131], a[236:239], v[132:135]
 ds_write_b128 v58, a[116:119] offset:54272
 v_mul_f32 v68, s54, v68
 v_mul_f32 v69, s54, v69
 v_mfma_f32_16x16x32_bf16 v[140:143], a[132:135], a[236:239], v[140:143]
 ds_write_b128 v58, a[120:123] offset:55296
 v_mul_f32 v70, s54, v70
 v_mul_f32 v71, s54, v71
 v_mfma_f32_16x16x32_bf16 v[148:151], a[136:139], a[236:239], v[148:151]
 ds_write_b128 v58, a[124:127] offset:56320
 v_mul_f32 v76, s54, v76
 v_mul_f32 v77, s54, v77
 v_mfma_f32_16x16x32_bf16 v[156:159], a[140:143], a[236:239], v[156:159]
 ds_read_b64 a[208:209], v36
 v_mul_f32 v78, s54, v78
 v_mul_f32 v79, s54, v79
 v_mfma_f32_16x16x32_bf16 v[164:167], a[144:147], a[236:239], v[164:167]
 ds_read_b64 a[210:211], v37
 v_cvt_pk_bf16_f32 v68, v68, v69
 v_cvt_pk_bf16_f32 v69, v70, v71
 v_mfma_f32_16x16x32_bf16 v[172:175], a[148:151], a[236:239], v[172:175]
 ds_read_b64 a[212:213], v36 offset:4096
 v_cvt_pk_bf16_f32 v70, v76, v77
 v_cvt_pk_bf16_f32 v71, v78, v79
 v_mfma_f32_16x16x32_bf16 v[180:183], a[152:155], a[236:239], v[180:183]
 ds_read_b64 a[214:215], v37 offset:4096
 v_mul_f32 v80, s54, v80
 v_mul_f32 v81, s54, v81
 v_mfma_f32_16x16x32_bf16 v[188:191], a[156:159], a[236:239], v[188:191]
 ds_read_b64 a[216:217], v38
 v_mul_f32 v82, s54, v82
 v_mul_f32 v83, s54, v83
 v_mfma_f32_16x16x32_bf16 v[192:195], a[128:131], a[240:243], v[192:195]
 ds_read_b64 a[218:219], v39
 v_mul_f32 v88, s54, v88
 v_mul_f32 v89, s54, v89
 v_mfma_f32_16x16x32_bf16 v[200:203], a[132:135], a[240:243], v[200:203]
 ds_read_b64 a[220:221], v38 offset:4096
 v_mul_f32 v90, s54, v90
 v_mul_f32 v91, s54, v91
 v_mfma_f32_16x16x32_bf16 v[208:211], a[136:139], a[240:243], v[208:211]
 ds_read_b64 a[222:223], v39 offset:4096
 v_cvt_pk_bf16_f32 v72, v80, v81
 v_cvt_pk_bf16_f32 v73, v82, v83
 v_mfma_f32_16x16x32_bf16 v[216:219], a[140:143], a[240:243], v[216:219]
 v_cvt_pk_bf16_f32 v74, v88, v89
 v_cvt_pk_bf16_f32 v75, v90, v91
 v_mfma_f32_16x16x32_bf16 v[224:227], a[144:147], a[240:243], v[224:227]
 v_mul_f32 v84, s54, v84
 v_mul_f32 v85, s54, v85
 v_mfma_f32_16x16x32_bf16 v[232:235], a[148:151], a[240:243], v[232:235]
 v_mul_f32 v86, s54, v86
 v_mul_f32 v87, s54, v87
 v_mfma_f32_16x16x32_bf16 v[240:243], a[152:155], a[240:243], v[240:243]
 v_mul_f32 v92, s54, v92
 v_mul_f32 v93, s54, v93
 v_mfma_f32_16x16x32_bf16 v[248:251], a[156:159], a[240:243], v[248:251]
 v_mul_f32 v94, s54, v94
 v_mul_f32 v95, s54, v95
 v_mfma_f32_16x16x32_bf16 v[196:199], a[128:131], a[244:247], v[196:199]
 v_cvt_pk_bf16_f32 v76, v84, v85
 v_cvt_pk_bf16_f32 v77, v86, v87
 v_mfma_f32_16x16x32_bf16 v[204:207], a[132:135], a[244:247], v[204:207]
 v_cvt_pk_bf16_f32 v78, v92, v93
 v_cvt_pk_bf16_f32 v79, v94, v95
 v_mfma_f32_16x16x32_bf16 v[212:215], a[136:139], a[244:247], v[212:215]
 v_mul_f32 v96, s54, v96
 v_mul_f32 v97, s54, v97
 v_mfma_f32_16x16x32_bf16 v[220:223], a[140:143], a[244:247], v[220:223]
 v_mul_f32 v98, s54, v98
 v_mul_f32 v99, s54, v99
 v_mfma_f32_16x16x32_bf16 v[228:231], a[144:147], a[244:247], v[228:231]
 v_mul_f32 v104, s54, v104
 v_mul_f32 v105, s54, v105
 v_mfma_f32_16x16x32_bf16 v[236:239], a[148:151], a[244:247], v[236:239]
 v_mul_f32 v106, s54, v106
 v_mul_f32 v107, s54, v107
 v_mfma_f32_16x16x32_bf16 v[244:247], a[152:155], a[244:247], v[244:247]
 v_cvt_pk_bf16_f32 v80, v96, v97
 v_cvt_pk_bf16_f32 v81, v98, v99
 v_mfma_f32_16x16x32_bf16 v[252:255], a[156:159], a[244:247], v[252:255]
 v_cvt_pk_bf16_f32 v82, v104, v105
 v_cvt_pk_bf16_f32 v83, v106, v107
 s_nop 3
 s_waitcnt lgkmcnt(0)
 v_mfma_f32_32x32x16_bf16 a[0:15], v[10:13], v[10:13], 0
 v_mul_f32 v100, s54, v100
 v_mul_f32 v101, s54, v101
 v_mul_f32 v102, s54, v102
 v_mul_f32 v103, s54, v103
 v_mul_f32 v108, s54, v108
 v_mul_f32 v109, s54, v109
 v_mul_f32 v110, s54, v110
 v_mul_f32 v111, s54, v111
 v_cvt_pk_bf16_f32 v84, v100, v101
 v_cvt_pk_bf16_f32 v85, v102, v103
 v_cvt_pk_bf16_f32 v86, v108, v109
 v_cvt_pk_bf16_f32 v87, v110, v111
 v_mul_f32 v112, s54, v112
 v_mul_f32 v113, s54, v113
 v_mul_f32 v114, s54, v114
 v_mul_f32 v115, s54, v115
 v_mfma_f32_32x32x16_bf16 a[16:31], v[10:13], v[10:13], 0
 v_mul_f32 v120, s54, v120
 v_mul_f32 v121, s54, v121
 v_mul_f32 v122, s54, v122
 v_mul_f32 v123, s54, v123
 v_cvt_pk_bf16_f32 v88, v112, v113
 v_cvt_pk_bf16_f32 v89, v114, v115
 v_cvt_pk_bf16_f32 v90, v120, v121
 v_cvt_pk_bf16_f32 v91, v122, v123
 v_mul_f32 v116, s54, v116
 v_mul_f32 v117, s54, v117
 v_mul_f32 v118, s54, v118
 v_mul_f32 v119, s54, v119
 v_mul_f32 v124, s54, v124
 v_mul_f32 v125, s54, v125
 v_mul_f32 v126, s54, v126
 v_mul_f32 v127, s54, v127
 v_cvt_pk_bf16_f32 v92, v116, v117
 v_mfma_f32_32x32x16_bf16 a[32:47], v[10:13], v[10:13], 0
 v_cvt_pk_bf16_f32 v93, v118, v119
 v_cvt_pk_bf16_f32 v94, v124, v125
 v_cvt_pk_bf16_f32 v95, v126, v127
 v_mul_f32 v128, s54, v128
 v_mul_f32 v129, s54, v129
 v_mul_f32 v130, s54, v130
 v_mul_f32 v131, s54, v131
 v_mul_f32 v136, s54, v136
 v_mul_f32 v137, s54, v137
 v_mul_f32 v138, s54, v138
 v_mul_f32 v139, s54, v139
 v_cvt_pk_bf16_f32 v96, v128, v129
 v_cvt_pk_bf16_f32 v97, v130, v131
 v_cvt_pk_bf16_f32 v98, v136, v137
 v_cvt_pk_bf16_f32 v99, v138, v139
 v_mul_f32 v132, s54, v132
 v_mfma_f32_32x32x16_bf16 a[48:63], v[10:13], v[10:13], 0
 v_mul_f32 v133, s54, v133
 v_mul_f32 v134, s54, v134
 v_mul_f32 v135, s54, v135
 v_mul_f32 v140, s54, v140
 v_mul_f32 v141, s54, v141
 v_mul_f32 v142, s54, v142
 v_mul_f32 v143, s54, v143
 v_cvt_pk_bf16_f32 v100, v132, v133
 v_cvt_pk_bf16_f32 v101, v134, v135
 v_cvt_pk_bf16_f32 v102, v140, v141
 v_cvt_pk_bf16_f32 v103, v142, v143
 v_mul_f32 v144, s54, v144
 v_mul_f32 v145, s54, v145
 v_mul_f32 v146, s54, v146
 v_mul_f32 v147, s54, v147
 v_mul_f32 v152, s54, v152
 v_mfma_f32_32x32x16_bf16 a[64:79], v[10:13], v[10:13], 0
 v_mul_f32 v153, s54, v153
 v_mul_f32 v154, s54, v154
 v_mul_f32 v155, s54, v155
 v_cvt_pk_bf16_f32 v104, v144, v145
 v_cvt_pk_bf16_f32 v105, v146, v147
 v_cvt_pk_bf16_f32 v106, v152, v153
 v_cvt_pk_bf16_f32 v107, v154, v155
 v_mul_f32 v148, s54, v148
 v_mul_f32 v149, s54, v149
 v_mul_f32 v150, s54, v150
 v_mul_f32 v151, s54, v151
 v_mul_f32 v156, s54, v156
 v_mul_f32 v157, s54, v157
 v_mul_f32 v158, s54, v158
 v_mul_f32 v159, s54, v159
 v_cvt_pk_bf16_f32 v108, v148, v149
 v_mfma_f32_32x32x16_bf16 a[80:95], v[10:13], v[10:13], 0
 v_cvt_pk_bf16_f32 v109, v150, v151
 v_cvt_pk_bf16_f32 v110, v156, v157
 v_cvt_pk_bf16_f32 v111, v158, v159
 v_mul_f32 v160, s54, v160
 v_mul_f32 v161, s54, v161
 v_mul_f32 v162, s54, v162
 v_mul_f32 v163, s54, v163
 v_mul_f32 v168, s54, v168
 v_mul_f32 v169, s54, v169
 v_mul_f32 v170, s54, v170
 v_mul_f32 v171, s54, v171
 v_cvt_pk_bf16_f32 v112, v160, v161
 v_cvt_pk_bf16_f32 v113, v162, v163
 v_cvt_pk_bf16_f32 v114, v168, v169
 v_cvt_pk_bf16_f32 v115, v170, v171
 v_mul_f32 v164, s54, v164
 v_mul_f32 v165, s54, v165
 v_mfma_f32_32x32x16_bf16 a[96:111], v[10:13], v[10:13], 0
 v_mul_f32 v166, s54, v166
 v_mul_f32 v167, s54, v167
 v_mul_f32 v172, s54, v172
 v_mul_f32 v173, s54, v173
 v_mul_f32 v174, s54, v174
 v_mul_f32 v175, s54, v175
 v_cvt_pk_bf16_f32 v116, v164, v165
 v_cvt_pk_bf16_f32 v117, v166, v167
 v_cvt_pk_bf16_f32 v118, v172, v173
 v_cvt_pk_bf16_f32 v119, v174, v175
 v_mul_f32 v176, s54, v176
 v_mul_f32 v177, s54, v177
 v_mul_f32 v178, s54, v178
 v_mul_f32 v179, s54, v179
 v_mul_f32 v184, s54, v184
 v_mul_f32 v185, s54, v185
 v_mfma_f32_32x32x16_bf16 a[112:127], v[10:13], v[10:13], 0
 v_mul_f32 v186, s54, v186
 v_mul_f32 v187, s54, v187
 v_cvt_pk_bf16_f32 v120, v176, v177
 v_cvt_pk_bf16_f32 v121, v178, v179
 v_cvt_pk_bf16_f32 v122, v184, v185
 v_cvt_pk_bf16_f32 v123, v186, v187
 v_mul_f32 v180, s54, v180
 v_mul_f32 v181, s54, v181
 v_mul_f32 v182, s54, v182
 v_mul_f32 v183, s54, v183
 v_mul_f32 v188, s54, v188
 v_mul_f32 v189, s54, v189
 v_mul_f32 v190, s54, v190
 v_mul_f32 v191, s54, v191
 v_cvt_pk_bf16_f32 v124, v180, v181
 v_cvt_pk_bf16_f32 v125, v182, v183
 v_mfma_f32_32x32x16_bf16 a[128:143], v[10:13], v[10:13], 0
 v_cvt_pk_bf16_f32 v126, v188, v189
 v_cvt_pk_bf16_f32 v127, v190, v191
 v_mul_f32 v192, s54, v192
 v_mul_f32 v193, s54, v193
 v_mul_f32 v194, s54, v194
 v_mul_f32 v195, s54, v195
 v_mul_f32 v200, s54, v200
 v_mul_f32 v201, s54, v201
 v_mul_f32 v202, s54, v202
 v_mul_f32 v203, s54, v203
 v_cvt_pk_bf16_f32 v128, v192, v193
 v_cvt_pk_bf16_f32 v129, v194, v195
 v_cvt_pk_bf16_f32 v130, v200, v201
 v_cvt_pk_bf16_f32 v131, v202, v203
 v_mul_f32 v196, s54, v196
 v_mul_f32 v197, s54, v197
 v_mul_f32 v198, s54, v198
 v_mfma_f32_32x32x16_bf16 a[144:159], v[10:13], v[10:13], 0
 v_mul_f32 v199, s54, v199
 v_mul_f32 v204, s54, v204
 v_mul_f32 v205, s54, v205
 v_mul_f32 v206, s54, v206
 v_mul_f32 v207, s54, v207
 v_cvt_pk_bf16_f32 v132, v196, v197
 v_cvt_pk_bf16_f32 v133, v198, v199
 v_cvt_pk_bf16_f32 v134, v204, v205
 v_cvt_pk_bf16_f32 v135, v206, v207
 v_mul_f32 v208, s54, v208
 v_mul_f32 v209, s54, v209
 v_mul_f32 v210, s54, v210
 v_mul_f32 v211, s54, v211
 v_mul_f32 v216, s54, v216
 v_mul_f32 v217, s54, v217
 v_mul_f32 v218, s54, v218
 v_mfma_f32_32x32x16_bf16 a[160:175], v[10:13], v[10:13], 0
 v_mul_f32 v219, s54, v219
 v_cvt_pk_bf16_f32 v136, v208, v209
 v_cvt_pk_bf16_f32 v137, v210, v211
 v_cvt_pk_bf16_f32 v138, v216, v217
 v_cvt_pk_bf16_f32 v139, v218, v219
 v_mul_f32 v212, s54, v212
 v_mul_f32 v213, s54, v213
 v_mul_f32 v214, s54, v214
 v_mul_f32 v215, s54, v215
 v_mul_f32 v220, s54, v220
 v_mul_f32 v221, s54, v221
 v_mul_f32 v222, s54, v222
 v_mul_f32 v223, s54, v223
 v_cvt_pk_bf16_f32 v140, v212, v213
 v_cvt_pk_bf16_f32 v141, v214, v215
 v_cvt_pk_bf16_f32 v142, v220, v221
 v_mfma_f32_32x32x16_bf16 a[176:191], v[10:13], v[10:13], 0
 v_cvt_pk_bf16_f32 v143, v222, v223
 v_mul_f32 v224, s54, v224
 v_mul_f32 v225, s54, v225
 v_mul_f32 v226, s54, v226
 v_mul_f32 v227, s54, v227
 v_mul_f32 v232, s54, v232
 v_mul_f32 v233, s54, v233
 v_mul_f32 v234, s54, v234
 v_mul_f32 v235, s54, v235
 v_cvt_pk_bf16_f32 v144, v224, v225
 v_cvt_pk_bf16_f32 v145, v226, v227
 v_cvt_pk_bf16_f32 v146, v232, v233
 v_cvt_pk_bf16_f32 v147, v234, v235
 v_mul_f32 v228, s54, v228
 v_mul_f32 v229, s54, v229
 v_mul_f32 v230, s54, v230
 v_mfma_f32_32x32x16_bf16 a[224:239], v[10:13], v[10:13], 0
 v_mul_f32 v231, s54, v231
 v_mul_f32 v236, s54, v236
 v_mul_f32 v237, s54, v237
 v_mul_f32 v238, s54, v238
 v_mul_f32 v239, s54, v239
 v_cvt_pk_bf16_f32 v148, v228, v229
 v_cvt_pk_bf16_f32 v149, v230, v231
 v_cvt_pk_bf16_f32 v150, v236, v237
 v_cvt_pk_bf16_f32 v151, v238, v239
 v_mul_f32 v240, s54, v240
 v_mul_f32 v241, s54, v241
 v_mul_f32 v242, s54, v242
 v_mul_f32 v243, s54, v243
 v_mul_f32 v248, s54, v248
 v_mul_f32 v249, s54, v249
 v_mul_f32 v250, s54, v250
 v_mul_f32 v251, s54, v251
 v_mfma_f32_32x32x16_bf16 a[240:255], v[10:13], v[10:13], 0
 v_cvt_pk_bf16_f32 v152, v240, v241
 v_cvt_pk_bf16_f32 v153, v242, v243
 v_cvt_pk_bf16_f32 v154, v248, v249
 v_cvt_pk_bf16_f32 v155, v250, v251
 v_mul_f32 v244, s54, v244
 v_mul_f32 v245, s54, v245
 v_mul_f32 v246, s54, v246
 v_mul_f32 v247, s54, v247
 v_mul_f32 v252, s54, v252
 v_mul_f32 v253, s54, v253
 v_mul_f32 v254, s54, v254
 v_mul_f32 v255, s54, v255
 v_cvt_pk_bf16_f32 v156, v244, v245
 v_cvt_pk_bf16_f32 v157, v246, v247
 v_cvt_pk_bf16_f32 v158, v252, v253
 v_cvt_pk_bf16_f32 v159, v254, v255
 s_nop 1
 v_mfma_f32_16x16x32_bf16 v[160:163], a[192:195], v[64:67], 0
 s_add_u32 s39, s58, 40960
 s_and_b32 s39, s39, 262143
 buffer_load_dwordx4 v[208:211], v48, s[28:31], s39 offen nt
 v_mfma_f32_16x16x32_bf16 v[184:187], a[196:199], v[64:67], 0
 buffer_load_dwordx4 v[212:215], v49, s[28:31], s39 offen offset:1024 nt
 buffer_load_dwordx4 v[216:219], v50, s[28:31], s39 offen offset:2048 nt
 v_mfma_f32_16x16x32_bf16 v[160:163], a[200:203], v[72:75], v[160:163]
 buffer_load_dwordx4 v[220:223], v51, s[28:31], s39 offen offset:3072 nt
 s_add_u32 s39, s58, 45056
 s_and_b32 s39, s39, 262143
 v_mfma_f32_16x16x32_bf16 v[184:187], a[204:207], v[72:75], v[184:187]
 buffer_load_dwordx4 v[224:227], v48, s[28:31], s39 offen nt
 buffer_load_dwordx4 v[228:231], v49, s[28:31], s39 offen offset:1024 nt
 v_mfma_f32_16x16x32_bf16 v[160:163], a[208:211], v[80:83], v[160:163]
 buffer_load_dwordx4 v[232:235], v50, s[28:31], s39 offen offset:2048 nt
 buffer_load_dwordx4 v[236:239], v51, s[28:31], s39 offen offset:3072 nt
 v_mfma_f32_16x16x32_bf16 v[184:187], a[212:215], v[80:83], v[184:187]
 v_mfma_f32_16x16x32_bf16 v[160:163], a[216:219], v[88:91], v[160:163]
 s_sub_u32 s57, 0, s40
 s_lshl_b32 s42, s40, 13
 s_add_u32 s50, s58, 49152
 s_sub_u32 s50, s50, s42
 s_and_b32 s50, s50, 262143
 s_add_u32 s51, s50, 4096
 s_mov_b32 s45, 0
 v_mfma_f32_16x16x32_bf16 v[184:187], a[220:223], v[88:91], v[184:187]
 s_lshl_b32 s44, s2, 2
 s_add_u32 s44, s44, s36
 s_lshl_b32 s44, s44, 13
 v_mfma_f32_16x16x32_bf16 v[164:167], a[192:195], v[68:71], 0
 buffer_load_dword v61, v60, s[80:83], s44 offen
 v_mfma_f32_16x16x32_bf16 v[188:191], a[196:199], v[68:71], 0
 s_sub_u32 s42, 0, s40
 s_and_b32 s42, s42, 3
 s_lshl_b32 s42, s42, 14
 s_add_u32 s94, s52, s42
 v_max3_f32 v2, v160, v161, v162
 v_max3_f32 v2, v2, v163, v184
 v_mfma_f32_16x16x32_bf16 v[164:167], a[200:203], v[76:79], v[164:167]
 s_sub_u32 s42, 1, s40
 s_and_b32 s42, s42, 3
 s_lshl_b32 s42, s42, 14
 s_add_u32 s95, s52, s42
 v_max3_f32 v2, v2, v185, v186
 v_max_f32 v2, v2, v187
 v_mfma_f32_16x16x32_bf16 v[188:191], a[204:207], v[76:79], v[188:191]
 s_sub_u32 s42, 2, s40
 s_and_b32 s42, s42, 3
 s_lshl_b32 s42, s42, 14
 s_add_u32 s96, s52, s42
 v_mov_b32 v3, v2
 s_nop 1
 v_permlane16_swap_b32 v2, v3
 v_mfma_f32_16x16x32_bf16 v[164:167], a[208:211], v[84:87], v[164:167]
 s_sub_u32 s42, 3, s40
 s_and_b32 s42, s42, 3
 s_lshl_b32 s42, s42, 14
 s_add_u32 s97, s52, s42
 s_nop 1
 v_max_f32 v2, v2, v3
 v_mfma_f32_16x16x32_bf16 v[188:191], a[212:215], v[84:87], v[188:191]
 s_mov_b32 s78, s94
 s_cmp_lg_u32 s40, 0
 s_cselect_b64 vcc, -1, 0
 v_mov_b32 v3, v2
 s_nop 1
 v_mfma_f32_16x16x32_bf16 v[164:167], a[216:219], v[92:95], v[164:167]
 v_permlane32_swap_b32 v2, v3
 s_nop 1
 v_add_u32 v58, s79, v58
 v_mfma_f32_16x16x32_bf16 v[188:191], a[220:223], v[92:95], v[188:191]
 v_max_f32 v2, v2, v3
 v_sub_f32 v160, 0, v2
 v_sub_f32 v161, 0, v2
 v_mfma_f32_16x16x32_bf16 v[168:171], a[192:195], v[96:99], 0
 v_sub_f32 v162, 0, v2
 v_sub_f32 v163, 0, v2
 v_mfma_f32_16x16x32_bf16 v[192:195], a[196:199], v[96:99], 0
 v_max3_f32 v2, v164, v165, v166
 v_max3_f32 v2, v2, v167, v188
 v_mfma_f32_16x16x32_bf16 v[168:171], a[200:203], v[104:107], v[168:171]
 v_max3_f32 v2, v2, v189, v190
 v_max_f32 v2, v2, v191
 v_mfma_f32_16x16x32_bf16 v[192:195], a[204:207], v[104:107], v[192:195]
 v_mov_b32 v3, v2
 s_nop 1
 v_permlane16_swap_b32 v2, v3
 v_mfma_f32_16x16x32_bf16 v[168:171], a[208:211], v[112:115], v[168:171]
 s_nop 1
 v_max_f32 v2, v2, v3
 v_mfma_f32_16x16x32_bf16 v[192:195], a[212:215], v[112:115], v[192:195]
 v_mov_b32 v3, v2
 s_nop 1
 v_mfma_f32_16x16x32_bf16 v[168:171], a[216:219], v[120:123], v[168:171]
 v_permlane32_swap_b32 v2, v3
 s_nop 1
 v_mfma_f32_16x16x32_bf16 v[192:195], a[220:223], v[120:123], v[192:195]
 v_max_f32 v2, v2, v3
 v_sub_f32 v164, 0, v2
 v_sub_f32 v165, 0, v2
 v_mfma_f32_16x16x32_bf16 v[172:175], a[192:195], v[100:103], 0
 v_sub_f32 v166, 0, v2
 v_sub_f32 v167, 0, v2
 v_mfma_f32_16x16x32_bf16 v[196:199], a[196:199], v[100:103], 0
 v_max3_f32 v2, v168, v169, v170
 v_max3_f32 v2, v2, v171, v192
 v_mfma_f32_16x16x32_bf16 v[172:175], a[200:203], v[108:111], v[172:175]
 v_max3_f32 v2, v2, v193, v194
 v_max_f32 v2, v2, v195
 v_mov_b32 v184, 0
 v_mfma_f32_16x16x32_bf16 v[196:199], a[204:207], v[108:111], v[196:199]
 v_mov_b32 v3, v2
 s_nop 1
 v_permlane16_swap_b32 v2, v3
 v_mov_b32 v185, 0
 v_mfma_f32_16x16x32_bf16 v[172:175], a[208:211], v[116:119], v[172:175]
 s_nop 1
 v_max_f32 v2, v2, v3
 v_mov_b32 v186, 0
 v_mfma_f32_16x16x32_bf16 v[196:199], a[212:215], v[116:119], v[196:199]
 v_mov_b32 v3, v2
 s_nop 1
 v_mov_b32 v187, 0
 v_mfma_f32_16x16x32_bf16 v[172:175], a[216:219], v[124:127], v[172:175]
 v_permlane32_swap_b32 v2, v3
 s_nop 1
 v_mov_b32 v188, 0
 v_mfma_f32_16x16x32_bf16 v[196:199], a[220:223], v[124:127], v[196:199]
 v_max_f32 v2, v2, v3
 v_sub_f32 v168, 0, v2
 v_sub_f32 v169, 0, v2
 v_mov_b32 v189, 0
 v_mfma_f32_16x16x32_bf16 v[176:179], a[192:195], v[128:131], 0
 v_sub_f32 v170, 0, v2
 v_sub_f32 v171, 0, v2
 v_mov_b32 v190, 0
 v_mfma_f32_16x16x32_bf16 v[200:203], a[196:199], v[128:131], 0
 v_max3_f32 v2, v172, v173, v174
 v_max3_f32 v2, v2, v175, v196
 v_mov_b32 v191, 0
 v_mfma_f32_16x16x32_bf16 v[176:179], a[200:203], v[136:139], v[176:179]
 v_max3_f32 v2, v2, v197, v198
 v_max_f32 v2, v2, v199
 v_mfma_f32_16x16x32_bf16 v[200:203], a[204:207], v[136:139], v[200:203]
 v_mov_b32 v3, v2
 s_nop 1
 v_permlane16_swap_b32 v2, v3
 v_mfma_f32_16x16x32_bf16 v[176:179], a[208:211], v[144:147], v[176:179]
 s_nop 1
 v_max_f32 v2, v2, v3
 v_mfma_f32_16x16x32_bf16 v[200:203], a[212:215], v[144:147], v[200:203]
 v_mov_b32 v3, v2
 s_nop 1
 v_mfma_f32_16x16x32_bf16 v[176:179], a[216:219], v[152:155], v[176:179]
 v_permlane32_swap_b32 v2, v3
 s_nop 1
 v_mfma_f32_16x16x32_bf16 v[200:203], a[220:223], v[152:155], v[200:203]
 v_max_f32 v2, v2, v3
 v_sub_f32 v172, 0, v2
 v_sub_f32 v173, 0, v2
 v_mfma_f32_16x16x32_bf16 v[180:183], a[192:195], v[132:135], 0
 v_sub_f32 v174, 0, v2
 v_sub_f32 v175, 0, v2
 v_mfma_f32_16x16x32_bf16 v[204:207], a[196:199], v[132:135], 0
 v_max3_f32 v2, v176, v177, v178
 v_max3_f32 v2, v2, v179, v200
 v_max3_f32 v2, v2, v201, v202
 v_mfma_f32_16x16x32_bf16 v[180:183], a[200:203], v[140:143], v[180:183]
 v_max_f32 v2, v2, v203
 v_mov_b32 v3, v2
 v_mov_b32 v192, 0
 v_mfma_f32_16x16x32_bf16 v[204:207], a[204:207], v[140:143], v[204:207]
 s_nop 1
 v_permlane16_swap_b32 v2, v3
 s_nop 1
 v_mov_b32 v193, 0
 v_mov_b32 v194, 0
 v_mfma_f32_16x16x32_bf16 v[180:183], a[208:211], v[148:151], v[180:183]
 v_max_f32 v2, v2, v3
 v_mov_b32 v3, v2
 v_mov_b32 v195, 0
 v_mfma_f32_16x16x32_bf16 v[204:207], a[212:215], v[148:151], v[204:207]
 s_nop 1
 v_permlane32_swap_b32 v2, v3
 s_nop 1
 v_mov_b32 v196, 0
 v_mfma_f32_16x16x32_bf16 v[180:183], a[216:219], v[156:159], v[180:183]
 v_max_f32 v2, v2, v3
 v_sub_f32 v176, 0, v2
 v_mov_b32 v197, 0
 v_mov_b32 v198, 0
 v_mfma_f32_16x16x32_bf16 v[204:207], a[220:223], v[156:159], v[204:207]
 v_sub_f32 v177, 0, v2
 v_sub_f32 v178, 0, v2
 v_sub_f32 v179, 0, v2
 v_mov_b32 v199, 0xf149f2ca
 s_nop 7
 v_max3_f32 v2, v180, v181, v182
 v_max3_f32 v2, v2, v183, v204
 v_max3_f32 v2, v2, v205, v206
 v_max_f32 v2, v2, v207
 v_mov_b32 v3, v2
 s_nop 1
 v_permlane16_swap_b32 v2, v3
 s_nop 1
 v_max_f32 v2, v2, v3
 v_mov_b32 v3, v2
 s_nop 1
 v_permlane32_swap_b32 v2, v3
 s_nop 1
 v_max_f32 v2, v2, v3
 v_sub_f32 v180, 0, v2
 v_sub_f32 v181, 0, v2
 v_sub_f32 v182, 0, v2
 v_sub_f32 v183, 0, v2
 v_mov_b32 v204, 0
 v_mov_b32 v205, 0
 v_mov_b32 v206, 0
 v_mov_b32 v207, 0
 s_nop 1
 s_waitcnt lgkmcnt(0)
L1_tile0:
 v_mfma_f32_16x16x32_bf16 v[184:187], a[192:195], v[64:67], v[160:163]
 v_cvt_pk_bf16_f32 v206, v196, v197
 v_exp_f32 v199, v199
 v_mfma_f32_16x16x32_bf16 v[188:191], a[196:199], v[64:67], v[160:163]
 v_add_f32 v57, v57, v192
 v_cvt_pk_bf16_f32 v207, v198, v199
 v_add_f32 v57, v57, v196
 v_mfma_f32_16x16x32_bf16 v[184:187], a[200:203], v[72:75], v[184:187]
 v_add_f32 v57, v57, v197
 v_add_f32 v57, v57, v198
 v_add_f32 v57, v57, v199
 v_mfma_f32_16x16x32_bf16 v[188:191], a[204:207], v[72:75], v[188:191]
 v_mfma_f32_16x16x32_bf16 v[184:187], a[208:211], v[80:83], v[184:187]
 v_mfma_f32_16x16x32_bf16 v[188:191], a[212:215], v[80:83], v[188:191]
 v_mfma_f32_16x16x32_bf16 v[184:187], a[216:219], v[88:91], v[184:187]
 v_mfma_f32_16x16x32_bf16 v[188:191], a[220:223], v[88:91], v[188:191]
 s_barrier
 v_mfma_f32_16x16x32_bf16 a[160:163], a[224:227], v[204:207], a[160:163]
 ds_read_b64_tr_b16 a[224:225], v40
 v_exp_f32 v184, v184
 v_mfma_f32_16x16x32_bf16 a[164:167], a[228:231], v[204:207], a[164:167]
 ds_read_b64_tr_b16 a[228:229], v41
 v_exp_f32 v185, v185
 v_mfma_f32_16x16x32_bf16 a[168:171], a[232:235], v[204:207], a[168:171]
 ds_read_b64_tr_b16 a[232:233], v42
 v_exp_f32 v186, v186
 v_mfma_f32_16x16x32_bf16 a[172:175], a[236:239], v[204:207], a[172:175]
 ds_read_b64_tr_b16 a[236:237], v43
 v_cvt_pk_bf16_f32 v200, v184, v185
 v_add_f32 v52, v52, v185
 v_mfma_f32_16x16x32_bf16 a[176:179], a[240:243], v[204:207], a[176:179]
 ds_read_b64_tr_b16 a[226:227], v40 offset:4096
 ds_read_b64_tr_b16 a[240:241], v44
 v_add_f32 v52, v52, v186
 v_mfma_f32_16x16x32_bf16 a[180:183], a[244:247], v[204:207], a[180:183]
 ds_read_b64_tr_b16 a[230:231], v41 offset:4096
 ds_read_b64_tr_b16 a[244:245], v45
 v_mfma_f32_16x16x32_bf16 a[184:187], a[248:251], v[204:207], a[184:187]
 ds_read_b64_tr_b16 a[234:235], v42 offset:4096
 ds_read_b64_tr_b16 a[248:249], v46
 v_mfma_f32_16x16x32_bf16 a[188:191], a[252:255], v[204:207], a[188:191]
 ds_read_b64_tr_b16 a[238:239], v43 offset:4096
 ds_read_b64_tr_b16 a[252:253], v47
 v_mfma_f32_16x16x32_bf16 v[192:195], a[192:195], v[68:71], v[164:167]
 ds_read_b64_tr_b16 a[242:243], v44 offset:4096
 v_exp_f32 v187, v187
 v_mfma_f32_16x16x32_bf16 v[196:199], a[196:199], v[68:71], v[164:167]
 ds_read_b64_tr_b16 a[246:247], v45 offset:4096
 v_exp_f32 v188, v188
 v_mfma_f32_16x16x32_bf16 v[192:195], a[200:203], v[76:79], v[192:195]
 ds_read_b64_tr_b16 a[250:251], v46 offset:4096
 v_cvt_pk_bf16_f32 v201, v186, v187
 v_add_f32 v52, v52, v187
 v_mfma_f32_16x16x32_bf16 v[196:199], a[204:207], v[76:79], v[196:199]
 ds_read_b64_tr_b16 a[254:255], v47 offset:4096
 v_exp_f32 v189, v189
 v_mfma_f32_16x16x32_bf16 v[192:195], a[208:211], v[84:87], v[192:195]
 s_cbranch_vccnz L1_only1
 s_add_u32 m0, s94, 0
 s_nop 0
 buffer_load_dwordx4 v48, s[28:31], s50 offen nt lds
 buffer_load_dwordx4 v49, s[28:31], s50 offen offset:1024 nt lds
 buffer_load_dwordx4 v50, s[28:31], s50 offen offset:2048 nt lds
 buffer_load_dwordx4 v51, s[28:31], s50 offen offset:3072 nt lds
L1_only1:
 v_exp_f32 v190, v190
 v_mfma_f32_16x16x32_bf16 v[196:199], a[212:215], v[84:87], v[196:199]
 v_cvt_pk_bf16_f32 v202, v188, v189
 v_exp_f32 v191, v191
 v_mfma_f32_16x16x32_bf16 v[192:195], a[216:219], v[92:95], v[192:195]
 v_add_f32 v52, v52, v184
 v_cvt_pk_bf16_f32 v203, v190, v191
 v_mfma_f32_16x16x32_bf16 v[196:199], a[220:223], v[92:95], v[196:199]
 v_add_f32 v52, v52, v188
 v_add_f32 v52, v52, v189
 s_waitcnt lgkmcnt(5)
 v_mfma_f32_16x16x32_bf16 a[0:3], a[224:227], v[200:203], a[0:3]
 v_exp_f32 v192, v192
 v_mfma_f32_16x16x32_bf16 a[4:7], a[228:231], v[200:203], a[4:7]
 v_exp_f32 v193, v193
 v_add_f32 v52, v52, v190
 v_mfma_f32_16x16x32_bf16 a[8:11], a[232:235], v[200:203], a[8:11]
 v_exp_f32 v194, v194
 v_mfma_f32_16x16x32_bf16 a[12:15], a[236:239], v[200:203], a[12:15]
 v_cvt_pk_bf16_f32 v204, v192, v193
 v_add_f32 v52, v52, v191
 s_waitcnt lgkmcnt(0)
 v_mfma_f32_16x16x32_bf16 a[16:19], a[240:243], v[200:203], a[16:19]
 v_exp_f32 v195, v195
 v_mfma_f32_16x16x32_bf16 a[20:23], a[244:247], v[200:203], a[20:23]
 v_exp_f32 v196, v196
 v_cvt_pk_bf16_f32 v205, v194, v195
 v_mfma_f32_16x16x32_bf16 a[24:27], a[248:251], v[200:203], a[24:27]
 s_cbranch_vccnz L1_only2
 s_add_u32 m0, s94, 4096
 s_nop 0
 buffer_load_dwordx4 v48, s[28:31], s51 offen nt lds
 buffer_load_dwordx4 v49, s[28:31], s51 offen offset:1024 nt lds
 buffer_load_dwordx4 v50, s[28:31], s51 offen offset:2048 nt lds
 buffer_load_dwordx4 v51, s[28:31], s51 offen offset:3072 nt lds
L1_only2:
 v_exp_f32 v197, v197
 v_mfma_f32_16x16x32_bf16 a[28:31], a[252:255], v[200:203], a[28:31]
 v_exp_f32 v198, v198
 v_cvt_pk_bf16_f32 v206, v196, v197
 v_mfma_f32_16x16x32_bf16 v[184:187], a[192:195], v[96:99], v[168:171]
 v_exp_f32 v199, v199
 v_mfma_f32_16x16x32_bf16 v[188:191], a[196:199], v[96:99], v[168:171]
 v_add_f32 v53, v53, v192
 v_cvt_pk_bf16_f32 v207, v198, v199
 v_mfma_f32_16x16x32_bf16 v[184:187], a[200:203], v[104:107], v[184:187]
 v_add_f32 v53, v53, v193
 v_mfma_f32_16x16x32_bf16 v[188:191], a[204:207], v[104:107], v[188:191]
 v_add_f32 v53, v53, v194
 v_add_f32 v53, v53, v195
 v_mfma_f32_16x16x32_bf16 v[184:187], a[208:211], v[112:115], v[184:187]
 v_add_f32 v53, v53, v196
 v_mfma_f32_16x16x32_bf16 v[188:191], a[212:215], v[112:115], v[188:191]
 v_add_f32 v53, v53, v197
 v_add_f32 v53, v53, v198
 v_mfma_f32_16x16x32_bf16 v[184:187], a[216:219], v[120:123], v[184:187]
 v_add_f32 v53, v53, v199
 v_mfma_f32_16x16x32_bf16 v[188:191], a[220:223], v[120:123], v[188:191]
 s_add_u32 s50, s50, 8192
 s_and_b32 s50, s50, 262143
 s_add_u32 s51, s50, 4096
 v_mfma_f32_16x16x32_bf16 a[32:35], a[224:227], v[204:207], a[32:35]
 v_exp_f32 v184, v184
 v_mfma_f32_16x16x32_bf16 a[36:39], a[228:231], v[204:207], a[36:39]
 v_exp_f32 v185, v185
 v_mfma_f32_16x16x32_bf16 a[40:43], a[232:235], v[204:207], a[40:43]
 v_exp_f32 v186, v186
 v_mfma_f32_16x16x32_bf16 a[44:47], a[236:239], v[204:207], a[44:47]
 v_cvt_pk_bf16_f32 v200, v184, v185
 v_add_f32 v54, v54, v185
 v_mfma_f32_16x16x32_bf16 a[48:51], a[240:243], v[204:207], a[48:51]
 v_exp_f32 v187, v187
 v_mfma_f32_16x16x32_bf16 a[52:55], a[244:247], v[204:207], a[52:55]
 v_exp_f32 v188, v188
 v_mfma_f32_16x16x32_bf16 a[56:59], a[248:251], v[204:207], a[56:59]
 v_cvt_pk_bf16_f32 v201, v186, v187
 v_add_f32 v54, v54, v186
 v_mfma_f32_16x16x32_bf16 a[60:63], a[252:255], v[204:207], a[60:63]
 v_exp_f32 v189, v189
 v_mfma_f32_16x16x32_bf16 v[192:195], a[192:195], v[100:103], v[172:175]
 v_exp_f32 v190, v190
 v_mfma_f32_16x16x32_bf16 v[196:199], a[196:199], v[100:103], v[172:175]
 v_cvt_pk_bf16_f32 v202, v188, v189
 v_add_f32 v54, v54, v187
 v_mfma_f32_16x16x32_bf16 v[192:195], a[200:203], v[108:111], v[192:195]
 v_exp_f32 v191, v191
 v_mfma_f32_16x16x32_bf16 v[196:199], a[204:207], v[108:111], v[196:199]
 v_add_f32 v54, v54, v184
 v_cvt_pk_bf16_f32 v203, v190, v191
 v_mfma_f32_16x16x32_bf16 v[192:195], a[208:211], v[116:119], v[192:195]
 v_add_f32 v54, v54, v188
 v_add_f32 v54, v54, v189
 v_mfma_f32_16x16x32_bf16 v[196:199], a[212:215], v[116:119], v[196:199]
 v_add_f32 v54, v54, v190
 v_add_f32 v54, v54, v191
 v_mfma_f32_16x16x32_bf16 v[192:195], a[216:219], v[124:127], v[192:195]
 v_mfma_f32_16x16x32_bf16 v[196:199], a[220:223], v[124:127], v[196:199]
 v_mfma_f32_16x16x32_bf16 a[64:67], a[224:227], v[200:203], a[64:67]
 v_exp_f32 v192, v192
 v_mfma_f32_16x16x32_bf16 a[68:71], a[228:231], v[200:203], a[68:71]
 v_exp_f32 v193, v193
 v_mfma_f32_16x16x32_bf16 a[72:75], a[232:235], v[200:203], a[72:75]
 v_exp_f32 v194, v194
 v_mfma_f32_16x16x32_bf16 a[76:79], a[236:239], v[200:203], a[76:79]
 v_cvt_pk_bf16_f32 v204, v192, v193
 v_add_f32 v55, v55, v193
 v_mfma_f32_16x16x32_bf16 a[80:83], a[240:243], v[200:203], a[80:83]
 v_exp_f32 v195, v195
 v_mfma_f32_16x16x32_bf16 a[84:87], a[244:247], v[200:203], a[84:87]
 v_exp_f32 v196, v196
 v_mfma_f32_16x16x32_bf16 a[88:91], a[248:251], v[200:203], a[88:91]
 v_cvt_pk_bf16_f32 v205, v194, v195
 v_add_f32 v55, v55, v194
 v_mfma_f32_16x16x32_bf16 a[92:95], a[252:255], v[200:203], a[92:95]
 v_exp_f32 v197, v197
 v_mfma_f32_16x16x32_bf16 v[184:187], a[192:195], v[128:131], v[176:179]
 v_exp_f32 v198, v198
 v_mfma_f32_16x16x32_bf16 v[188:191], a[196:199], v[128:131], v[176:179]
 v_cvt_pk_bf16_f32 v206, v196, v197
 v_add_f32 v55, v55, v195
 v_mfma_f32_16x16x32_bf16 v[184:187], a[200:203], v[136:139], v[184:187]
 v_exp_f32 v199, v199
 v_mfma_f32_16x16x32_bf16 v[188:191], a[204:207], v[136:139], v[188:191]
 v_add_f32 v55, v55, v192
 v_cvt_pk_bf16_f32 v207, v198, v199
 v_mfma_f32_16x16x32_bf16 v[184:187], a[208:211], v[144:147], v[184:187]
 v_add_f32 v55, v55, v196
 v_add_f32 v55, v55, v197
 v_mfma_f32_16x16x32_bf16 v[188:191], a[212:215], v[144:147], v[188:191]
 v_add_f32 v55, v55, v198
 v_add_f32 v55, v55, v199
 v_mfma_f32_16x16x32_bf16 v[184:187], a[216:219], v[152:155], v[184:187]
 v_mfma_f32_16x16x32_bf16 v[188:191], a[220:223], v[152:155], v[188:191]
 v_mfma_f32_16x16x32_bf16 a[96:99], a[224:227], v[204:207], a[96:99]
 v_exp_f32 v184, v184
 v_mfma_f32_16x16x32_bf16 a[100:103], a[228:231], v[204:207], a[100:103]
 v_exp_f32 v185, v185
 v_mfma_f32_16x16x32_bf16 a[104:107], a[232:235], v[204:207], a[104:107]
 v_exp_f32 v186, v186
 v_cvt_pk_bf16_f32 v200, v184, v185
 v_mfma_f32_16x16x32_bf16 a[108:111], a[236:239], v[204:207], a[108:111]
 v_exp_f32 v187, v187
 v_add_f32 v56, v56, v185
 v_mfma_f32_16x16x32_bf16 a[112:115], a[240:243], v[204:207], a[112:115]
 v_exp_f32 v188, v188
 v_cvt_pk_bf16_f32 v201, v186, v187
 v_mfma_f32_16x16x32_bf16 a[116:119], a[244:247], v[204:207], a[116:119]
 v_exp_f32 v189, v189
 v_add_f32 v56, v56, v186
 v_mfma_f32_16x16x32_bf16 a[120:123], a[248:251], v[204:207], a[120:123]
 v_exp_f32 v190, v190
 v_cvt_pk_bf16_f32 v202, v188, v189
 v_mfma_f32_16x16x32_bf16 a[124:127], a[252:255], v[204:207], a[124:127]
 v_exp_f32 v191, v191
 v_add_f32 v56, v56, v184
 v_mfma_f32_16x16x32_bf16 v[192:195], a[192:195], v[132:135], v[180:183]
 ds_read_b64 a[192:193], v32 offset:16384
 v_cvt_pk_bf16_f32 v203, v190, v191
 v_add_f32 v56, v56, v187
 v_mfma_f32_16x16x32_bf16 v[196:199], a[196:199], v[132:135], v[180:183]
 ds_read_b64 a[196:197], v32 offset:20480
 v_add_f32 v56, v56, v188
 v_add_f32 v56, v56, v189
 v_mfma_f32_16x16x32_bf16 v[192:195], a[200:203], v[140:143], v[192:195]
 ds_read_b64 a[200:201], v34 offset:16384
 v_add_f32 v56, v56, v190
 v_add_f32 v56, v56, v191
 v_mfma_f32_16x16x32_bf16 v[196:199], a[204:207], v[140:143], v[196:199]
 ds_read_b64 a[204:205], v34 offset:20480
 v_mfma_f32_16x16x32_bf16 v[192:195], a[208:211], v[148:151], v[192:195]
 ds_read_b64 a[194:195], v33 offset:16384
 ds_read_b64 a[208:209], v36 offset:16384
 v_mfma_f32_16x16x32_bf16 v[196:199], a[212:215], v[148:151], v[196:199]
 ds_read_b64 a[198:199], v33 offset:20480
 ds_read_b64 a[212:213], v36 offset:20480
 v_mfma_f32_16x16x32_bf16 v[192:195], a[216:219], v[156:159], v[192:195]
 ds_read_b64 a[202:203], v35 offset:16384
 ds_read_b64 a[216:217], v38 offset:16384
 v_mfma_f32_16x16x32_bf16 v[196:199], a[220:223], v[156:159], v[196:199]
 ds_read_b64 a[206:207], v35 offset:20480
 ds_read_b64 a[220:221], v38 offset:20480
 v_mfma_f32_16x16x32_bf16 a[128:131], a[224:227], v[200:203], a[128:131]
 ds_read_b64 a[210:211], v37 offset:16384
 v_exp_f32 v192, v192
 v_mfma_f32_16x16x32_bf16 a[132:135], a[228:231], v[200:203], a[132:135]
 ds_read_b64 a[214:215], v37 offset:20480
 v_exp_f32 v193, v193
 v_mfma_f32_16x16x32_bf16 a[136:139], a[232:235], v[200:203], a[136:139]
 ds_read_b64 a[218:219], v39 offset:16384
 v_exp_f32 v194, v194
 v_mfma_f32_16x16x32_bf16 a[140:143], a[236:239], v[200:203], a[140:143]
 ds_read_b64 a[222:223], v39 offset:20480
 v_cvt_pk_bf16_f32 v204, v192, v193
 v_add_f32 v57, v57, v193
 v_mfma_f32_16x16x32_bf16 a[144:147], a[240:243], v[200:203], a[144:147]
 v_exp_f32 v195, v195
 v_add_f32 v57, v57, v194
 v_mfma_f32_16x16x32_bf16 a[148:151], a[244:247], v[200:203], a[148:151]
 v_exp_f32 v196, v196
 v_cvt_pk_bf16_f32 v205, v194, v195
 v_mfma_f32_16x16x32_bf16 a[152:155], a[248:251], v[200:203], a[152:155]
 v_exp_f32 v197, v197
 v_add_f32 v57, v57, v195
 v_mfma_f32_16x16x32_bf16 a[156:159], a[252:255], v[200:203], a[156:159]
 v_exp_f32 v198, v198
 s_waitcnt lgkmcnt(5)
 v_mfma_f32_16x16x32_bf16 v[184:187], a[192:195], v[64:67], v[160:163]
 v_cvt_pk_bf16_f32 v206, v196, v197
 v_exp_f32 v199, v199
 v_mfma_f32_16x16x32_bf16 v[188:191], a[196:199], v[64:67], v[160:163]
 v_add_f32 v57, v57, v192
 v_cvt_pk_bf16_f32 v207, v198, v199
 v_add_f32 v57, v57, v196
 v_mfma_f32_16x16x32_bf16 v[184:187], a[200:203], v[72:75], v[184:187]
 v_add_f32 v57, v57, v197
 v_add_f32 v57, v57, v198
 v_add_f32 v57, v57, v199
 v_mfma_f32_16x16x32_bf16 v[188:191], a[204:207], v[72:75], v[188:191]
 s_waitcnt lgkmcnt(0)
 v_mfma_f32_16x16x32_bf16 v[184:187], a[208:211], v[80:83], v[184:187]
 v_mfma_f32_16x16x32_bf16 v[188:191], a[212:215], v[80:83], v[188:191]
 v_mfma_f32_16x16x32_bf16 v[184:187], a[216:219], v[88:91], v[184:187]
 s_add_u32 m0, s95, 0
 v_mfma_f32_16x16x32_bf16 v[188:191], a[220:223], v[88:91], v[188:191]
 s_barrier
 v_mfma_f32_16x16x32_bf16 a[160:163], a[224:227], v[204:207], a[160:163]
 ds_read_b64_tr_b16 a[224:225], v40 offset:16384
 v_exp_f32 v184, v184
 v_mfma_f32_16x16x32_bf16 a[164:167], a[228:231], v[204:207], a[164:167]
 ds_read_b64_tr_b16 a[228:229], v41 offset:16384
 v_exp_f32 v185, v185
 v_mfma_f32_16x16x32_bf16 a[168:171], a[232:235], v[204:207], a[168:171]
 ds_read_b64_tr_b16 a[232:233], v42 offset:16384
 v_exp_f32 v186, v186
 v_mfma_f32_16x16x32_bf16 a[172:175], a[236:239], v[204:207], a[172:175]
 ds_read_b64_tr_b16 a[236:237], v43 offset:16384
 v_cvt_pk_bf16_f32 v200, v184, v185
 v_add_f32 v52, v52, v185
 v_mfma_f32_16x16x32_bf16 a[176:179], a[240:243], v[204:207], a[176:179]
 ds_read_b64_tr_b16 a[226:227], v40 offset:20480
 ds_read_b64_tr_b16 a[240:241], v44 offset:16384
 v_add_f32 v52, v52, v186
 v_mfma_f32_16x16x32_bf16 a[180:183], a[244:247], v[204:207], a[180:183]
 ds_read_b64_tr_b16 a[230:231], v41 offset:20480
 ds_read_b64_tr_b16 a[244:245], v45 offset:16384
 v_mfma_f32_16x16x32_bf16 a[184:187], a[248:251], v[204:207], a[184:187]
 ds_read_b64_tr_b16 a[234:235], v42 offset:20480
 ds_read_b64_tr_b16 a[248:249], v46 offset:16384
 v_mfma_f32_16x16x32_bf16 a[188:191], a[252:255], v[204:207], a[188:191]
 ds_read_b64_tr_b16 a[238:239], v43 offset:20480
 ds_read_b64_tr_b16 a[252:253], v47 offset:16384
 v_mfma_f32_16x16x32_bf16 v[192:195], a[192:195], v[68:71], v[164:167]
 ds_read_b64_tr_b16 a[242:243], v44 offset:20480
 v_exp_f32 v187, v187
 v_mfma_f32_16x16x32_bf16 v[196:199], a[196:199], v[68:71], v[164:167]
 ds_read_b64_tr_b16 a[246:247], v45 offset:20480
 v_exp_f32 v188, v188
 v_mfma_f32_16x16x32_bf16 v[192:195], a[200:203], v[76:79], v[192:195]
 ds_read_b64_tr_b16 a[250:251], v46 offset:20480
 v_cvt_pk_bf16_f32 v201, v186, v187
 v_add_f32 v52, v52, v187
 v_mfma_f32_16x16x32_bf16 v[196:199], a[204:207], v[76:79], v[196:199]
 ds_read_b64_tr_b16 a[254:255], v47 offset:20480
 v_exp_f32 v189, v189
 v_mfma_f32_16x16x32_bf16 v[192:195], a[208:211], v[84:87], v[192:195]
 buffer_load_dwordx4 v48, s[28:31], s50 offen nt lds
 v_exp_f32 v190, v190
 v_mfma_f32_16x16x32_bf16 v[196:199], a[212:215], v[84:87], v[196:199]
 v_cvt_pk_bf16_f32 v202, v188, v189
 v_exp_f32 v191, v191
 v_mfma_f32_16x16x32_bf16 v[192:195], a[216:219], v[92:95], v[192:195]
 buffer_load_dwordx4 v49, s[28:31], s50 offen offset:1024 nt lds
 v_add_f32 v52, v52, v184
 v_cvt_pk_bf16_f32 v203, v190, v191
 v_mfma_f32_16x16x32_bf16 v[196:199], a[220:223], v[92:95], v[196:199]
 v_add_f32 v52, v52, v188
 v_add_f32 v52, v52, v189
 s_waitcnt lgkmcnt(5)
 v_mfma_f32_16x16x32_bf16 a[0:3], a[224:227], v[200:203], a[0:3]
 buffer_load_dwordx4 v50, s[28:31], s50 offen offset:2048 nt lds
 v_exp_f32 v192, v192
 v_mfma_f32_16x16x32_bf16 a[4:7], a[228:231], v[200:203], a[4:7]
 v_exp_f32 v193, v193
 v_add_f32 v52, v52, v190
 v_mfma_f32_16x16x32_bf16 a[8:11], a[232:235], v[200:203], a[8:11]
 buffer_load_dwordx4 v51, s[28:31], s50 offen offset:3072 nt lds
 v_exp_f32 v194, v194
 v_mfma_f32_16x16x32_bf16 a[12:15], a[236:239], v[200:203], a[12:15]
 v_cvt_pk_bf16_f32 v204, v192, v193
 v_add_f32 v52, v52, v191
 s_waitcnt lgkmcnt(0)
 v_mfma_f32_16x16x32_bf16 a[16:19], a[240:243], v[200:203], a[16:19]
 s_add_u32 m0, s95, 4096
 v_exp_f32 v195, v195
 v_mfma_f32_16x16x32_bf16 a[20:23], a[244:247], v[200:203], a[20:23]
 v_exp_f32 v196, v196
 v_cvt_pk_bf16_f32 v205, v194, v195
 v_mfma_f32_16x16x32_bf16 a[24:27], a[248:251], v[200:203], a[24:27]
 buffer_load_dwordx4 v48, s[28:31], s51 offen nt lds
 s_and_b32 s75, s2, 7
 s_lshr_b32 s48, s2, 3
 v_exp_f32 v197, v197
 v_mfma_f32_16x16x32_bf16 a[28:31], a[252:255], v[200:203], a[28:31]
 v_exp_f32 v198, v198
 v_cvt_pk_bf16_f32 v206, v196, v197
 v_mfma_f32_16x16x32_bf16 v[184:187], a[192:195], v[96:99], v[168:171]
 buffer_load_dwordx4 v49, s[28:31], s51 offen offset:1024 nt lds
 s_lshr_b32 s49, s75, 1
 v_exp_f32 v199, v199
 v_mfma_f32_16x16x32_bf16 v[188:191], a[196:199], v[96:99], v[168:171]
 v_add_f32 v53, v53, v192
 v_cvt_pk_bf16_f32 v207, v198, v199
 v_mfma_f32_16x16x32_bf16 v[184:187], a[200:203], v[104:107], v[184:187]
 buffer_load_dwordx4 v50, s[28:31], s51 offen offset:2048 nt lds
 s_lshl_b32 s49, s49, 3
 s_and_b32 s46, s48, 7
 v_add_f32 v53, v53, v193
 v_mfma_f32_16x16x32_bf16 v[188:191], a[204:207], v[104:107], v[188:191]
 v_add_f32 v53, v53, v194
 v_add_f32 v53, v53, v195
 v_mfma_f32_16x16x32_bf16 v[184:187], a[208:211], v[112:115], v[184:187]
 buffer_load_dwordx4 v51, s[28:31], s51 offen offset:3072 nt lds
 s_add_u32 s46, s49, s46
 v_add_f32 v53, v53, v196
 v_mfma_f32_16x16x32_bf16 v[188:191], a[212:215], v[112:115], v[188:191]
 v_add_f32 v53, v53, v197
 v_add_f32 v53, v53, v198
 v_mfma_f32_16x16x32_bf16 v[184:187], a[216:219], v[120:123], v[184:187]
 s_and_b32 s49, s75, 1
 v_add_f32 v53, v53, v199
 v_mfma_f32_16x16x32_bf16 v[188:191], a[220:223], v[120:123], v[188:191]
 s_add_u32 s50, s50, 8192
 s_and_b32 s50, s50, 262143
 s_add_u32 s51, s50, 4096
 v_mfma_f32_16x16x32_bf16 a[32:35], a[224:227], v[204:207], a[32:35]
 s_lshl_b32 s49, s49, 2
 s_lshr_b32 s47, s48, 3
 v_exp_f32 v184, v184
 v_mfma_f32_16x16x32_bf16 a[36:39], a[228:231], v[204:207], a[36:39]
 v_exp_f32 v185, v185
 v_mfma_f32_16x16x32_bf16 a[40:43], a[232:235], v[204:207], a[40:43]
 s_add_u32 s47, s47, s49
 v_exp_f32 v186, v186
 v_mfma_f32_16x16x32_bf16 a[44:47], a[236:239], v[204:207], a[44:47]
 v_cvt_pk_bf16_f32 v200, v184, v185
 v_add_f32 v54, v54, v185
 v_mfma_f32_16x16x32_bf16 a[48:51], a[240:243], v[204:207], a[48:51]
 s_lshl_b32 s47, s47, 2
 s_lshr_b32 s47, 0x76345210, s47
 v_exp_f32 v187, v187
 v_mfma_f32_16x16x32_bf16 a[52:55], a[244:247], v[204:207], a[52:55]
 v_exp_f32 v188, v188
 v_mfma_f32_16x16x32_bf16 a[56:59], a[248:251], v[204:207], a[56:59]
 s_and_b32 s47, s47, 7
 v_cvt_pk_bf16_f32 v201, v186, v187
 v_add_f32 v54, v54, v186
 v_mfma_f32_16x16x32_bf16 a[60:63], a[252:255], v[204:207], a[60:63]
 v_exp_f32 v189, v189
 v_mfma_f32_16x16x32_bf16 v[192:195], a[192:195], v[100:103], v[172:175]
 v_lshrrev_b32 v12, 4, v1
 v_exp_f32 v190, v190
 v_mfma_f32_16x16x32_bf16 v[196:199], a[196:199], v[100:103], v[172:175]
 v_cvt_pk_bf16_f32 v202, v188, v189
 v_add_f32 v54, v54, v187
 v_mfma_f32_16x16x32_bf16 v[192:195], a[200:203], v[108:111], v[192:195]
 buffer_load_dword v63, v0, s[88:91], 0 offen sc1
 v_and_b32 v11, 15, v1
 v_lshlrev_b32 v13, 1, v12
 v_exp_f32 v191, v191
 v_mfma_f32_16x16x32_bf16 v[196:199], a[204:207], v[108:111], v[196:199]
 v_add_f32 v54, v54, v184
 v_cvt_pk_bf16_f32 v203, v190, v191
 v_mfma_f32_16x16x32_bf16 v[192:195], a[208:211], v[116:119], v[192:195]
 v_xor_b32 v11, v11, v13
 v_add_f32 v54, v54, v188
 v_add_f32 v54, v54, v189
 v_mfma_f32_16x16x32_bf16 v[196:199], a[212:215], v[116:119], v[196:199]
 v_add_f32 v54, v54, v190
 v_add_f32 v54, v54, v191
 v_mfma_f32_16x16x32_bf16 v[192:195], a[216:219], v[124:127], v[192:195]
 v_lshlrev_b32 v10, 11, v12
 v_lshl_add_u32 v18, v11, 4, v10
 v_mfma_f32_16x16x32_bf16 v[196:199], a[220:223], v[124:127], v[196:199]
 v_mfma_f32_16x16x32_bf16 a[64:67], a[224:227], v[200:203], a[64:67]
 v_xor_b32 v11, 128, v18
 v_exp_f32 v192, v192
 v_mfma_f32_16x16x32_bf16 a[68:71], a[228:231], v[200:203], a[68:71]
 v_exp_f32 v193, v193
 v_mfma_f32_16x16x32_bf16 a[72:75], a[232:235], v[200:203], a[72:75]
 v_add_u32 v19, 7168, v11
 v_exp_f32 v194, v194
 v_mfma_f32_16x16x32_bf16 a[76:79], a[236:239], v[200:203], a[76:79]
 v_cvt_pk_bf16_f32 v204, v192, v193
 v_add_f32 v55, v55, v193
 v_mfma_f32_16x16x32_bf16 a[80:83], a[240:243], v[200:203], a[80:83]
 v_add_u32 v20, 14336, v18
 v_add_u32 v21, 21504, v11
 v_exp_f32 v195, v195
 v_mfma_f32_16x16x32_bf16 a[84:87], a[244:247], v[200:203], a[84:87]
 v_exp_f32 v196, v196
 v_mfma_f32_16x16x32_bf16 a[88:91], a[248:251], v[200:203], a[88:91]
 v_add_u32 v22, 32768, v18
 v_cvt_pk_bf16_f32 v205, v194, v195
 v_add_f32 v55, v55, v194
 v_mfma_f32_16x16x32_bf16 a[92:95], a[252:255], v[200:203], a[92:95]
 v_exp_f32 v197, v197
 v_mfma_f32_16x16x32_bf16 v[184:187], a[192:195], v[128:131], v[176:179]
 v_add_u32 v23, 39936, v11
 v_add_u32 v24, 47104, v18
 v_exp_f32 v198, v198
 v_mfma_f32_16x16x32_bf16 v[188:191], a[196:199], v[128:131], v[176:179]
 v_cvt_pk_bf16_f32 v206, v196, v197
 v_add_f32 v55, v55, v195
 v_mfma_f32_16x16x32_bf16 v[184:187], a[200:203], v[136:139], v[184:187]
 v_add_u32 v25, 54272, v11
 v_exp_f32 v199, v199
 v_mfma_f32_16x16x32_bf16 v[188:191], a[204:207], v[136:139], v[188:191]
 v_add_f32 v55, v55, v192
 v_cvt_pk_bf16_f32 v207, v198, v199
 v_mfma_f32_16x16x32_bf16 v[184:187], a[208:211], v[144:147], v[184:187]
 s_mul_i32 s74, s36, 8192
 v_add_f32 v55, v55, v196
 v_add_f32 v55, v55, v197
 v_mfma_f32_16x16x32_bf16 v[188:191], a[212:215], v[144:147], v[188:191]
 v_add_f32 v55, v55, v198
 v_add_f32 v55, v55, v199
 v_mfma_f32_16x16x32_bf16 v[184:187], a[216:219], v[152:155], v[184:187]
 s_lshl_b32 s76, s36, 20
 s_lshl_b32 s77, s36, 15
 v_mfma_f32_16x16x32_bf16 v[188:191], a[220:223], v[152:155], v[188:191]
 v_mfma_f32_16x16x32_bf16 a[96:99], a[224:227], v[204:207], a[96:99]
 s_lshl_b32 s48, s47, 8
 v_exp_f32 v184, v184
 v_mfma_f32_16x16x32_bf16 a[100:103], a[228:231], v[204:207], a[100:103]
 v_exp_f32 v185, v185
 v_mfma_f32_16x16x32_bf16 a[104:107], a[232:235], v[204:207], a[104:107]
 s_add_u32 s20, s12, s48
 s_addc_u32 s21, s13, 0
 v_exp_f32 v186, v186
 v_cvt_pk_bf16_f32 v200, v184, v185
 v_mfma_f32_16x16x32_bf16 a[108:111], a[236:239], v[204:207], a[108:111]
 v_exp_f32 v187, v187
 v_add_f32 v56, v56, v185
 v_mfma_f32_16x16x32_bf16 a[112:115], a[240:243], v[204:207], a[112:115]
 s_sub_u32 s22, 8388608, s48
 s_mov_b32 s23, 0x20000
 v_exp_f32 v188, v188
 v_cvt_pk_bf16_f32 v201, v186, v187
 v_mfma_f32_16x16x32_bf16 a[116:119], a[244:247], v[204:207], a[116:119]
 v_exp_f32 v189, v189
 v_add_f32 v56, v56, v186
 v_mfma_f32_16x16x32_bf16 a[120:123], a[248:251], v[204:207], a[120:123]
 s_mov_b32 s24, s18
 v_exp_f32 v190, v190
 v_cvt_pk_bf16_f32 v202, v188, v189
 v_mfma_f32_16x16x32_bf16 a[124:127], a[252:255], v[204:207], a[124:127]
 v_exp_f32 v191, v191
 v_add_f32 v56, v56, v184
 v_mfma_f32_16x16x32_bf16 v[192:195], a[192:195], v[132:135], v[180:183]
 ds_read_b64 a[192:193], v32 offset:32768
 s_mov_b32 s25, s19
 s_mov_b32 s26, 25165824
 v_cvt_pk_bf16_f32 v203, v190, v191
 v_add_f32 v56, v56, v187
 v_mfma_f32_16x16x32_bf16 v[196:199], a[196:199], v[132:135], v[180:183]
 ds_read_b64 a[196:197], v32 offset:36864
 v_add_f32 v56, v56, v188
 v_add_f32 v56, v56, v189
 v_mfma_f32_16x16x32_bf16 v[192:195], a[200:203], v[140:143], v[192:195]
 ds_read_b64 a[200:201], v34 offset:32768
 s_mov_b32 s27, 0x20000
 v_add_f32 v56, v56, v190
 v_add_f32 v56, v56, v191
 v_mfma_f32_16x16x32_bf16 v[196:199], a[204:207], v[140:143], v[196:199]
 ds_read_b64 a[204:205], v34 offset:36864
 v_mfma_f32_16x16x32_bf16 v[192:195], a[208:211], v[148:151], v[192:195]
 ds_read_b64 a[194:195], v33 offset:32768
 ds_read_b64 a[208:209], v36 offset:32768
 s_mul_i32 s48, s46, 786432
 v_mfma_f32_16x16x32_bf16 v[196:199], a[212:215], v[148:151], v[196:199]
 ds_read_b64 a[198:199], v33 offset:36864
 ds_read_b64 a[212:213], v36 offset:36864
 v_mfma_f32_16x16x32_bf16 v[192:195], a[216:219], v[156:159], v[192:195]
 ds_read_b64 a[202:203], v35 offset:32768
 ds_read_b64 a[216:217], v38 offset:32768
 v_lshlrev_b32 v4, 4, v1
 v_add_u32 v26, s48, v4
 v_mfma_f32_16x16x32_bf16 v[196:199], a[220:223], v[156:159], v[196:199]
 ds_read_b64 a[206:207], v35 offset:36864
 ds_read_b64 a[220:221], v38 offset:36864
 v_mfma_f32_16x16x32_bf16 a[128:131], a[224:227], v[200:203], a[128:131]
 ds_read_b64 a[210:211], v37 offset:32768
 v_add_u32 v27, 131072, v26
 v_exp_f32 v192, v192
 v_mfma_f32_16x16x32_bf16 a[132:135], a[228:231], v[200:203], a[132:135]
 ds_read_b64 a[214:215], v37 offset:36864
 v_exp_f32 v193, v193
 v_mfma_f32_16x16x32_bf16 a[136:139], a[232:235], v[200:203], a[136:139]
 ds_read_b64 a[218:219], v39 offset:32768
 v_add_u32 v28, 262144, v26
 v_add_u32 v29, 393216, v26
 v_exp_f32 v194, v194
 v_mfma_f32_16x16x32_bf16 a[140:143], a[236:239], v[200:203], a[140:143]
 ds_read_b64 a[222:223], v39 offset:36864
 v_cvt_pk_bf16_f32 v204, v192, v193
 v_add_f32 v57, v57, v193
 v_mfma_f32_16x16x32_bf16 a[144:147], a[240:243], v[200:203], a[144:147]
 v_add_u32 v30, 524288, v26
 v_exp_f32 v195, v195
 v_add_f32 v57, v57, v194
 v_mfma_f32_16x16x32_bf16 a[148:151], a[244:247], v[200:203], a[148:151]
 v_exp_f32 v196, v196
 v_cvt_pk_bf16_f32 v205, v194, v195
 v_mfma_f32_16x16x32_bf16 a[152:155], a[248:251], v[200:203], a[152:155]
 v_exp_f32 v197, v197
 v_add_f32 v57, v57, v195
 v_mfma_f32_16x16x32_bf16 a[156:159], a[252:255], v[200:203], a[156:159]
 v_exp_f32 v198, v198
 s_waitcnt lgkmcnt(5)
 v_mfma_f32_16x16x32_bf16 v[184:187], a[192:195], v[64:67], v[160:163]
 v_cvt_pk_bf16_f32 v206, v196, v197
 v_exp_f32 v199, v199
 v_mfma_f32_16x16x32_bf16 v[188:191], a[196:199], v[64:67], v[160:163]
 v_add_f32 v57, v57, v192
 v_cvt_pk_bf16_f32 v207, v198, v199
 v_add_f32 v57, v57, v196
 v_mfma_f32_16x16x32_bf16 v[184:187], a[200:203], v[72:75], v[184:187]
 v_add_f32 v57, v57, v197
 v_add_f32 v57, v57, v198
 v_add_f32 v57, v57, v199
 v_mfma_f32_16x16x32_bf16 v[188:191], a[204:207], v[72:75], v[188:191]
 s_waitcnt lgkmcnt(0)
 v_mfma_f32_16x16x32_bf16 v[184:187], a[208:211], v[80:83], v[184:187]
 v_mfma_f32_16x16x32_bf16 v[188:191], a[212:215], v[80:83], v[188:191]
 v_mfma_f32_16x16x32_bf16 v[184:187], a[216:219], v[88:91], v[184:187]
 s_add_u32 m0, s96, 0
 v_mfma_f32_16x16x32_bf16 v[188:191], a[220:223], v[88:91], v[188:191]
 s_barrier
 v_mfma_f32_16x16x32_bf16 a[160:163], a[224:227], v[204:207], a[160:163]
 ds_read_b64_tr_b16 a[224:225], v40 offset:32768
 v_exp_f32 v184, v184
 v_mfma_f32_16x16x32_bf16 a[164:167], a[228:231], v[204:207], a[164:167]
 ds_read_b64_tr_b16 a[228:229], v41 offset:32768
 v_exp_f32 v185, v185
 v_mfma_f32_16x16x32_bf16 a[168:171], a[232:235], v[204:207], a[168:171]
 ds_read_b64_tr_b16 a[232:233], v42 offset:32768
 v_exp_f32 v186, v186
 v_mfma_f32_16x16x32_bf16 a[172:175], a[236:239], v[204:207], a[172:175]
 ds_read_b64_tr_b16 a[236:237], v43 offset:32768
 v_cvt_pk_bf16_f32 v200, v184, v185
 v_add_f32 v52, v52, v185
 v_mfma_f32_16x16x32_bf16 a[176:179], a[240:243], v[204:207], a[176:179]
 ds_read_b64_tr_b16 a[226:227], v40 offset:36864
 ds_read_b64_tr_b16 a[240:241], v44 offset:32768
 v_add_f32 v52, v52, v186
 v_mfma_f32_16x16x32_bf16 a[180:183], a[244:247], v[204:207], a[180:183]
 ds_read_b64_tr_b16 a[230:231], v41 offset:36864
 ds_read_b64_tr_b16 a[244:245], v45 offset:32768
 v_mfma_f32_16x16x32_bf16 a[184:187], a[248:251], v[204:207], a[184:187]
 ds_read_b64_tr_b16 a[234:235], v42 offset:36864
 ds_read_b64_tr_b16 a[248:249], v46 offset:32768
 v_mfma_f32_16x16x32_bf16 a[188:191], a[252:255], v[204:207], a[188:191]
 ds_read_b64_tr_b16 a[238:239], v43 offset:36864
 ds_read_b64_tr_b16 a[252:253], v47 offset:32768
 v_mfma_f32_16x16x32_bf16 v[192:195], a[192:195], v[68:71], v[164:167]
 ds_read_b64_tr_b16 a[242:243], v44 offset:36864
 v_exp_f32 v187, v187
 v_mfma_f32_16x16x32_bf16 v[196:199], a[196:199], v[68:71], v[164:167]
 ds_read_b64_tr_b16 a[246:247], v45 offset:36864
 v_exp_f32 v188, v188
 v_mfma_f32_16x16x32_bf16 v[192:195], a[200:203], v[76:79], v[192:195]
 ds_read_b64_tr_b16 a[250:251], v46 offset:36864
 v_cvt_pk_bf16_f32 v201, v186, v187
 v_add_f32 v52, v52, v187
 v_mfma_f32_16x16x32_bf16 v[196:199], a[204:207], v[76:79], v[196:199]
 ds_read_b64_tr_b16 a[254:255], v47 offset:36864
 v_exp_f32 v189, v189
 v_mfma_f32_16x16x32_bf16 v[192:195], a[208:211], v[84:87], v[192:195]
 buffer_load_dwordx4 v48, s[28:31], s50 offen nt lds
 v_exp_f32 v190, v190
 v_mfma_f32_16x16x32_bf16 v[196:199], a[212:215], v[84:87], v[196:199]
 v_cvt_pk_bf16_f32 v202, v188, v189
 v_exp_f32 v191, v191
 v_mfma_f32_16x16x32_bf16 v[192:195], a[216:219], v[92:95], v[192:195]
 buffer_load_dwordx4 v49, s[28:31], s50 offen offset:1024 nt lds
 v_add_f32 v52, v52, v184
 v_cvt_pk_bf16_f32 v203, v190, v191
 v_mfma_f32_16x16x32_bf16 v[196:199], a[220:223], v[92:95], v[196:199]
 v_add_f32 v52, v52, v188
 v_add_f32 v52, v52, v189
 s_waitcnt lgkmcnt(5)
 v_mfma_f32_16x16x32_bf16 a[0:3], a[224:227], v[200:203], a[0:3]
 buffer_load_dwordx4 v50, s[28:31], s50 offen offset:2048 nt lds
 v_exp_f32 v192, v192
 v_mfma_f32_16x16x32_bf16 a[4:7], a[228:231], v[200:203], a[4:7]
 v_exp_f32 v193, v193
 v_add_f32 v52, v52, v190
 v_mfma_f32_16x16x32_bf16 a[8:11], a[232:235], v[200:203], a[8:11]
 buffer_load_dwordx4 v51, s[28:31], s50 offen offset:3072 nt lds
 v_exp_f32 v194, v194
 v_mfma_f32_16x16x32_bf16 a[12:15], a[236:239], v[200:203], a[12:15]
 v_cvt_pk_bf16_f32 v204, v192, v193
 v_add_f32 v52, v52, v191
 s_waitcnt lgkmcnt(0)
 v_mfma_f32_16x16x32_bf16 a[16:19], a[240:243], v[200:203], a[16:19]
 s_add_u32 m0, s96, 4096
 v_exp_f32 v195, v195
 v_mfma_f32_16x16x32_bf16 a[20:23], a[244:247], v[200:203], a[20:23]
 v_exp_f32 v196, v196
 v_cvt_pk_bf16_f32 v205, v194, v195
 v_mfma_f32_16x16x32_bf16 a[24:27], a[248:251], v[200:203], a[24:27]
 buffer_load_dwordx4 v48, s[28:31], s51 offen nt lds
 v_add_u32 v31, 655360, v26
 v_exp_f32 v197, v197
 v_mfma_f32_16x16x32_bf16 a[28:31], a[252:255], v[200:203], a[28:31]
 v_exp_f32 v198, v198
 v_cvt_pk_bf16_f32 v206, v196, v197
 v_mfma_f32_16x16x32_bf16 v[184:187], a[192:195], v[96:99], v[168:171]
 buffer_load_dwordx4 v49, s[28:31], s51 offen offset:1024 nt lds
 v_lshrrev_b32 v5, 4, v1
 v_lshrrev_b32 v6, 2, v1
 v_exp_f32 v199, v199
 v_mfma_f32_16x16x32_bf16 v[188:191], a[196:199], v[96:99], v[168:171]
 v_add_f32 v53, v53, v192
 v_cvt_pk_bf16_f32 v207, v198, v199
 v_mfma_f32_16x16x32_bf16 v[184:187], a[200:203], v[104:107], v[184:187]
 buffer_load_dwordx4 v50, s[28:31], s51 offen offset:2048 nt lds
 v_and_b32 v7, 3, v1
 v_add_f32 v53, v53, v193
 v_mfma_f32_16x16x32_bf16 v[188:191], a[204:207], v[104:107], v[188:191]
 v_add_f32 v53, v53, v194
 v_add_f32 v53, v53, v195
 v_mfma_f32_16x16x32_bf16 v[184:187], a[208:211], v[112:115], v[184:187]
 buffer_load_dwordx4 v51, s[28:31], s51 offen offset:3072 nt lds
 v_and_b32 v9, 7, v6
 v_lshlrev_b32 v8, 8, v6
 v_add_f32 v53, v53, v196
 v_mfma_f32_16x16x32_bf16 v[188:191], a[212:215], v[112:115], v[188:191]
 v_add_f32 v53, v53, v197
 v_add_f32 v53, v53, v198
 v_mfma_f32_16x16x32_bf16 v[184:187], a[216:219], v[120:123], v[184:187]
 v_add_u32 v8, s74, v8
 v_add_f32 v53, v53, v199
 v_mfma_f32_16x16x32_bf16 v[188:191], a[220:223], v[120:123], v[188:191]
 s_add_u32 s50, s50, 8192
 s_and_b32 s50, s50, 262143
 s_add_u32 s51, s50, 4096
 v_mfma_f32_16x16x32_bf16 a[32:35], a[224:227], v[204:207], a[32:35]
 v_lshl_add_u32 v8, v7, 3, v8
 v_exp_f32 v184, v184
 v_mfma_f32_16x16x32_bf16 a[36:39], a[228:231], v[204:207], a[36:39]
 v_exp_f32 v185, v185
 v_mfma_f32_16x16x32_bf16 a[40:43], a[232:235], v[204:207], a[40:43]
 v_lshl_add_u32 v8, v9, 5, v8
 v_add_u32 v8, 98304, v8
 v_exp_f32 v186, v186
 v_mfma_f32_16x16x32_bf16 a[44:47], a[236:239], v[204:207], a[44:47]
 v_cvt_pk_bf16_f32 v200, v184, v185
 v_add_f32 v54, v54, v185
 v_mfma_f32_16x16x32_bf16 a[48:51], a[240:243], v[204:207], a[48:51]
 s_add_u32 s48, s36, 0
 v_exp_f32 v187, v187
 v_mfma_f32_16x16x32_bf16 a[52:55], a[244:247], v[204:207], a[52:55]
 v_exp_f32 v188, v188
 v_mfma_f32_16x16x32_bf16 a[56:59], a[248:251], v[204:207], a[56:59]
 s_and_b32 s48, s48, 3
 s_lshl_b32 s48, s48, 6
 v_cvt_pk_bf16_f32 v201, v186, v187
 v_add_f32 v54, v54, v186
 v_mfma_f32_16x16x32_bf16 a[60:63], a[252:255], v[204:207], a[60:63]
 v_exp_f32 v189, v189
 v_mfma_f32_16x16x32_bf16 v[192:195], a[192:195], v[100:103], v[172:175]
 v_xor_b32 v10, s48, v8
 v_exp_f32 v190, v190
 v_mfma_f32_16x16x32_bf16 v[196:199], a[196:199], v[100:103], v[172:175]
 v_cvt_pk_bf16_f32 v202, v188, v189
 v_add_f32 v54, v54, v187
 v_mfma_f32_16x16x32_bf16 v[192:195], a[200:203], v[108:111], v[192:195]
 v_xor_b32 v11, 32, v10
 v_exp_f32 v191, v191
 v_mfma_f32_16x16x32_bf16 v[196:199], a[204:207], v[108:111], v[196:199]
 v_add_f32 v54, v54, v184
 v_cvt_pk_bf16_f32 v203, v190, v191
 v_mfma_f32_16x16x32_bf16 v[192:195], a[208:211], v[116:119], v[192:195]
 s_add_u32 s48, s36, 1
 s_and_b32 s48, s48, 3
 v_add_f32 v54, v54, v188
 v_add_f32 v54, v54, v189
 v_mfma_f32_16x16x32_bf16 v[196:199], a[212:215], v[116:119], v[196:199]
 v_add_f32 v54, v54, v190
 v_add_f32 v54, v54, v191
 v_mfma_f32_16x16x32_bf16 v[192:195], a[216:219], v[124:127], v[192:195]
 s_lshl_b32 s48, s48, 6
 v_mfma_f32_16x16x32_bf16 v[196:199], a[220:223], v[124:127], v[196:199]
 v_mfma_f32_16x16x32_bf16 a[64:67], a[224:227], v[200:203], a[64:67]
 v_xor_b32 v12, s48, v8
 v_exp_f32 v192, v192
 v_mfma_f32_16x16x32_bf16 a[68:71], a[228:231], v[200:203], a[68:71]
 v_exp_f32 v193, v193
 v_mfma_f32_16x16x32_bf16 a[72:75], a[232:235], v[200:203], a[72:75]
 v_xor_b32 v13, 32, v12
 s_add_u32 s48, s36, 2
 v_exp_f32 v194, v194
 v_mfma_f32_16x16x32_bf16 a[76:79], a[236:239], v[200:203], a[76:79]
 v_cvt_pk_bf16_f32 v204, v192, v193
 v_add_f32 v55, v55, v193
 v_mfma_f32_16x16x32_bf16 a[80:83], a[240:243], v[200:203], a[80:83]
 s_and_b32 s48, s48, 3
 v_exp_f32 v195, v195
 v_mfma_f32_16x16x32_bf16 a[84:87], a[244:247], v[200:203], a[84:87]
 v_exp_f32 v196, v196
 v_mfma_f32_16x16x32_bf16 a[88:91], a[248:251], v[200:203], a[88:91]
 s_lshl_b32 s48, s48, 6
 v_xor_b32 v14, s48, v8
 v_cvt_pk_bf16_f32 v205, v194, v195
 v_add_f32 v55, v55, v194
 v_mfma_f32_16x16x32_bf16 a[92:95], a[252:255], v[200:203], a[92:95]
 v_exp_f32 v197, v197
 v_mfma_f32_16x16x32_bf16 v[184:187], a[192:195], v[128:131], v[176:179]
 v_xor_b32 v15, 32, v14
 v_exp_f32 v198, v198
 v_mfma_f32_16x16x32_bf16 v[188:191], a[196:199], v[128:131], v[176:179]
 v_cvt_pk_bf16_f32 v206, v196, v197
 v_add_f32 v55, v55, v195
 v_mfma_f32_16x16x32_bf16 v[184:187], a[200:203], v[136:139], v[184:187]
 s_add_u32 s48, s36, 3
 v_exp_f32 v199, v199
 v_mfma_f32_16x16x32_bf16 v[188:191], a[204:207], v[136:139], v[188:191]
 v_add_f32 v55, v55, v192
 v_cvt_pk_bf16_f32 v207, v198, v199
 v_mfma_f32_16x16x32_bf16 v[184:187], a[208:211], v[144:147], v[184:187]
 s_and_b32 s48, s48, 3
 s_lshl_b32 s48, s48, 6
 v_add_f32 v55, v55, v196
 v_add_f32 v55, v55, v197
 v_mfma_f32_16x16x32_bf16 v[188:191], a[212:215], v[144:147], v[188:191]
 v_add_f32 v55, v55, v198
 v_add_f32 v55, v55, v199
 v_mfma_f32_16x16x32_bf16 v[184:187], a[216:219], v[152:155], v[184:187]
 v_xor_b32 v16, s48, v8
 v_mfma_f32_16x16x32_bf16 v[188:191], a[220:223], v[152:155], v[188:191]
 v_mfma_f32_16x16x32_bf16 a[96:99], a[224:227], v[204:207], a[96:99]
 v_xor_b32 v17, 32, v16
 v_mov_b32 v252, 0
 v_exp_f32 v184, v184
 v_mfma_f32_16x16x32_bf16 a[100:103], a[228:231], v[204:207], a[100:103]
 v_exp_f32 v185, v185
 v_mfma_f32_16x16x32_bf16 a[104:107], a[232:235], v[204:207], a[104:107]
 v_mov_b32 v253, 0
 v_exp_f32 v186, v186
 v_cvt_pk_bf16_f32 v200, v184, v185
 v_mfma_f32_16x16x32_bf16 a[108:111], a[236:239], v[204:207], a[108:111]
 v_exp_f32 v187, v187
 v_add_f32 v56, v56, v185
 v_mfma_f32_16x16x32_bf16 a[112:115], a[240:243], v[204:207], a[112:115]
 v_mov_b32 v254, 0
 v_exp_f32 v188, v188
 v_cvt_pk_bf16_f32 v201, v186, v187
 v_mfma_f32_16x16x32_bf16 a[116:119], a[244:247], v[204:207], a[116:119]
 v_exp_f32 v189, v189
 v_add_f32 v56, v56, v186
 v_mfma_f32_16x16x32_bf16 a[120:123], a[248:251], v[204:207], a[120:123]
 v_mov_b32 v255, 0
 s_lshr_b32 s48, s46, 1
 v_exp_f32 v190, v190
 v_cvt_pk_bf16_f32 v202, v188, v189
 v_mfma_f32_16x16x32_bf16 a[124:127], a[252:255], v[204:207], a[124:127]
 v_exp_f32 v191, v191
 v_add_f32 v56, v56, v184
 v_mfma_f32_16x16x32_bf16 v[192:195], a[192:195], v[132:135], v[180:183]
 ds_read_b64 a[192:193], v32 offset:49152
 s_lshl_b32 s48, s48, 4
 v_cvt_pk_bf16_f32 v203, v190, v191
 v_add_f32 v56, v56, v187
 v_mfma_f32_16x16x32_bf16 v[196:199], a[196:199], v[132:135], v[180:183]
 ds_read_b64 a[196:197], v32 offset:53248
 v_add_f32 v56, v56, v188
 v_add_f32 v56, v56, v189
 v_mfma_f32_16x16x32_bf16 v[192:195], a[200:203], v[140:143], v[192:195]
 ds_read_b64 a[200:201], v34 offset:49152
 s_lshl_b32 s49, s47, 1
 s_add_u32 s48, s48, s49
 v_add_f32 v56, v56, v190
 v_add_f32 v56, v56, v191
 v_mfma_f32_16x16x32_bf16 v[196:199], a[204:207], v[140:143], v[196:199]
 ds_read_b64 a[204:205], v34 offset:53248
 v_mfma_f32_16x16x32_bf16 v[192:195], a[208:211], v[148:151], v[192:195]
 ds_read_b64 a[194:195], v33 offset:49152
 ds_read_b64 a[208:209], v36 offset:49152
 s_and_b32 s49, s46, 1
 v_mfma_f32_16x16x32_bf16 v[196:199], a[212:215], v[148:151], v[196:199]
 ds_read_b64 a[198:199], v33 offset:53248
 ds_read_b64 a[212:213], v36 offset:53248
 v_mfma_f32_16x16x32_bf16 v[192:195], a[216:219], v[156:159], v[192:195]
 ds_read_b64 a[202:203], v35 offset:49152
 ds_read_b64 a[216:217], v38 offset:49152
 s_add_u32 s48, s48, s49
 v_mfma_f32_16x16x32_bf16 v[196:199], a[220:223], v[156:159], v[196:199]
 ds_read_b64 a[206:207], v35 offset:53248
 ds_read_b64 a[220:221], v38 offset:53248
 v_mfma_f32_16x16x32_bf16 a[128:131], a[224:227], v[200:203], a[128:131]
 ds_read_b64 a[210:211], v37 offset:49152
 s_lshl_b32 s48, s48, 8
 s_lshl_b32 s49, s36, 4
 v_exp_f32 v192, v192
 v_mfma_f32_16x16x32_bf16 a[132:135], a[228:231], v[200:203], a[132:135]
 ds_read_b64 a[214:215], v37 offset:53248
 v_exp_f32 v193, v193
 v_mfma_f32_16x16x32_bf16 a[136:139], a[232:235], v[200:203], a[136:139]
 ds_read_b64 a[218:219], v39 offset:49152
 s_add_u32 s48, s48, s49
 v_exp_f32 v194, v194
 v_mfma_f32_16x16x32_bf16 a[140:143], a[236:239], v[200:203], a[140:143]
 ds_read_b64 a[222:223], v39 offset:53248
 v_cvt_pk_bf16_f32 v204, v192, v193
 v_add_f32 v57, v57, v193
 v_mfma_f32_16x16x32_bf16 a[144:147], a[240:243], v[200:203], a[144:147]
 s_add_u32 s92, s48, 33554432
 v_exp_f32 v195, v195
 v_add_f32 v57, v57, v194
 v_mfma_f32_16x16x32_bf16 a[148:151], a[244:247], v[200:203], a[148:151]
 v_exp_f32 v196, v196
 v_cvt_pk_bf16_f32 v205, v194, v195
 v_mfma_f32_16x16x32_bf16 a[152:155], a[248:251], v[200:203], a[152:155]
 v_exp_f32 v197, v197
 v_add_f32 v57, v57, v195
 v_mfma_f32_16x16x32_bf16 a[156:159], a[252:255], v[200:203], a[156:159]
 v_exp_f32 v198, v198
 s_waitcnt lgkmcnt(5)
 v_mfma_f32_16x16x32_bf16 v[184:187], a[192:195], v[64:67], v[160:163]
 v_cvt_pk_bf16_f32 v206, v196, v197
 v_exp_f32 v199, v199
 v_mfma_f32_16x16x32_bf16 v[188:191], a[196:199], v[64:67], v[160:163]
 v_add_f32 v57, v57, v192
 v_cvt_pk_bf16_f32 v207, v198, v199
 v_add_f32 v57, v57, v196
 v_mfma_f32_16x16x32_bf16 v[184:187], a[200:203], v[72:75], v[184:187]
 v_add_f32 v57, v57, v197
 v_add_f32 v57, v57, v198
 v_add_f32 v57, v57, v199
 v_mfma_f32_16x16x32_bf16 v[188:191], a[204:207], v[72:75], v[188:191]
 s_waitcnt lgkmcnt(0)
 v_mfma_f32_16x16x32_bf16 v[184:187], a[208:211], v[80:83], v[184:187]
 v_mfma_f32_16x16x32_bf16 v[188:191], a[212:215], v[80:83], v[188:191]
 v_mfma_f32_16x16x32_bf16 v[184:187], a[216:219], v[88:91], v[184:187]
 s_add_u32 m0, s97, 0
 v_mfma_f32_16x16x32_bf16 v[188:191], a[220:223], v[88:91], v[188:191]
 s_waitcnt vmcnt(32)
 s_barrier
 v_mfma_f32_16x16x32_bf16 a[160:163], a[224:227], v[204:207], a[160:163]
 ds_read_b64_tr_b16 a[224:225], v40 offset:49152
 v_exp_f32 v184, v184
 v_mfma_f32_16x16x32_bf16 a[164:167], a[228:231], v[204:207], a[164:167]
 ds_read_b64_tr_b16 a[228:229], v41 offset:49152
 v_exp_f32 v185, v185
 v_mfma_f32_16x16x32_bf16 a[168:171], a[232:235], v[204:207], a[168:171]
 ds_read_b64_tr_b16 a[232:233], v42 offset:49152
 v_exp_f32 v186, v186
 v_mfma_f32_16x16x32_bf16 a[172:175], a[236:239], v[204:207], a[172:175]
 ds_read_b64_tr_b16 a[236:237], v43 offset:49152
 v_cvt_pk_bf16_f32 v200, v184, v185
 v_add_f32 v52, v52, v185
 v_mfma_f32_16x16x32_bf16 a[176:179], a[240:243], v[204:207], a[176:179]
 ds_read_b64_tr_b16 a[226:227], v40 offset:53248
 ds_read_b64_tr_b16 a[240:241], v44 offset:49152
 v_add_f32 v52, v52, v186
 v_mfma_f32_16x16x32_bf16 a[180:183], a[244:247], v[204:207], a[180:183]
 ds_read_b64_tr_b16 a[230:231], v41 offset:53248
 ds_read_b64_tr_b16 a[244:245], v45 offset:49152
 v_mfma_f32_16x16x32_bf16 a[184:187], a[248:251], v[204:207], a[184:187]
 ds_read_b64_tr_b16 a[234:235], v42 offset:53248
 ds_read_b64_tr_b16 a[248:249], v46 offset:49152
 v_mfma_f32_16x16x32_bf16 a[188:191], a[252:255], v[204:207], a[188:191]
 ds_read_b64_tr_b16 a[238:239], v43 offset:53248
 ds_read_b64_tr_b16 a[252:253], v47 offset:49152
 v_mfma_f32_16x16x32_bf16 v[192:195], a[192:195], v[68:71], v[164:167]
 ds_read_b64_tr_b16 a[242:243], v44 offset:53248
 v_exp_f32 v187, v187
 v_mfma_f32_16x16x32_bf16 v[196:199], a[196:199], v[68:71], v[164:167]
 ds_read_b64_tr_b16 a[246:247], v45 offset:53248
 v_exp_f32 v188, v188
 v_mfma_f32_16x16x32_bf16 v[192:195], a[200:203], v[76:79], v[192:195]
 ds_read_b64_tr_b16 a[250:251], v46 offset:53248
 v_cvt_pk_bf16_f32 v201, v186, v187
 v_add_f32 v52, v52, v187
 v_mfma_f32_16x16x32_bf16 v[196:199], a[204:207], v[76:79], v[196:199]
 ds_read_b64_tr_b16 a[254:255], v47 offset:53248
 v_exp_f32 v189, v189
 v_mfma_f32_16x16x32_bf16 v[192:195], a[208:211], v[84:87], v[192:195]
 buffer_load_dwordx4 v48, s[28:31], s50 offen nt lds
 v_exp_f32 v190, v190
 v_mfma_f32_16x16x32_bf16 v[196:199], a[212:215], v[84:87], v[196:199]
 v_cvt_pk_bf16_f32 v202, v188, v189
 v_exp_f32 v191, v191
 v_mfma_f32_16x16x32_bf16 v[192:195], a[216:219], v[92:95], v[192:195]
 buffer_load_dwordx4 v49, s[28:31], s50 offen offset:1024 nt lds
 v_add_f32 v52, v52, v184
 v_cvt_pk_bf16_f32 v203, v190, v191
 v_mfma_f32_16x16x32_bf16 v[196:199], a[220:223], v[92:95], v[196:199]
 v_add_f32 v52, v52, v188
 v_add_f32 v52, v52, v189
 s_waitcnt lgkmcnt(5)
 v_mfma_f32_16x16x32_bf16 a[0:3], a[224:227], v[200:203], a[0:3]
 buffer_load_dwordx4 v50, s[28:31], s50 offen offset:2048 nt lds
 v_exp_f32 v192, v192
 v_mfma_f32_16x16x32_bf16 a[4:7], a[228:231], v[200:203], a[4:7]
 v_exp_f32 v193, v193
 v_add_f32 v52, v52, v190
 v_mfma_f32_16x16x32_bf16 a[8:11], a[232:235], v[200:203], a[8:11]
 buffer_load_dwordx4 v51, s[28:31], s50 offen offset:3072 nt lds
 v_exp_f32 v194, v194
 v_mfma_f32_16x16x32_bf16 a[12:15], a[236:239], v[200:203], a[12:15]
 v_cvt_pk_bf16_f32 v204, v192, v193
 v_add_f32 v52, v52, v191
 s_waitcnt lgkmcnt(0)
 v_mfma_f32_16x16x32_bf16 a[16:19], a[240:243], v[200:203], a[16:19]
 s_add_u32 m0, s97, 4096
 v_exp_f32 v195, v195
 v_mfma_f32_16x16x32_bf16 a[20:23], a[244:247], v[200:203], a[20:23]
 v_exp_f32 v196, v196
 v_cvt_pk_bf16_f32 v205, v194, v195
 v_mfma_f32_16x16x32_bf16 a[24:27], a[248:251], v[200:203], a[24:27]
 buffer_load_dwordx4 v48, s[28:31], s51 offen nt lds
 v_exp_f32 v197, v197
 v_mfma_f32_16x16x32_bf16 a[28:31], a[252:255], v[200:203], a[28:31]
 v_exp_f32 v198, v198
 v_cvt_pk_bf16_f32 v206, v196, v197
 v_mfma_f32_16x16x32_bf16 v[184:187], a[192:195], v[96:99], v[168:171]
 buffer_load_dwordx4 v49, s[28:31], s51 offen offset:1024 nt lds
 v_exp_f32 v199, v199
 v_mfma_f32_16x16x32_bf16 v[188:191], a[196:199], v[96:99], v[168:171]
 v_add_f32 v53, v53, v192
 v_cvt_pk_bf16_f32 v207, v198, v199
 v_mfma_f32_16x16x32_bf16 v[184:187], a[200:203], v[104:107], v[184:187]
 buffer_load_dwordx4 v50, s[28:31], s51 offen offset:2048 nt lds
 v_add_f32 v53, v53, v193
 v_mfma_f32_16x16x32_bf16 v[188:191], a[204:207], v[104:107], v[188:191]
 v_add_f32 v53, v53, v194
 v_add_f32 v53, v53, v195
 v_mfma_f32_16x16x32_bf16 v[184:187], a[208:211], v[112:115], v[184:187]
 buffer_load_dwordx4 v51, s[28:31], s51 offen offset:3072 nt lds
 v_add_f32 v53, v53, v196
 v_mfma_f32_16x16x32_bf16 v[188:191], a[212:215], v[112:115], v[188:191]
 v_add_f32 v53, v53, v197
 v_add_f32 v53, v53, v198
 v_mfma_f32_16x16x32_bf16 v[184:187], a[216:219], v[120:123], v[184:187]
 v_add_f32 v53, v53, v199
 v_mfma_f32_16x16x32_bf16 v[188:191], a[220:223], v[120:123], v[188:191]
 s_add_u32 s50, s50, 8192
 s_and_b32 s50, s50, 262143
 s_add_u32 s51, s50, 4096
 v_mfma_f32_16x16x32_bf16 a[32:35], a[224:227], v[204:207], a[32:35]
 v_exp_f32 v184, v184
 v_mfma_f32_16x16x32_bf16 a[36:39], a[228:231], v[204:207], a[36:39]
 v_exp_f32 v185, v185
 v_mfma_f32_16x16x32_bf16 a[40:43], a[232:235], v[204:207], a[40:43]
 v_exp_f32 v186, v186
 v_mfma_f32_16x16x32_bf16 a[44:47], a[236:239], v[204:207], a[44:47]
 v_cvt_pk_bf16_f32 v200, v184, v185
 v_add_f32 v54, v54, v185
 v_mfma_f32_16x16x32_bf16 a[48:51], a[240:243], v[204:207], a[48:51]
 v_add_u32 v32, s79, v32
 v_exp_f32 v187, v187
 v_mfma_f32_16x16x32_bf16 a[52:55], a[244:247], v[204:207], a[52:55]
 v_add_u32 v33, s79, v33
 v_exp_f32 v188, v188
 v_mfma_f32_16x16x32_bf16 a[56:59], a[248:251], v[204:207], a[56:59]
 v_add_u32 v34, s79, v34
 v_cvt_pk_bf16_f32 v201, v186, v187
 v_add_f32 v54, v54, v186
 v_mfma_f32_16x16x32_bf16 a[60:63], a[252:255], v[204:207], a[60:63]
 v_add_u32 v35, s79, v35
 v_exp_f32 v189, v189
 v_mfma_f32_16x16x32_bf16 v[192:195], a[192:195], v[100:103], v[172:175]
 v_add_u32 v36, s79, v36
 v_exp_f32 v190, v190
 v_mfma_f32_16x16x32_bf16 v[196:199], a[196:199], v[100:103], v[172:175]
 v_add_u32 v37, s79, v37
 v_cvt_pk_bf16_f32 v202, v188, v189
 v_add_f32 v54, v54, v187
 v_mfma_f32_16x16x32_bf16 v[192:195], a[200:203], v[108:111], v[192:195]
 v_add_u32 v38, s79, v38
 v_exp_f32 v191, v191
 v_mfma_f32_16x16x32_bf16 v[196:199], a[204:207], v[108:111], v[196:199]
 v_add_u32 v39, s79, v39
 v_add_f32 v54, v54, v184
 v_cvt_pk_bf16_f32 v203, v190, v191
 v_mfma_f32_16x16x32_bf16 v[192:195], a[208:211], v[116:119], v[192:195]
 v_add_u32 v40, s79, v40
 v_add_f32 v54, v54, v188
 v_add_f32 v54, v54, v189
 v_mfma_f32_16x16x32_bf16 v[196:199], a[212:215], v[116:119], v[196:199]
 v_add_u32 v41, s79, v41
 v_add_f32 v54, v54, v190
 v_add_f32 v54, v54, v191
 v_mfma_f32_16x16x32_bf16 v[192:195], a[216:219], v[124:127], v[192:195]
 v_add_u32 v42, s79, v42
 v_mfma_f32_16x16x32_bf16 v[196:199], a[220:223], v[124:127], v[196:199]
 v_add_u32 v43, s79, v43
 v_mfma_f32_16x16x32_bf16 a[64:67], a[224:227], v[200:203], a[64:67]
 v_add_u32 v44, s79, v44
 v_exp_f32 v192, v192
 v_mfma_f32_16x16x32_bf16 a[68:71], a[228:231], v[200:203], a[68:71]
 v_add_u32 v45, s79, v45
 v_exp_f32 v193, v193
 v_mfma_f32_16x16x32_bf16 a[72:75], a[232:235], v[200:203], a[72:75]
 v_add_u32 v46, s79, v46
 v_exp_f32 v194, v194
 v_mfma_f32_16x16x32_bf16 a[76:79], a[236:239], v[200:203], a[76:79]
 v_add_u32 v47, s79, v47
 v_cvt_pk_bf16_f32 v204, v192, v193
 v_add_f32 v55, v55, v193
 v_mfma_f32_16x16x32_bf16 a[80:83], a[240:243], v[200:203], a[80:83]
 v_exp_f32 v195, v195
 v_mfma_f32_16x16x32_bf16 a[84:87], a[244:247], v[200:203], a[84:87]
 v_exp_f32 v196, v196
 v_mfma_f32_16x16x32_bf16 a[88:91], a[248:251], v[200:203], a[88:91]
 v_cvt_pk_bf16_f32 v205, v194, v195
 v_add_f32 v55, v55, v194
 v_mfma_f32_16x16x32_bf16 a[92:95], a[252:255], v[200:203], a[92:95]
 v_exp_f32 v197, v197
 v_mfma_f32_16x16x32_bf16 v[184:187], a[192:195], v[128:131], v[176:179]
 v_exp_f32 v198, v198
 v_mfma_f32_16x16x32_bf16 v[188:191], a[196:199], v[128:131], v[176:179]
 v_cvt_pk_bf16_f32 v206, v196, v197
 v_add_f32 v55, v55, v195
 v_mfma_f32_16x16x32_bf16 v[184:187], a[200:203], v[136:139], v[184:187]
 v_exp_f32 v199, v199
 v_mfma_f32_16x16x32_bf16 v[188:191], a[204:207], v[136:139], v[188:191]
 v_add_f32 v55, v55, v192
 v_cvt_pk_bf16_f32 v207, v198, v199
 v_mfma_f32_16x16x32_bf16 v[184:187], a[208:211], v[144:147], v[184:187]
 v_add_f32 v55, v55, v196
 v_add_f32 v55, v55, v197
 v_mfma_f32_16x16x32_bf16 v[188:191], a[212:215], v[144:147], v[188:191]
 v_add_f32 v55, v55, v198
 v_add_f32 v55, v55, v199
 v_mfma_f32_16x16x32_bf16 v[184:187], a[216:219], v[152:155], v[184:187]
 v_mfma_f32_16x16x32_bf16 v[188:191], a[220:223], v[152:155], v[188:191]
 v_mfma_f32_16x16x32_bf16 a[96:99], a[224:227], v[204:207], a[96:99]
 v_exp_f32 v184, v184
 v_mfma_f32_16x16x32_bf16 a[100:103], a[228:231], v[204:207], a[100:103]
 v_exp_f32 v185, v185
 v_mfma_f32_16x16x32_bf16 a[104:107], a[232:235], v[204:207], a[104:107]
 v_exp_f32 v186, v186
 v_cvt_pk_bf16_f32 v200, v184, v185
 v_mfma_f32_16x16x32_bf16 a[108:111], a[236:239], v[204:207], a[108:111]
 v_exp_f32 v187, v187
 v_add_f32 v56, v56, v185
 v_mfma_f32_16x16x32_bf16 a[112:115], a[240:243], v[204:207], a[112:115]
 v_exp_f32 v188, v188
 v_cvt_pk_bf16_f32 v201, v186, v187
 v_mfma_f32_16x16x32_bf16 a[116:119], a[244:247], v[204:207], a[116:119]
 v_exp_f32 v189, v189
 v_add_f32 v56, v56, v186
 v_mfma_f32_16x16x32_bf16 a[120:123], a[248:251], v[204:207], a[120:123]
 v_exp_f32 v190, v190
 v_cvt_pk_bf16_f32 v202, v188, v189
 v_mfma_f32_16x16x32_bf16 a[124:127], a[252:255], v[204:207], a[124:127]
 v_exp_f32 v191, v191
 v_add_f32 v56, v56, v184
 v_mfma_f32_16x16x32_bf16 v[192:195], a[192:195], v[132:135], v[180:183]
 ds_read_b64 a[192:193], v32
 v_cvt_pk_bf16_f32 v203, v190, v191
 v_add_f32 v56, v56, v187
 v_mfma_f32_16x16x32_bf16 v[196:199], a[196:199], v[132:135], v[180:183]
 ds_read_b64 a[196:197], v32 offset:4096
 v_add_f32 v56, v56, v188
 v_add_f32 v56, v56, v189
 v_mfma_f32_16x16x32_bf16 v[192:195], a[200:203], v[140:143], v[192:195]
 ds_read_b64 a[200:201], v34
 v_add_f32 v56, v56, v190
 v_add_f32 v56, v56, v191
 v_mfma_f32_16x16x32_bf16 v[196:199], a[204:207], v[140:143], v[196:199]
 ds_read_b64 a[204:205], v34 offset:4096
 v_mfma_f32_16x16x32_bf16 v[192:195], a[208:211], v[148:151], v[192:195]
 ds_read_b64 a[194:195], v33
 ds_read_b64 a[208:209], v36
 v_mfma_f32_16x16x32_bf16 v[196:199], a[212:215], v[148:151], v[196:199]
 ds_read_b64 a[198:199], v33 offset:4096
 ds_read_b64 a[212:213], v36 offset:4096
 v_mfma_f32_16x16x32_bf16 v[192:195], a[216:219], v[156:159], v[192:195]
 ds_read_b64 a[202:203], v35
 ds_read_b64 a[216:217], v38
 v_mfma_f32_16x16x32_bf16 v[196:199], a[220:223], v[156:159], v[196:199]
 ds_read_b64 a[206:207], v35 offset:4096
 ds_read_b64 a[220:221], v38 offset:4096
 v_mfma_f32_16x16x32_bf16 a[128:131], a[224:227], v[200:203], a[128:131]
 ds_read_b64 a[210:211], v37
 v_exp_f32 v192, v192
 v_mfma_f32_16x16x32_bf16 a[132:135], a[228:231], v[200:203], a[132:135]
 ds_read_b64 a[214:215], v37 offset:4096
 v_exp_f32 v193, v193
 v_mfma_f32_16x16x32_bf16 a[136:139], a[232:235], v[200:203], a[136:139]
 ds_read_b64 a[218:219], v39
 v_exp_f32 v194, v194
 v_mfma_f32_16x16x32_bf16 a[140:143], a[236:239], v[200:203], a[140:143]
 ds_read_b64 a[222:223], v39 offset:4096
 v_cvt_pk_bf16_f32 v204, v192, v193
 v_add_f32 v57, v57, v193
 v_mfma_f32_16x16x32_bf16 a[144:147], a[240:243], v[200:203], a[144:147]
 v_exp_f32 v195, v195
 v_add_f32 v57, v57, v194
 v_mfma_f32_16x16x32_bf16 a[148:151], a[244:247], v[200:203], a[148:151]
 v_exp_f32 v196, v196
 v_cvt_pk_bf16_f32 v205, v194, v195
 v_mfma_f32_16x16x32_bf16 a[152:155], a[248:251], v[200:203], a[152:155]
 v_exp_f32 v197, v197
 v_add_f32 v57, v57, v195
 v_mfma_f32_16x16x32_bf16 a[156:159], a[252:255], v[200:203], a[156:159]
 v_exp_f32 v198, v198
 s_waitcnt lgkmcnt(5)
 v_mfma_f32_16x16x32_bf16 v[184:187], a[192:195], v[64:67], v[160:163]
 v_cvt_pk_bf16_f32 v206, v196, v197
 v_exp_f32 v199, v199
 v_mfma_f32_16x16x32_bf16 v[188:191], a[196:199], v[64:67], v[160:163]
 v_add_f32 v57, v57, v192
 v_cvt_pk_bf16_f32 v207, v198, v199
 v_add_f32 v57, v57, v196
 v_mfma_f32_16x16x32_bf16 v[184:187], a[200:203], v[72:75], v[184:187]
 v_add_f32 v57, v57, v197
 v_add_f32 v57, v57, v198
 v_add_f32 v57, v57, v199
 v_mfma_f32_16x16x32_bf16 v[188:191], a[204:207], v[72:75], v[188:191]
 s_waitcnt lgkmcnt(0)
 v_mfma_f32_16x16x32_bf16 v[184:187], a[208:211], v[80:83], v[184:187]
 v_mfma_f32_16x16x32_bf16 v[188:191], a[212:215], v[80:83], v[188:191]
 v_mfma_f32_16x16x32_bf16 v[184:187], a[216:219], v[88:91], v[184:187]
 v_mfma_f32_16x16x32_bf16 v[188:191], a[220:223], v[88:91], v[188:191]
 s_waitcnt vmcnt(32)
 s_barrier
 v_mfma_f32_16x16x32_bf16 a[160:163], a[224:227], v[204:207], a[160:163]
 ds_read_b64_tr_b16 a[224:225], v40
 v_exp_f32 v184, v184
 v_mfma_f32_16x16x32_bf16 a[164:167], a[228:231], v[204:207], a[164:167]
 ds_read_b64_tr_b16 a[228:229], v41
 v_exp_f32 v185, v185
 v_mfma_f32_16x16x32_bf16 a[168:171], a[232:235], v[204:207], a[168:171]
 ds_read_b64_tr_b16 a[232:233], v42
 v_exp_f32 v186, v186
 v_mfma_f32_16x16x32_bf16 a[172:175], a[236:239], v[204:207], a[172:175]
 ds_read_b64_tr_b16 a[236:237], v43
 v_cvt_pk_bf16_f32 v200, v184, v185
 v_add_f32 v52, v52, v185
 v_mfma_f32_16x16x32_bf16 a[176:179], a[240:243], v[204:207], a[176:179]
 ds_read_b64_tr_b16 a[226:227], v40 offset:4096
 ds_read_b64_tr_b16 a[240:241], v44
 v_add_f32 v52, v52, v186
 v_mfma_f32_16x16x32_bf16 a[180:183], a[244:247], v[204:207], a[180:183]
 ds_read_b64_tr_b16 a[230:231], v41 offset:4096
 ds_read_b64_tr_b16 a[244:245], v45
 v_mfma_f32_16x16x32_bf16 a[184:187], a[248:251], v[204:207], a[184:187]
 ds_read_b64_tr_b16 a[234:235], v42 offset:4096
 ds_read_b64_tr_b16 a[248:249], v46
 v_mfma_f32_16x16x32_bf16 a[188:191], a[252:255], v[204:207], a[188:191]
 ds_read_b64_tr_b16 a[238:239], v43 offset:4096
 ds_read_b64_tr_b16 a[252:253], v47
 v_mfma_f32_16x16x32_bf16 v[192:195], a[192:195], v[68:71], v[164:167]
 ds_read_b64_tr_b16 a[242:243], v44 offset:4096
 v_exp_f32 v187, v187
 v_mfma_f32_16x16x32_bf16 v[196:199], a[196:199], v[68:71], v[164:167]
 ds_read_b64_tr_b16 a[246:247], v45 offset:4096
 v_exp_f32 v188, v188
 v_mfma_f32_16x16x32_bf16 v[192:195], a[200:203], v[76:79], v[192:195]
 ds_read_b64_tr_b16 a[250:251], v46 offset:4096
 v_cvt_pk_bf16_f32 v201, v186, v187
 v_add_f32 v52, v52, v187
 v_mfma_f32_16x16x32_bf16 v[196:199], a[204:207], v[76:79], v[196:199]
 ds_read_b64_tr_b16 a[254:255], v47 offset:4096
 v_exp_f32 v189, v189
 v_mfma_f32_16x16x32_bf16 v[192:195], a[208:211], v[84:87], v[192:195]
 v_exp_f32 v190, v190
 v_mfma_f32_16x16x32_bf16 v[196:199], a[212:215], v[84:87], v[196:199]
 v_cvt_pk_bf16_f32 v202, v188, v189
 v_exp_f32 v191, v191
 v_mfma_f32_16x16x32_bf16 v[192:195], a[216:219], v[92:95], v[192:195]
 v_add_f32 v52, v52, v184
 v_cvt_pk_bf16_f32 v203, v190, v191
 v_mfma_f32_16x16x32_bf16 v[196:199], a[220:223], v[92:95], v[196:199]
 v_add_f32 v52, v52, v188
 v_add_f32 v52, v52, v189
 s_waitcnt lgkmcnt(5)
 v_mfma_f32_16x16x32_bf16 a[0:3], a[224:227], v[200:203], a[0:3]
 v_exp_f32 v192, v192
 v_mfma_f32_16x16x32_bf16 a[4:7], a[228:231], v[200:203], a[4:7]
 v_exp_f32 v193, v193
 v_add_f32 v52, v52, v190
 v_mfma_f32_16x16x32_bf16 a[8:11], a[232:235], v[200:203], a[8:11]
 v_exp_f32 v194, v194
 v_mfma_f32_16x16x32_bf16 a[12:15], a[236:239], v[200:203], a[12:15]
 v_cvt_pk_bf16_f32 v204, v192, v193
 v_add_f32 v52, v52, v191
 s_waitcnt lgkmcnt(0)
 v_mfma_f32_16x16x32_bf16 a[16:19], a[240:243], v[200:203], a[16:19]
 v_exp_f32 v195, v195
 v_mfma_f32_16x16x32_bf16 a[20:23], a[244:247], v[200:203], a[20:23]
 s_cbranch_vccnz L1_only3
 ds_write_b128 v58, v[208:211]
 ds_write_b128 v58, v[212:215] offset:1024
 ds_write_b128 v58, v[216:219] offset:2048
 ds_write_b128 v58, v[220:223] offset:3072
 ds_write_b128 v58, v[224:227] offset:4096
 ds_write_b128 v58, v[228:231] offset:5120
 ds_write_b128 v58, v[232:235] offset:6144
 ds_write_b128 v58, v[236:239] offset:7168
L1_only3:
 v_exp_f32 v196, v196
 v_cvt_pk_bf16_f32 v205, v194, v195
 v_mfma_f32_16x16x32_bf16 a[24:27], a[248:251], v[200:203], a[24:27]
 v_exp_f32 v197, v197
 v_mfma_f32_16x16x32_bf16 a[28:31], a[252:255], v[200:203], a[28:31]
 v_exp_f32 v198, v198
 v_cvt_pk_bf16_f32 v206, v196, v197
 v_mfma_f32_16x16x32_bf16 v[184:187], a[192:195], v[96:99], v[168:171]
 v_exp_f32 v199, v199
 v_mfma_f32_16x16x32_bf16 v[188:191], a[196:199], v[96:99], v[168:171]
 v_add_f32 v53, v53, v192
 v_cvt_pk_bf16_f32 v207, v198, v199
 v_mfma_f32_16x16x32_bf16 v[184:187], a[200:203], v[104:107], v[184:187]
 v_add_f32 v53, v53, v193
 v_mfma_f32_16x16x32_bf16 v[188:191], a[204:207], v[104:107], v[188:191]
 v_add_f32 v53, v53, v194
 v_add_f32 v53, v53, v195
 v_mfma_f32_16x16x32_bf16 v[184:187], a[208:211], v[112:115], v[184:187]
 v_add_f32 v53, v53, v196
 v_mfma_f32_16x16x32_bf16 v[188:191], a[212:215], v[112:115], v[188:191]
 v_add_f32 v53, v53, v197
 v_add_f32 v53, v53, v198
 v_mfma_f32_16x16x32_bf16 v[184:187], a[216:219], v[120:123], v[184:187]
 v_add_f32 v53, v53, v199
 v_mfma_f32_16x16x32_bf16 v[188:191], a[220:223], v[120:123], v[188:191]
 v_mfma_f32_16x16x32_bf16 a[32:35], a[224:227], v[204:207], a[32:35]
 v_exp_f32 v184, v184
 v_mfma_f32_16x16x32_bf16 a[36:39], a[228:231], v[204:207], a[36:39]
 v_exp_f32 v185, v185
 v_mfma_f32_16x16x32_bf16 a[40:43], a[232:235], v[204:207], a[40:43]
 v_exp_f32 v186, v186
 v_mfma_f32_16x16x32_bf16 a[44:47], a[236:239], v[204:207], a[44:47]
 v_cvt_pk_bf16_f32 v200, v184, v185
 v_add_f32 v54, v54, v185
 v_mfma_f32_16x16x32_bf16 a[48:51], a[240:243], v[204:207], a[48:51]
 v_exp_f32 v187, v187
 v_mfma_f32_16x16x32_bf16 a[52:55], a[244:247], v[204:207], a[52:55]
 s_waitcnt vmcnt(24) lgkmcnt(0)
 s_barrier
 v_exp_f32 v188, v188
 v_mfma_f32_16x16x32_bf16 a[56:59], a[248:251], v[204:207], a[56:59]
 s_cbranch_vccz L1_only4
 ds_write_b128 v58, v[208:211]
 ds_write_b128 v58, v[212:215] offset:1024
 ds_write_b128 v58, v[216:219] offset:2048
 ds_write_b128 v58, v[220:223] offset:3072
 ds_write_b128 v58, v[224:227] offset:4096
 ds_write_b128 v58, v[228:231] offset:5120
 ds_write_b128 v58, v[232:235] offset:6144
 ds_write_b128 v58, v[236:239] offset:7168
L1_only4:
 v_cvt_pk_bf16_f32 v201, v186, v187
 v_add_f32 v54, v54, v186
 v_mfma_f32_16x16x32_bf16 a[60:63], a[252:255], v[204:207], a[60:63]
 v_exp_f32 v189, v189
 v_mfma_f32_16x16x32_bf16 v[192:195], a[192:195], v[100:103], v[172:175]
 v_exp_f32 v190, v190
 v_mfma_f32_16x16x32_bf16 v[196:199], a[196:199], v[100:103], v[172:175]
 v_cvt_pk_bf16_f32 v202, v188, v189
 v_add_f32 v54, v54, v187
 v_mfma_f32_16x16x32_bf16 v[192:195], a[200:203], v[108:111], v[192:195]
 s_cbranch_vccz L1_only5
 s_add_u32 m0, s94, 0
 s_nop 0
 buffer_load_dwordx4 v48, s[28:31], s50 offen nt lds
 buffer_load_dwordx4 v49, s[28:31], s50 offen offset:1024 nt lds
 buffer_load_dwordx4 v50, s[28:31], s50 offen offset:2048 nt lds
 buffer_load_dwordx4 v51, s[28:31], s50 offen offset:3072 nt lds
L1_only5:
 v_exp_f32 v191, v191
 v_mfma_f32_16x16x32_bf16 v[196:199], a[204:207], v[108:111], v[196:199]
 v_add_f32 v54, v54, v184
 v_cvt_pk_bf16_f32 v203, v190, v191
 v_mfma_f32_16x16x32_bf16 v[192:195], a[208:211], v[116:119], v[192:195]
 v_add_f32 v54, v54, v188
 v_add_f32 v54, v54, v189
 v_mfma_f32_16x16x32_bf16 v[196:199], a[212:215], v[116:119], v[196:199]
 v_add_f32 v54, v54, v190
 v_add_f32 v54, v54, v191
 v_mfma_f32_16x16x32_bf16 v[192:195], a[216:219], v[124:127], v[192:195]
 v_mfma_f32_16x16x32_bf16 v[196:199], a[220:223], v[124:127], v[196:199]
 v_mfma_f32_16x16x32_bf16 a[64:67], a[224:227], v[200:203], a[64:67]
 v_exp_f32 v192, v192
 v_mfma_f32_16x16x32_bf16 a[68:71], a[228:231], v[200:203], a[68:71]
 v_exp_f32 v193, v193
 v_mfma_f32_16x16x32_bf16 a[72:75], a[232:235], v[200:203], a[72:75]
 v_exp_f32 v194, v194
 v_mfma_f32_16x16x32_bf16 a[76:79], a[236:239], v[200:203], a[76:79]
 v_cvt_pk_bf16_f32 v204, v192, v193
 v_add_f32 v55, v55, v193
 v_mfma_f32_16x16x32_bf16 a[80:83], a[240:243], v[200:203], a[80:83]
 s_cbranch_vccz L1_only6
 s_add_u32 m0, s94, 4096
 s_nop 0
 buffer_load_dwordx4 v48, s[28:31], s51 offen nt lds
 buffer_load_dwordx4 v49, s[28:31], s51 offen offset:1024 nt lds
 buffer_load_dwordx4 v50, s[28:31], s51 offen offset:2048 nt lds
 buffer_load_dwordx4 v51, s[28:31], s51 offen offset:3072 nt lds
L1_only6:
 v_exp_f32 v195, v195
 v_mfma_f32_16x16x32_bf16 a[84:87], a[244:247], v[200:203], a[84:87]
 v_exp_f32 v196, v196
 v_mfma_f32_16x16x32_bf16 a[88:91], a[248:251], v[200:203], a[88:91]
 s_cmp_eq_u32 s40, 0
 s_cselect_b32 s94, s78, s72
 v_cvt_pk_bf16_f32 v205, v194, v195
 v_add_f32 v55, v55, v194
 v_mfma_f32_16x16x32_bf16 a[92:95], a[252:255], v[200:203], a[92:95]
 v_exp_f32 v197, v197
 v_mfma_f32_16x16x32_bf16 v[184:187], a[192:195], v[128:131], v[176:179]
 v_exp_f32 v198, v198
 v_mfma_f32_16x16x32_bf16 v[188:191], a[196:199], v[128:131], v[176:179]
 v_cvt_pk_bf16_f32 v206, v196, v197
 v_add_f32 v55, v55, v195
 v_mfma_f32_16x16x32_bf16 v[184:187], a[200:203], v[136:139], v[184:187]
 v_exp_f32 v199, v199
 v_mfma_f32_16x16x32_bf16 v[188:191], a[204:207], v[136:139], v[188:191]
 v_add_f32 v55, v55, v192
 v_cvt_pk_bf16_f32 v207, v198, v199
 v_mfma_f32_16x16x32_bf16 v[184:187], a[208:211], v[144:147], v[184:187]
 v_add_f32 v55, v55, v196
 v_add_f32 v55, v55, v197
 v_mfma_f32_16x16x32_bf16 v[188:191], a[212:215], v[144:147], v[188:191]
 v_add_f32 v55, v55, v198
 v_add_f32 v55, v55, v199
 v_mfma_f32_16x16x32_bf16 v[184:187], a[216:219], v[152:155], v[184:187]
 v_mfma_f32_16x16x32_bf16 v[188:191], a[220:223], v[152:155], v[188:191]
 v_mfma_f32_16x16x32_bf16 a[96:99], a[224:227], v[204:207], a[96:99]
 v_exp_f32 v184, v184
 v_mfma_f32_16x16x32_bf16 a[100:103], a[228:231], v[204:207], a[100:103]
 v_exp_f32 v185, v185
 v_mfma_f32_16x16x32_bf16 a[104:107], a[232:235], v[204:207], a[104:107]
 v_exp_f32 v186, v186
 v_cvt_pk_bf16_f32 v200, v184, v185
 v_mfma_f32_16x16x32_bf16 a[108:111], a[236:239], v[204:207], a[108:111]
 v_exp_f32 v187, v187
 v_add_f32 v56, v56, v185
 v_mfma_f32_16x16x32_bf16 a[112:115], a[240:243], v[204:207], a[112:115]
 v_exp_f32 v188, v188
 v_cvt_pk_bf16_f32 v201, v186, v187
 v_mfma_f32_16x16x32_bf16 a[116:119], a[244:247], v[204:207], a[116:119]
 v_exp_f32 v189, v189
 v_add_f32 v56, v56, v186
 v_mfma_f32_16x16x32_bf16 a[120:123], a[248:251], v[204:207], a[120:123]
 v_exp_f32 v190, v190
 v_cvt_pk_bf16_f32 v202, v188, v189
 v_mfma_f32_16x16x32_bf16 a[124:127], a[252:255], v[204:207], a[124:127]
 v_exp_f32 v191, v191
 v_add_f32 v56, v56, v184
 v_mfma_f32_16x16x32_bf16 v[192:195], a[192:195], v[132:135], v[180:183]
 ds_read_b64 a[192:193], v32
 v_cvt_pk_bf16_f32 v203, v190, v191
 v_add_f32 v56, v56, v187
 v_mfma_f32_16x16x32_bf16 v[196:199], a[196:199], v[132:135], v[180:183]
 ds_read_b64 a[196:197], v32 offset:4096
 v_add_f32 v56, v56, v188
 v_add_f32 v56, v56, v189
 v_mfma_f32_16x16x32_bf16 v[192:195], a[200:203], v[140:143], v[192:195]
 ds_read_b64 a[200:201], v34
 v_add_f32 v56, v56, v190
 v_add_f32 v56, v56, v191
 v_mfma_f32_16x16x32_bf16 v[196:199], a[204:207], v[140:143], v[196:199]
 ds_read_b64 a[204:205], v34 offset:4096
 v_mfma_f32_16x16x32_bf16 v[192:195], a[208:211], v[148:151], v[192:195]
 ds_read_b64 a[194:195], v33
 ds_read_b64 a[208:209], v36
 v_mfma_f32_16x16x32_bf16 v[196:199], a[212:215], v[148:151], v[196:199]
 ds_read_b64 a[198:199], v33 offset:4096
 ds_read_b64 a[212:213], v36 offset:4096
 v_mfma_f32_16x16x32_bf16 v[192:195], a[216:219], v[156:159], v[192:195]
 ds_read_b64 a[202:203], v35
 ds_read_b64 a[216:217], v38
 v_mfma_f32_16x16x32_bf16 v[196:199], a[220:223], v[156:159], v[196:199]
 ds_read_b64 a[206:207], v35 offset:4096
 ds_read_b64 a[220:221], v38 offset:4096
 v_mfma_f32_16x16x32_bf16 a[128:131], a[224:227], v[200:203], a[128:131]
 ds_read_b64 a[210:211], v37
 v_exp_f32 v192, v192
 v_mfma_f32_16x16x32_bf16 a[132:135], a[228:231], v[200:203], a[132:135]
 ds_read_b64 a[214:215], v37 offset:4096
 v_exp_f32 v193, v193
 v_mfma_f32_16x16x32_bf16 a[136:139], a[232:235], v[200:203], a[136:139]
 ds_read_b64 a[218:219], v39
 v_exp_f32 v194, v194
 v_mfma_f32_16x16x32_bf16 a[140:143], a[236:239], v[200:203], a[140:143]
 ds_read_b64 a[222:223], v39 offset:4096
 v_cvt_pk_bf16_f32 v204, v192, v193
 v_add_f32 v57, v57, v193
 v_mfma_f32_16x16x32_bf16 a[144:147], a[240:243], v[200:203], a[144:147]
 v_exp_f32 v195, v195
 v_add_f32 v57, v57, v194
 v_mfma_f32_16x16x32_bf16 a[148:151], a[244:247], v[200:203], a[148:151]
 v_exp_f32 v196, v196
 v_cvt_pk_bf16_f32 v205, v194, v195
 v_mfma_f32_16x16x32_bf16 a[152:155], a[248:251], v[200:203], a[152:155]
 v_exp_f32 v197, v197
 v_add_f32 v57, v57, v195
 v_mfma_f32_16x16x32_bf16 a[156:159], a[252:255], v[200:203], a[156:159]
 v_exp_f32 v198, v198
 s_waitcnt lgkmcnt(5)
 v_mfma_f32_16x16x32_bf16 v[184:187], a[192:195], v[64:67], v[160:163]
 v_cvt_pk_bf16_f32 v206, v196, v197
 v_exp_f32 v199, v199
 v_mfma_f32_16x16x32_bf16 v[188:191], a[196:199], v[64:67], v[160:163]
 v_add_f32 v57, v57, v192
 v_cvt_pk_bf16_f32 v207, v198, v199
 v_add_f32 v57, v57, v196
 v_mfma_f32_16x16x32_bf16 v[184:187], a[200:203], v[72:75], v[184:187]
 v_add_f32 v57, v57, v197
 v_add_f32 v57, v57, v198
 v_add_f32 v57, v57, v199
 v_mfma_f32_16x16x32_bf16 v[188:191], a[204:207], v[72:75], v[188:191]
 s_waitcnt lgkmcnt(0)
 v_mfma_f32_16x16x32_bf16 v[184:187], a[208:211], v[80:83], v[184:187]
 v_mfma_f32_16x16x32_bf16 v[188:191], a[212:215], v[80:83], v[188:191]
 v_mfma_f32_16x16x32_bf16 v[184:187], a[216:219], v[88:91], v[184:187]
 v_mfma_f32_16x16x32_bf16 v[188:191], a[220:223], v[88:91], v[188:191]
 s_waitcnt vmcnt(24)
 s_barrier
 v_mfma_f32_16x16x32_bf16 a[160:163], a[224:227], v[204:207], a[160:163]
 ds_read_b64_tr_b16 a[224:225], v40
 v_exp_f32 v184, v184
 v_mfma_f32_16x16x32_bf16 a[164:167], a[228:231], v[204:207], a[164:167]
 ds_read_b64_tr_b16 a[228:229], v41
 v_exp_f32 v185, v185
 v_mfma_f32_16x16x32_bf16 a[168:171], a[232:235], v[204:207], a[168:171]
 ds_read_b64_tr_b16 a[232:233], v42
 v_exp_f32 v186, v186
 v_mfma_f32_16x16x32_bf16 a[172:175], a[236:239], v[204:207], a[172:175]
 ds_read_b64_tr_b16 a[236:237], v43
 v_cvt_pk_bf16_f32 v200, v184, v185
 v_add_f32 v52, v52, v185
 v_mfma_f32_16x16x32_bf16 a[176:179], a[240:243], v[204:207], a[176:179]
 ds_read_b64_tr_b16 a[226:227], v40 offset:4096
 ds_read_b64_tr_b16 a[240:241], v44
 v_add_f32 v52, v52, v186
 v_mfma_f32_16x16x32_bf16 a[180:183], a[244:247], v[204:207], a[180:183]
 ds_read_b64_tr_b16 a[230:231], v41 offset:4096
 ds_read_b64_tr_b16 a[244:245], v45
 v_mfma_f32_16x16x32_bf16 a[184:187], a[248:251], v[204:207], a[184:187]
 ds_read_b64_tr_b16 a[234:235], v42 offset:4096
 ds_read_b64_tr_b16 a[248:249], v46
 v_mfma_f32_16x16x32_bf16 a[188:191], a[252:255], v[204:207], a[188:191]
 ds_read_b64_tr_b16 a[238:239], v43 offset:4096
 ds_read_b64_tr_b16 a[252:253], v47
 v_mfma_f32_16x16x32_bf16 v[192:195], a[192:195], v[68:71], v[164:167]
 ds_read_b64_tr_b16 a[242:243], v44 offset:4096
 v_exp_f32 v187, v187
 v_mfma_f32_16x16x32_bf16 v[196:199], a[196:199], v[68:71], v[164:167]
 ds_read_b64_tr_b16 a[246:247], v45 offset:4096
 v_exp_f32 v188, v188
 v_mfma_f32_16x16x32_bf16 v[192:195], a[200:203], v[76:79], v[192:195]
 ds_read_b64_tr_b16 a[250:251], v46 offset:4096
 v_cvt_pk_bf16_f32 v201, v186, v187
 v_add_f32 v52, v52, v187
 v_mfma_f32_16x16x32_bf16 v[196:199], a[204:207], v[76:79], v[196:199]
 ds_read_b64_tr_b16 a[254:255], v47 offset:4096
 v_exp_f32 v189, v189
 v_mfma_f32_16x16x32_bf16 v[192:195], a[208:211], v[84:87], v[192:195]
 v_exp_f32 v190, v190
 v_mfma_f32_16x16x32_bf16 v[196:199], a[212:215], v[84:87], v[196:199]
 v_cvt_pk_bf16_f32 v202, v188, v189
 v_exp_f32 v191, v191
 v_mfma_f32_16x16x32_bf16 v[192:195], a[216:219], v[92:95], v[192:195]
 v_add_f32 v52, v52, v184
 v_cvt_pk_bf16_f32 v203, v190, v191
 v_mfma_f32_16x16x32_bf16 v[196:199], a[220:223], v[92:95], v[196:199]
 v_add_f32 v52, v52, v188
 v_add_f32 v52, v52, v189
 s_waitcnt lgkmcnt(5)
 v_mfma_f32_16x16x32_bf16 a[0:3], a[224:227], v[200:203], a[0:3]
 v_exp_f32 v192, v192
 v_mfma_f32_16x16x32_bf16 a[4:7], a[228:231], v[200:203], a[4:7]
 v_exp_f32 v193, v193
 v_add_f32 v52, v52, v190
 v_mfma_f32_16x16x32_bf16 a[8:11], a[232:235], v[200:203], a[8:11]
 v_exp_f32 v194, v194
 v_mfma_f32_16x16x32_bf16 a[12:15], a[236:239], v[200:203], a[12:15]
 v_cvt_pk_bf16_f32 v204, v192, v193
 v_add_f32 v52, v52, v191
 s_waitcnt lgkmcnt(0)
 v_mfma_f32_16x16x32_bf16 a[16:19], a[240:243], v[200:203], a[16:19]
 v_exp_f32 v195, v195
 v_mfma_f32_16x16x32_bf16 a[20:23], a[244:247], v[200:203], a[20:23]
 v_exp_f32 v196, v196
 v_cvt_pk_bf16_f32 v205, v194, v195
 v_mfma_f32_16x16x32_bf16 a[24:27], a[248:251], v[200:203], a[24:27]
 v_exp_f32 v197, v197
 v_mfma_f32_16x16x32_bf16 a[28:31], a[252:255], v[200:203], a[28:31]
 v_exp_f32 v198, v198
 v_cvt_pk_bf16_f32 v206, v196, v197
 v_mfma_f32_16x16x32_bf16 v[184:187], a[192:195], v[96:99], v[168:171]
 v_exp_f32 v199, v199
 v_mfma_f32_16x16x32_bf16 v[188:191], a[196:199], v[96:99], v[168:171]
 v_add_f32 v53, v53, v192
 v_cvt_pk_bf16_f32 v207, v198, v199
 v_mfma_f32_16x16x32_bf16 v[184:187], a[200:203], v[104:107], v[184:187]
 v_add_f32 v53, v53, v193
 v_mfma_f32_16x16x32_bf16 v[188:191], a[204:207], v[104:107], v[188:191]
 v_add_f32 v53, v53, v194
 v_add_f32 v53, v53, v195
 v_mfma_f32_16x16x32_bf16 v[184:187], a[208:211], v[112:115], v[184:187]
 v_add_f32 v53, v53, v196
 v_mfma_f32_16x16x32_bf16 v[188:191], a[212:215], v[112:115], v[188:191]
 v_add_f32 v53, v53, v197
 v_add_f32 v53, v53, v198
 v_mfma_f32_16x16x32_bf16 v[184:187], a[216:219], v[120:123], v[184:187]
 v_add_f32 v53, v53, v199
 v_mfma_f32_16x16x32_bf16 v[188:191], a[220:223], v[120:123], v[188:191]
 v_mfma_f32_16x16x32_bf16 a[32:35], a[224:227], v[204:207], a[32:35]
 v_exp_f32 v184, v184
 v_mfma_f32_16x16x32_bf16 a[36:39], a[228:231], v[204:207], a[36:39]
 v_exp_f32 v185, v185
 v_mfma_f32_16x16x32_bf16 a[40:43], a[232:235], v[204:207], a[40:43]
 v_exp_f32 v186, v186
 v_mfma_f32_16x16x32_bf16 a[44:47], a[236:239], v[204:207], a[44:47]
 v_cvt_pk_bf16_f32 v200, v184, v185
 v_add_f32 v54, v54, v185
 v_mfma_f32_16x16x32_bf16 a[48:51], a[240:243], v[204:207], a[48:51]
 v_subrev_u32 v32, s79, v32
 v_exp_f32 v187, v187
 v_mfma_f32_16x16x32_bf16 a[52:55], a[244:247], v[204:207], a[52:55]
 v_subrev_u32 v33, s79, v33
 v_exp_f32 v188, v188
 v_mfma_f32_16x16x32_bf16 a[56:59], a[248:251], v[204:207], a[56:59]
 v_subrev_u32 v34, s79, v34
 v_cvt_pk_bf16_f32 v201, v186, v187
 v_add_f32 v54, v54, v186
 v_mfma_f32_16x16x32_bf16 a[60:63], a[252:255], v[204:207], a[60:63]
 v_subrev_u32 v35, s79, v35
 v_exp_f32 v189, v189
 v_mfma_f32_16x16x32_bf16 v[192:195], a[192:195], v[100:103], v[172:175]
 v_subrev_u32 v36, s79, v36
 v_exp_f32 v190, v190
 v_mfma_f32_16x16x32_bf16 v[196:199], a[196:199], v[100:103], v[172:175]
 v_subrev_u32 v37, s79, v37
 v_cvt_pk_bf16_f32 v202, v188, v189
 v_add_f32 v54, v54, v187
 v_mfma_f32_16x16x32_bf16 v[192:195], a[200:203], v[108:111], v[192:195]
 v_subrev_u32 v38, s79, v38
 v_exp_f32 v191, v191
 v_mfma_f32_16x16x32_bf16 v[196:199], a[204:207], v[108:111], v[196:199]
 v_subrev_u32 v39, s79, v39
 v_add_f32 v54, v54, v184
 v_cvt_pk_bf16_f32 v203, v190, v191
 v_mfma_f32_16x16x32_bf16 v[192:195], a[208:211], v[116:119], v[192:195]
 v_subrev_u32 v40, s79, v40
 v_add_f32 v54, v54, v188
 v_add_f32 v54, v54, v189
 v_mfma_f32_16x16x32_bf16 v[196:199], a[212:215], v[116:119], v[196:199]
 v_subrev_u32 v41, s79, v41
 v_add_f32 v54, v54, v190
 v_add_f32 v54, v54, v191
 v_mfma_f32_16x16x32_bf16 v[192:195], a[216:219], v[124:127], v[192:195]
 v_subrev_u32 v42, s79, v42
 v_mfma_f32_16x16x32_bf16 v[196:199], a[220:223], v[124:127], v[196:199]
 v_subrev_u32 v43, s79, v43
 v_mfma_f32_16x16x32_bf16 a[64:67], a[224:227], v[200:203], a[64:67]
 v_subrev_u32 v44, s79, v44
 v_exp_f32 v192, v192
 v_mfma_f32_16x16x32_bf16 a[68:71], a[228:231], v[200:203], a[68:71]
 v_subrev_u32 v45, s79, v45
 v_exp_f32 v193, v193
 v_mfma_f32_16x16x32_bf16 a[72:75], a[232:235], v[200:203], a[72:75]
 v_subrev_u32 v46, s79, v46
 v_exp_f32 v194, v194
 v_mfma_f32_16x16x32_bf16 a[76:79], a[236:239], v[200:203], a[76:79]
 v_subrev_u32 v47, s79, v47
 v_cvt_pk_bf16_f32 v204, v192, v193
 v_add_f32 v55, v55, v193
 v_mfma_f32_16x16x32_bf16 a[80:83], a[240:243], v[200:203], a[80:83]
 v_exp_f32 v195, v195
 v_mfma_f32_16x16x32_bf16 a[84:87], a[244:247], v[200:203], a[84:87]
 v_exp_f32 v196, v196
 v_mfma_f32_16x16x32_bf16 a[88:91], a[248:251], v[200:203], a[88:91]
 v_cvt_pk_bf16_f32 v205, v194, v195
 v_add_f32 v55, v55, v194
 v_mfma_f32_16x16x32_bf16 a[92:95], a[252:255], v[200:203], a[92:95]
 v_exp_f32 v197, v197
 v_mfma_f32_16x16x32_bf16 v[184:187], a[192:195], v[128:131], v[176:179]
 v_exp_f32 v198, v198
 v_mfma_f32_16x16x32_bf16 v[188:191], a[196:199], v[128:131], v[176:179]
 v_cvt_pk_bf16_f32 v206, v196, v197
 v_add_f32 v55, v55, v195
 v_mfma_f32_16x16x32_bf16 v[184:187], a[200:203], v[136:139], v[184:187]
 v_exp_f32 v199, v199
 v_mfma_f32_16x16x32_bf16 v[188:191], a[204:207], v[136:139], v[188:191]
 v_add_f32 v55, v55, v192
 v_cvt_pk_bf16_f32 v207, v198, v199
 v_mfma_f32_16x16x32_bf16 v[184:187], a[208:211], v[144:147], v[184:187]
 v_add_f32 v55, v55, v196
 v_add_f32 v55, v55, v197
 v_mfma_f32_16x16x32_bf16 v[188:191], a[212:215], v[144:147], v[188:191]
 v_add_f32 v55, v55, v198
 v_add_f32 v55, v55, v199
 v_mfma_f32_16x16x32_bf16 v[184:187], a[216:219], v[152:155], v[184:187]
 v_mfma_f32_16x16x32_bf16 v[188:191], a[220:223], v[152:155], v[188:191]
 v_mfma_f32_16x16x32_bf16 a[96:99], a[224:227], v[204:207], a[96:99]
 v_exp_f32 v184, v184
 v_mfma_f32_16x16x32_bf16 a[100:103], a[228:231], v[204:207], a[100:103]
 v_exp_f32 v185, v185
 v_mfma_f32_16x16x32_bf16 a[104:107], a[232:235], v[204:207], a[104:107]
 v_exp_f32 v186, v186
 v_cvt_pk_bf16_f32 v200, v184, v185
 v_mfma_f32_16x16x32_bf16 a[108:111], a[236:239], v[204:207], a[108:111]
 v_exp_f32 v187, v187
 v_add_f32 v56, v56, v185
 v_mfma_f32_16x16x32_bf16 a[112:115], a[240:243], v[204:207], a[112:115]
 v_exp_f32 v188, v188
 v_cvt_pk_bf16_f32 v201, v186, v187
 v_mfma_f32_16x16x32_bf16 a[116:119], a[244:247], v[204:207], a[116:119]
 v_exp_f32 v189, v189
 v_add_f32 v56, v56, v186
 v_mfma_f32_16x16x32_bf16 a[120:123], a[248:251], v[204:207], a[120:123]
 v_exp_f32 v190, v190
 v_cvt_pk_bf16_f32 v202, v188, v189
 v_mfma_f32_16x16x32_bf16 a[124:127], a[252:255], v[204:207], a[124:127]
 v_exp_f32 v191, v191
 v_add_f32 v56, v56, v184
 v_mfma_f32_16x16x32_bf16 v[192:195], a[192:195], v[132:135], v[180:183]
 ds_read_b64 a[192:193], v32
 v_cvt_pk_bf16_f32 v203, v190, v191
 v_add_f32 v56, v56, v187
 v_mfma_f32_16x16x32_bf16 v[196:199], a[196:199], v[132:135], v[180:183]
 ds_read_b64 a[196:197], v32 offset:4096
 v_add_f32 v56, v56, v188
 v_add_f32 v56, v56, v189
 v_mfma_f32_16x16x32_bf16 v[192:195], a[200:203], v[140:143], v[192:195]
 ds_read_b64 a[200:201], v34
 v_add_f32 v56, v56, v190
 v_add_f32 v56, v56, v191
 v_mfma_f32_16x16x32_bf16 v[196:199], a[204:207], v[140:143], v[196:199]
 ds_read_b64 a[204:205], v34 offset:4096
 v_mfma_f32_16x16x32_bf16 v[192:195], a[208:211], v[148:151], v[192:195]
 ds_read_b64 a[194:195], v33
 ds_read_b64 a[208:209], v36
 v_mfma_f32_16x16x32_bf16 v[196:199], a[212:215], v[148:151], v[196:199]
 ds_read_b64 a[198:199], v33 offset:4096
 ds_read_b64 a[212:213], v36 offset:4096
 v_mfma_f32_16x16x32_bf16 v[192:195], a[216:219], v[156:159], v[192:195]
 ds_read_b64 a[202:203], v35
 ds_read_b64 a[216:217], v38
 v_mfma_f32_16x16x32_bf16 v[196:199], a[220:223], v[156:159], v[196:199]
 ds_read_b64 a[206:207], v35 offset:4096
 ds_read_b64 a[220:221], v38 offset:4096
 v_mfma_f32_16x16x32_bf16 a[128:131], a[224:227], v[200:203], a[128:131]
 ds_read_b64 a[210:211], v37
 v_exp_f32 v192, v192
 v_mfma_f32_16x16x32_bf16 a[132:135], a[228:231], v[200:203], a[132:135]
 ds_read_b64 a[214:215], v37 offset:4096
 v_exp_f32 v193, v193
 v_mfma_f32_16x16x32_bf16 a[136:139], a[232:235], v[200:203], a[136:139]
 ds_read_b64 a[218:219], v39
 v_exp_f32 v194, v194
 v_mfma_f32_16x16x32_bf16 a[140:143], a[236:239], v[200:203], a[140:143]
 ds_read_b64 a[222:223], v39 offset:4096
 v_cvt_pk_bf16_f32 v204, v192, v193
 v_add_f32 v57, v57, v193
 v_mfma_f32_16x16x32_bf16 a[144:147], a[240:243], v[200:203], a[144:147]
 v_exp_f32 v195, v195
 v_add_f32 v57, v57, v194
 v_mfma_f32_16x16x32_bf16 a[148:151], a[244:247], v[200:203], a[148:151]
 v_exp_f32 v196, v196
 v_cvt_pk_bf16_f32 v205, v194, v195
 v_mfma_f32_16x16x32_bf16 a[152:155], a[248:251], v[200:203], a[152:155]
 v_exp_f32 v197, v197
 v_add_f32 v57, v57, v195
 v_mfma_f32_16x16x32_bf16 a[156:159], a[252:255], v[200:203], a[156:159]
 v_exp_f32 v198, v198
L1_loopB:
 s_waitcnt lgkmcnt(5)
 v_mfma_f32_16x16x32_bf16 v[184:187], a[192:195], v[64:67], v[160:163]
 v_cvt_pk_bf16_f32 v206, v196, v197
 v_exp_f32 v199, v199
 v_mfma_f32_16x16x32_bf16 v[188:191], a[196:199], v[64:67], v[160:163]
 v_add_f32 v57, v57, v192
 v_cvt_pk_bf16_f32 v207, v198, v199
 v_add_f32 v57, v57, v196
 v_mfma_f32_16x16x32_bf16 v[184:187], a[200:203], v[72:75], v[184:187]
 v_add_f32 v57, v57, v197
 v_add_f32 v57, v57, v198
 v_add_f32 v57, v57, v199
 v_mfma_f32_16x16x32_bf16 v[188:191], a[204:207], v[72:75], v[188:191]
 s_waitcnt lgkmcnt(0)
 v_mfma_f32_16x16x32_bf16 v[184:187], a[208:211], v[80:83], v[184:187]
 v_mfma_f32_16x16x32_bf16 v[188:191], a[212:215], v[80:83], v[188:191]
 s_cmp_lt_u32 s57, 22
 s_cselect_b32 s30, 262144, 0
 s_add_u32 s57, s57, 1
 v_mfma_f32_16x16x32_bf16 v[184:187], a[216:219], v[88:91], v[184:187]
 s_add_u32 m0, s94, 0
 v_mfma_f32_16x16x32_bf16 v[188:191], a[220:223], v[88:91], v[188:191]
 s_waitcnt vmcnt(16)
 s_barrier
 v_mfma_f32_16x16x32_bf16 a[160:163], a[224:227], v[204:207], a[160:163]
 ds_read_b64_tr_b16 a[224:225], v40
 v_exp_f32 v184, v184
 v_mfma_f32_16x16x32_bf16 a[164:167], a[228:231], v[204:207], a[164:167]
 ds_read_b64_tr_b16 a[228:229], v41
 v_exp_f32 v185, v185
 v_mfma_f32_16x16x32_bf16 a[168:171], a[232:235], v[204:207], a[168:171]
 ds_read_b64_tr_b16 a[232:233], v42
 v_exp_f32 v186, v186
 v_mfma_f32_16x16x32_bf16 a[172:175], a[236:239], v[204:207], a[172:175]
 ds_read_b64_tr_b16 a[236:237], v43
 v_cvt_pk_bf16_f32 v200, v184, v185
 v_add_f32 v52, v52, v185
 v_mfma_f32_16x16x32_bf16 a[176:179], a[240:243], v[204:207], a[176:179]
 ds_read_b64_tr_b16 a[226:227], v40 offset:4096
 ds_read_b64_tr_b16 a[240:241], v44
 v_add_f32 v52, v52, v186
 v_mfma_f32_16x16x32_bf16 a[180:183], a[244:247], v[204:207], a[180:183]
 ds_read_b64_tr_b16 a[230:231], v41 offset:4096
 ds_read_b64_tr_b16 a[244:245], v45
 v_mfma_f32_16x16x32_bf16 a[184:187], a[248:251], v[204:207], a[184:187]
 ds_read_b64_tr_b16 a[234:235], v42 offset:4096
 ds_read_b64_tr_b16 a[248:249], v46
 v_mfma_f32_16x16x32_bf16 a[188:191], a[252:255], v[204:207], a[188:191]
 ds_read_b64_tr_b16 a[238:239], v43 offset:4096
 ds_read_b64_tr_b16 a[252:253], v47
 v_mfma_f32_16x16x32_bf16 v[192:195], a[192:195], v[68:71], v[164:167]
 ds_read_b64_tr_b16 a[242:243], v44 offset:4096
 v_exp_f32 v187, v187
 v_mfma_f32_16x16x32_bf16 v[196:199], a[196:199], v[68:71], v[164:167]
 ds_read_b64_tr_b16 a[246:247], v45 offset:4096
 v_exp_f32 v188, v188
 v_mfma_f32_16x16x32_bf16 v[192:195], a[200:203], v[76:79], v[192:195]
 ds_read_b64_tr_b16 a[250:251], v46 offset:4096
 v_cvt_pk_bf16_f32 v201, v186, v187
 v_add_f32 v52, v52, v187
 v_mfma_f32_16x16x32_bf16 v[196:199], a[204:207], v[76:79], v[196:199]
 ds_read_b64_tr_b16 a[254:255], v47 offset:4096
 v_exp_f32 v189, v189
 v_mfma_f32_16x16x32_bf16 v[192:195], a[208:211], v[84:87], v[192:195]
 buffer_load_dwordx4 v48, s[28:31], s50 offen nt lds
 v_exp_f32 v190, v190
 v_mfma_f32_16x16x32_bf16 v[196:199], a[212:215], v[84:87], v[196:199]
 v_cvt_pk_bf16_f32 v202, v188, v189
 v_exp_f32 v191, v191
 v_mfma_f32_16x16x32_bf16 v[192:195], a[216:219], v[92:95], v[192:195]
 buffer_load_dwordx4 v49, s[28:31], s50 offen offset:1024 nt lds
 v_add_f32 v52, v52, v184
 v_cvt_pk_bf16_f32 v203, v190, v191
 v_mfma_f32_16x16x32_bf16 v[196:199], a[220:223], v[92:95], v[196:199]
 v_add_f32 v52, v52, v188
 v_add_f32 v52, v52, v189
 s_waitcnt lgkmcnt(5)
 v_mfma_f32_16x16x32_bf16 a[0:3], a[224:227], v[200:203], a[0:3]
 buffer_load_dwordx4 v50, s[28:31], s50 offen offset:2048 nt lds
 v_exp_f32 v192, v192
 v_mfma_f32_16x16x32_bf16 a[4:7], a[228:231], v[200:203], a[4:7]
 v_exp_f32 v193, v193
 v_add_f32 v52, v52, v190
 v_mfma_f32_16x16x32_bf16 a[8:11], a[232:235], v[200:203], a[8:11]
 buffer_load_dwordx4 v51, s[28:31], s50 offen offset:3072 nt lds
 v_exp_f32 v194, v194
 v_mfma_f32_16x16x32_bf16 a[12:15], a[236:239], v[200:203], a[12:15]
 v_cvt_pk_bf16_f32 v204, v192, v193
 v_add_f32 v52, v52, v191
 s_waitcnt lgkmcnt(0)
 v_mfma_f32_16x16x32_bf16 a[16:19], a[240:243], v[200:203], a[16:19]
 s_add_u32 m0, s94, 4096
 v_exp_f32 v195, v195
 v_mfma_f32_16x16x32_bf16 a[20:23], a[244:247], v[200:203], a[20:23]
 v_exp_f32 v196, v196
 v_cvt_pk_bf16_f32 v205, v194, v195
 v_mfma_f32_16x16x32_bf16 a[24:27], a[248:251], v[200:203], a[24:27]
 buffer_load_dwordx4 v48, s[28:31], s51 offen nt lds
 v_exp_f32 v197, v197
 v_mfma_f32_16x16x32_bf16 a[28:31], a[252:255], v[200:203], a[28:31]
 v_exp_f32 v198, v198
 v_cvt_pk_bf16_f32 v206, v196, v197
 v_mfma_f32_16x16x32_bf16 v[184:187], a[192:195], v[96:99], v[168:171]
 buffer_load_dwordx4 v49, s[28:31], s51 offen offset:1024 nt lds
 v_exp_f32 v199, v199
 v_mfma_f32_16x16x32_bf16 v[188:191], a[196:199], v[96:99], v[168:171]
 v_add_f32 v53, v53, v192
 v_cvt_pk_bf16_f32 v207, v198, v199
 v_mfma_f32_16x16x32_bf16 v[184:187], a[200:203], v[104:107], v[184:187]
 buffer_load_dwordx4 v50, s[28:31], s51 offen offset:2048 nt lds
 v_add_f32 v53, v53, v193
 v_mfma_f32_16x16x32_bf16 v[188:191], a[204:207], v[104:107], v[188:191]
 v_add_f32 v53, v53, v194
 v_add_f32 v53, v53, v195
 v_mfma_f32_16x16x32_bf16 v[184:187], a[208:211], v[112:115], v[184:187]
 buffer_load_dwordx4 v51, s[28:31], s51 offen offset:3072 nt lds
 v_add_f32 v53, v53, v196
 v_mfma_f32_16x16x32_bf16 v[188:191], a[212:215], v[112:115], v[188:191]
 v_add_f32 v53, v53, v197
 v_add_f32 v53, v53, v198
 v_mfma_f32_16x16x32_bf16 v[184:187], a[216:219], v[120:123], v[184:187]
 v_add_f32 v53, v53, v199
 v_mfma_f32_16x16x32_bf16 v[188:191], a[220:223], v[120:123], v[188:191]
 s_add_u32 s50, s50, 8192
 s_and_b32 s50, s50, 262143
 s_add_u32 s51, s50, 4096
 v_mfma_f32_16x16x32_bf16 a[32:35], a[224:227], v[204:207], a[32:35]
 v_exp_f32 v184, v184
 v_mfma_f32_16x16x32_bf16 a[36:39], a[228:231], v[204:207], a[36:39]
 v_exp_f32 v185, v185
 v_mfma_f32_16x16x32_bf16 a[40:43], a[232:235], v[204:207], a[40:43]
 v_exp_f32 v186, v186
 v_mfma_f32_16x16x32_bf16 a[44:47], a[236:239], v[204:207], a[44:47]
 v_cvt_pk_bf16_f32 v200, v184, v185
 v_add_f32 v54, v54, v185
 v_mfma_f32_16x16x32_bf16 a[48:51], a[240:243], v[204:207], a[48:51]
 v_exp_f32 v187, v187
 v_mfma_f32_16x16x32_bf16 a[52:55], a[244:247], v[204:207], a[52:55]
 v_exp_f32 v188, v188
 v_mfma_f32_16x16x32_bf16 a[56:59], a[248:251], v[204:207], a[56:59]
 v_cvt_pk_bf16_f32 v201, v186, v187
 v_add_f32 v54, v54, v186
 v_mfma_f32_16x16x32_bf16 a[60:63], a[252:255], v[204:207], a[60:63]
 v_exp_f32 v189, v189
 v_mfma_f32_16x16x32_bf16 v[192:195], a[192:195], v[100:103], v[172:175]
 v_exp_f32 v190, v190
 v_mfma_f32_16x16x32_bf16 v[196:199], a[196:199], v[100:103], v[172:175]
 v_cvt_pk_bf16_f32 v202, v188, v189
 v_add_f32 v54, v54, v187
 v_mfma_f32_16x16x32_bf16 v[192:195], a[200:203], v[108:111], v[192:195]
 v_exp_f32 v191, v191
 v_mfma_f32_16x16x32_bf16 v[196:199], a[204:207], v[108:111], v[196:199]
 v_add_f32 v54, v54, v184
 v_cvt_pk_bf16_f32 v203, v190, v191
 v_mfma_f32_16x16x32_bf16 v[192:195], a[208:211], v[116:119], v[192:195]
 v_add_f32 v54, v54, v188
 v_add_f32 v54, v54, v189
 v_mfma_f32_16x16x32_bf16 v[196:199], a[212:215], v[116:119], v[196:199]
 v_add_f32 v54, v54, v190
 v_add_f32 v54, v54, v191
 v_mfma_f32_16x16x32_bf16 v[192:195], a[216:219], v[124:127], v[192:195]
 v_mfma_f32_16x16x32_bf16 v[196:199], a[220:223], v[124:127], v[196:199]
 v_mfma_f32_16x16x32_bf16 a[64:67], a[224:227], v[200:203], a[64:67]
 v_exp_f32 v192, v192
 v_mfma_f32_16x16x32_bf16 a[68:71], a[228:231], v[200:203], a[68:71]
 v_exp_f32 v193, v193
 v_mfma_f32_16x16x32_bf16 a[72:75], a[232:235], v[200:203], a[72:75]
 v_exp_f32 v194, v194
 v_mfma_f32_16x16x32_bf16 a[76:79], a[236:239], v[200:203], a[76:79]
 v_cvt_pk_bf16_f32 v204, v192, v193
 v_add_f32 v55, v55, v193
 v_mfma_f32_16x16x32_bf16 a[80:83], a[240:243], v[200:203], a[80:83]
 v_exp_f32 v195, v195
 v_mfma_f32_16x16x32_bf16 a[84:87], a[244:247], v[200:203], a[84:87]
 v_exp_f32 v196, v196
 v_mfma_f32_16x16x32_bf16 a[88:91], a[248:251], v[200:203], a[88:91]
 v_cvt_pk_bf16_f32 v205, v194, v195
 v_add_f32 v55, v55, v194
 v_mfma_f32_16x16x32_bf16 a[92:95], a[252:255], v[200:203], a[92:95]
 v_exp_f32 v197, v197
 v_mfma_f32_16x16x32_bf16 v[184:187], a[192:195], v[128:131], v[176:179]
 v_exp_f32 v198, v198
 v_mfma_f32_16x16x32_bf16 v[188:191], a[196:199], v[128:131], v[176:179]
 v_cvt_pk_bf16_f32 v206, v196, v197
 v_add_f32 v55, v55, v195
 v_mfma_f32_16x16x32_bf16 v[184:187], a[200:203], v[136:139], v[184:187]
 v_exp_f32 v199, v199
 v_mfma_f32_16x16x32_bf16 v[188:191], a[204:207], v[136:139], v[188:191]
 v_add_f32 v55, v55, v192
 v_cvt_pk_bf16_f32 v207, v198, v199
 v_mfma_f32_16x16x32_bf16 v[184:187], a[208:211], v[144:147], v[184:187]
 v_add_f32 v55, v55, v196
 v_add_f32 v55, v55, v197
 v_mfma_f32_16x16x32_bf16 v[188:191], a[212:215], v[144:147], v[188:191]
 v_add_f32 v55, v55, v198
 v_add_f32 v55, v55, v199
 v_mfma_f32_16x16x32_bf16 v[184:187], a[216:219], v[152:155], v[184:187]
 v_mfma_f32_16x16x32_bf16 v[188:191], a[220:223], v[152:155], v[188:191]
 v_mfma_f32_16x16x32_bf16 a[96:99], a[224:227], v[204:207], a[96:99]
 v_exp_f32 v184, v184
 v_mfma_f32_16x16x32_bf16 a[100:103], a[228:231], v[204:207], a[100:103]
 v_exp_f32 v185, v185
 v_mfma_f32_16x16x32_bf16 a[104:107], a[232:235], v[204:207], a[104:107]
 v_exp_f32 v186, v186
 v_cvt_pk_bf16_f32 v200, v184, v185
 v_mfma_f32_16x16x32_bf16 a[108:111], a[236:239], v[204:207], a[108:111]
 v_exp_f32 v187, v187
 v_add_f32 v56, v56, v185
 v_mfma_f32_16x16x32_bf16 a[112:115], a[240:243], v[204:207], a[112:115]
 v_exp_f32 v188, v188
 v_cvt_pk_bf16_f32 v201, v186, v187
 v_mfma_f32_16x16x32_bf16 a[116:119], a[244:247], v[204:207], a[116:119]
 v_exp_f32 v189, v189
 v_add_f32 v56, v56, v186
 v_mfma_f32_16x16x32_bf16 a[120:123], a[248:251], v[204:207], a[120:123]
 v_exp_f32 v190, v190
 v_cvt_pk_bf16_f32 v202, v188, v189
 v_mfma_f32_16x16x32_bf16 a[124:127], a[252:255], v[204:207], a[124:127]
 v_exp_f32 v191, v191
 v_add_f32 v56, v56, v184
 v_mfma_f32_16x16x32_bf16 v[192:195], a[192:195], v[132:135], v[180:183]
 ds_read_b64 a[192:193], v32 offset:16384
 v_cvt_pk_bf16_f32 v203, v190, v191
 v_add_f32 v56, v56, v187
 v_mfma_f32_16x16x32_bf16 v[196:199], a[196:199], v[132:135], v[180:183]
 ds_read_b64 a[196:197], v32 offset:20480
 v_add_f32 v56, v56, v188
 v_add_f32 v56, v56, v189
 v_mfma_f32_16x16x32_bf16 v[192:195], a[200:203], v[140:143], v[192:195]
 ds_read_b64 a[200:201], v34 offset:16384
 v_add_f32 v56, v56, v190
 v_add_f32 v56, v56, v191
 v_mfma_f32_16x16x32_bf16 v[196:199], a[204:207], v[140:143], v[196:199]
 ds_read_b64 a[204:205], v34 offset:20480
 v_mfma_f32_16x16x32_bf16 v[192:195], a[208:211], v[148:151], v[192:195]
 ds_read_b64 a[194:195], v33 offset:16384
 ds_read_b64 a[208:209], v36 offset:16384
 v_mfma_f32_16x16x32_bf16 v[196:199], a[212:215], v[148:151], v[196:199]
 ds_read_b64 a[198:199], v33 offset:20480
 ds_read_b64 a[212:213], v36 offset:20480
 v_mfma_f32_16x16x32_bf16 v[192:195], a[216:219], v[156:159], v[192:195]
 ds_read_b64 a[202:203], v35 offset:16384
 ds_read_b64 a[216:217], v38 offset:16384
 v_mfma_f32_16x16x32_bf16 v[196:199], a[220:223], v[156:159], v[196:199]
 ds_read_b64 a[206:207], v35 offset:20480
 ds_read_b64 a[220:221], v38 offset:20480
 v_mfma_f32_16x16x32_bf16 a[128:131], a[224:227], v[200:203], a[128:131]
 ds_read_b64 a[210:211], v37 offset:16384
 v_exp_f32 v192, v192
 v_mfma_f32_16x16x32_bf16 a[132:135], a[228:231], v[200:203], a[132:135]
 ds_read_b64 a[214:215], v37 offset:20480
 v_exp_f32 v193, v193
 v_mfma_f32_16x16x32_bf16 a[136:139], a[232:235], v[200:203], a[136:139]
 ds_read_b64 a[218:219], v39 offset:16384
 v_exp_f32 v194, v194
 v_mfma_f32_16x16x32_bf16 a[140:143], a[236:239], v[200:203], a[140:143]
 ds_read_b64 a[222:223], v39 offset:20480
 v_cvt_pk_bf16_f32 v204, v192, v193
 v_add_f32 v57, v57, v193
 v_mfma_f32_16x16x32_bf16 a[144:147], a[240:243], v[200:203], a[144:147]
 v_exp_f32 v195, v195
 v_add_f32 v57, v57, v194
 v_mfma_f32_16x16x32_bf16 a[148:151], a[244:247], v[200:203], a[148:151]
 v_exp_f32 v196, v196
 v_cvt_pk_bf16_f32 v205, v194, v195
 v_mfma_f32_16x16x32_bf16 a[152:155], a[248:251], v[200:203], a[152:155]
 v_exp_f32 v197, v197
 v_add_f32 v57, v57, v195
 v_mfma_f32_16x16x32_bf16 a[156:159], a[252:255], v[200:203], a[156:159]
 v_exp_f32 v198, v198
 s_waitcnt lgkmcnt(5)
 v_mfma_f32_16x16x32_bf16 v[184:187], a[192:195], v[64:67], v[160:163]
 v_cvt_pk_bf16_f32 v206, v196, v197
 v_exp_f32 v199, v199
 v_mfma_f32_16x16x32_bf16 v[188:191], a[196:199], v[64:67], v[160:163]
 v_add_f32 v57, v57, v192
 v_cvt_pk_bf16_f32 v207, v198, v199
 v_add_f32 v57, v57, v196
 v_mfma_f32_16x16x32_bf16 v[184:187], a[200:203], v[72:75], v[184:187]
 v_add_f32 v57, v57, v197
 v_add_f32 v57, v57, v198
 v_add_f32 v57, v57, v199
 v_mfma_f32_16x16x32_bf16 v[188:191], a[204:207], v[72:75], v[188:191]
 s_waitcnt lgkmcnt(0)
 v_mfma_f32_16x16x32_bf16 v[184:187], a[208:211], v[80:83], v[184:187]
 v_mfma_f32_16x16x32_bf16 v[188:191], a[212:215], v[80:83], v[188:191]
 s_cmp_lt_u32 s57, 22
 s_cselect_b32 s30, 262144, 0
 s_add_u32 s57, s57, 1
 v_mfma_f32_16x16x32_bf16 v[184:187], a[216:219], v[88:91], v[184:187]
 s_add_u32 m0, s95, 0
 v_mfma_f32_16x16x32_bf16 v[188:191], a[220:223], v[88:91], v[188:191]
 s_waitcnt vmcnt(16)
 s_barrier
 v_mfma_f32_16x16x32_bf16 a[160:163], a[224:227], v[204:207], a[160:163]
 ds_read_b64_tr_b16 a[224:225], v40 offset:16384
 v_exp_f32 v184, v184
 v_mfma_f32_16x16x32_bf16 a[164:167], a[228:231], v[204:207], a[164:167]
 ds_read_b64_tr_b16 a[228:229], v41 offset:16384
 v_exp_f32 v185, v185
 v_mfma_f32_16x16x32_bf16 a[168:171], a[232:235], v[204:207], a[168:171]
 ds_read_b64_tr_b16 a[232:233], v42 offset:16384
 v_exp_f32 v186, v186
 v_mfma_f32_16x16x32_bf16 a[172:175], a[236:239], v[204:207], a[172:175]
 ds_read_b64_tr_b16 a[236:237], v43 offset:16384
 v_cvt_pk_bf16_f32 v200, v184, v185
 v_add_f32 v52, v52, v185
 v_mfma_f32_16x16x32_bf16 a[176:179], a[240:243], v[204:207], a[176:179]
 ds_read_b64_tr_b16 a[226:227], v40 offset:20480
 ds_read_b64_tr_b16 a[240:241], v44 offset:16384
 v_add_f32 v52, v52, v186
 v_mfma_f32_16x16x32_bf16 a[180:183], a[244:247], v[204:207], a[180:183]
 ds_read_b64_tr_b16 a[230:231], v41 offset:20480
 ds_read_b64_tr_b16 a[244:245], v45 offset:16384
 v_mfma_f32_16x16x32_bf16 a[184:187], a[248:251], v[204:207], a[184:187]
 ds_read_b64_tr_b16 a[234:235], v42 offset:20480
 ds_read_b64_tr_b16 a[248:249], v46 offset:16384
 v_mfma_f32_16x16x32_bf16 a[188:191], a[252:255], v[204:207], a[188:191]
 ds_read_b64_tr_b16 a[238:239], v43 offset:20480
 ds_read_b64_tr_b16 a[252:253], v47 offset:16384
 v_mfma_f32_16x16x32_bf16 v[192:195], a[192:195], v[68:71], v[164:167]
 ds_read_b64_tr_b16 a[242:243], v44 offset:20480
 v_exp_f32 v187, v187
 v_mfma_f32_16x16x32_bf16 v[196:199], a[196:199], v[68:71], v[164:167]
 ds_read_b64_tr_b16 a[246:247], v45 offset:20480
 v_exp_f32 v188, v188
 v_mfma_f32_16x16x32_bf16 v[192:195], a[200:203], v[76:79], v[192:195]
 ds_read_b64_tr_b16 a[250:251], v46 offset:20480
 v_cvt_pk_bf16_f32 v201, v186, v187
 v_add_f32 v52, v52, v187
 v_mfma_f32_16x16x32_bf16 v[196:199], a[204:207], v[76:79], v[196:199]
 ds_read_b64_tr_b16 a[254:255], v47 offset:20480
 v_exp_f32 v189, v189
 v_mfma_f32_16x16x32_bf16 v[192:195], a[208:211], v[84:87], v[192:195]
 buffer_load_dwordx4 v48, s[28:31], s50 offen nt lds
 v_exp_f32 v190, v190
 v_mfma_f32_16x16x32_bf16 v[196:199], a[212:215], v[84:87], v[196:199]
 v_cvt_pk_bf16_f32 v202, v188, v189
 v_exp_f32 v191, v191
 v_mfma_f32_16x16x32_bf16 v[192:195], a[216:219], v[92:95], v[192:195]
 buffer_load_dwordx4 v49, s[28:31], s50 offen offset:1024 nt lds
 v_add_f32 v52, v52, v184
 v_cvt_pk_bf16_f32 v203, v190, v191
 v_mfma_f32_16x16x32_bf16 v[196:199], a[220:223], v[92:95], v[196:199]
 v_add_f32 v52, v52, v188
 v_add_f32 v52, v52, v189
 s_waitcnt lgkmcnt(5)
 v_mfma_f32_16x16x32_bf16 a[0:3], a[224:227], v[200:203], a[0:3]
 buffer_load_dwordx4 v50, s[28:31], s50 offen offset:2048 nt lds
 v_exp_f32 v192, v192
 v_mfma_f32_16x16x32_bf16 a[4:7], a[228:231], v[200:203], a[4:7]
 v_exp_f32 v193, v193
 v_add_f32 v52, v52, v190
 v_mfma_f32_16x16x32_bf16 a[8:11], a[232:235], v[200:203], a[8:11]
 buffer_load_dwordx4 v51, s[28:31], s50 offen offset:3072 nt lds
 v_exp_f32 v194, v194
 v_mfma_f32_16x16x32_bf16 a[12:15], a[236:239], v[200:203], a[12:15]
 v_cvt_pk_bf16_f32 v204, v192, v193
 v_add_f32 v52, v52, v191
 s_waitcnt lgkmcnt(0)
 v_mfma_f32_16x16x32_bf16 a[16:19], a[240:243], v[200:203], a[16:19]
 s_add_u32 m0, s95, 4096
 v_exp_f32 v195, v195
 v_mfma_f32_16x16x32_bf16 a[20:23], a[244:247], v[200:203], a[20:23]
 v_exp_f32 v196, v196
 v_cvt_pk_bf16_f32 v205, v194, v195
 v_mfma_f32_16x16x32_bf16 a[24:27], a[248:251], v[200:203], a[24:27]
 buffer_load_dwordx4 v48, s[28:31], s51 offen nt lds
 v_exp_f32 v197, v197
 v_mfma_f32_16x16x32_bf16 a[28:31], a[252:255], v[200:203], a[28:31]
 v_exp_f32 v198, v198
 v_cvt_pk_bf16_f32 v206, v196, v197
 v_mfma_f32_16x16x32_bf16 v[184:187], a[192:195], v[96:99], v[168:171]
 buffer_load_dwordx4 v49, s[28:31], s51 offen offset:1024 nt lds
 v_exp_f32 v199, v199
 v_mfma_f32_16x16x32_bf16 v[188:191], a[196:199], v[96:99], v[168:171]
 v_add_f32 v53, v53, v192
 v_cvt_pk_bf16_f32 v207, v198, v199
 v_mfma_f32_16x16x32_bf16 v[184:187], a[200:203], v[104:107], v[184:187]
 buffer_load_dwordx4 v50, s[28:31], s51 offen offset:2048 nt lds
 v_add_f32 v53, v53, v193
 v_mfma_f32_16x16x32_bf16 v[188:191], a[204:207], v[104:107], v[188:191]
 v_add_f32 v53, v53, v194
 v_add_f32 v53, v53, v195
 v_mfma_f32_16x16x32_bf16 v[184:187], a[208:211], v[112:115], v[184:187]
 buffer_load_dwordx4 v51, s[28:31], s51 offen offset:3072 nt lds
 v_add_f32 v53, v53, v196
 v_mfma_f32_16x16x32_bf16 v[188:191], a[212:215], v[112:115], v[188:191]
 v_add_f32 v53, v53, v197
 v_add_f32 v53, v53, v198
 v_mfma_f32_16x16x32_bf16 v[184:187], a[216:219], v[120:123], v[184:187]
 v_add_f32 v53, v53, v199
 v_mfma_f32_16x16x32_bf16 v[188:191], a[220:223], v[120:123], v[188:191]
 s_add_u32 s50, s50, 8192
 s_and_b32 s50, s50, 262143
 s_add_u32 s51, s50, 4096
 v_mfma_f32_16x16x32_bf16 a[32:35], a[224:227], v[204:207], a[32:35]
 s_mov_b32 s94, s78
 v_exp_f32 v184, v184
 v_mfma_f32_16x16x32_bf16 a[36:39], a[228:231], v[204:207], a[36:39]
 v_exp_f32 v185, v185
 v_mfma_f32_16x16x32_bf16 a[40:43], a[232:235], v[204:207], a[40:43]
 v_exp_f32 v186, v186
 v_mfma_f32_16x16x32_bf16 a[44:47], a[236:239], v[204:207], a[44:47]
 v_cvt_pk_bf16_f32 v200, v184, v185
 v_add_f32 v54, v54, v185
 v_mfma_f32_16x16x32_bf16 a[48:51], a[240:243], v[204:207], a[48:51]
 v_exp_f32 v187, v187
 v_mfma_f32_16x16x32_bf16 a[52:55], a[244:247], v[204:207], a[52:55]
 v_exp_f32 v188, v188
 v_mfma_f32_16x16x32_bf16 a[56:59], a[248:251], v[204:207], a[56:59]
 v_cvt_pk_bf16_f32 v201, v186, v187
 v_add_f32 v54, v54, v186
 v_mfma_f32_16x16x32_bf16 a[60:63], a[252:255], v[204:207], a[60:63]
 v_exp_f32 v189, v189
 v_mfma_f32_16x16x32_bf16 v[192:195], a[192:195], v[100:103], v[172:175]
 v_exp_f32 v190, v190
 v_mfma_f32_16x16x32_bf16 v[196:199], a[196:199], v[100:103], v[172:175]
 v_cvt_pk_bf16_f32 v202, v188, v189
 v_add_f32 v54, v54, v187
 v_mfma_f32_16x16x32_bf16 v[192:195], a[200:203], v[108:111], v[192:195]
 v_exp_f32 v191, v191
 v_mfma_f32_16x16x32_bf16 v[196:199], a[204:207], v[108:111], v[196:199]
 v_add_f32 v54, v54, v184
 v_cvt_pk_bf16_f32 v203, v190, v191
 v_mfma_f32_16x16x32_bf16 v[192:195], a[208:211], v[116:119], v[192:195]
 v_add_f32 v54, v54, v188
 v_add_f32 v54, v54, v189
 v_mfma_f32_16x16x32_bf16 v[196:199], a[212:215], v[116:119], v[196:199]
 v_add_f32 v54, v54, v190
 v_add_f32 v54, v54, v191
 v_mfma_f32_16x16x32_bf16 v[192:195], a[216:219], v[124:127], v[192:195]
 v_mfma_f32_16x16x32_bf16 v[196:199], a[220:223], v[124:127], v[196:199]
 v_mfma_f32_16x16x32_bf16 a[64:67], a[224:227], v[200:203], a[64:67]
 v_exp_f32 v192, v192
 v_mfma_f32_16x16x32_bf16 a[68:71], a[228:231], v[200:203], a[68:71]
 v_exp_f32 v193, v193
 v_mfma_f32_16x16x32_bf16 a[72:75], a[232:235], v[200:203], a[72:75]
 v_exp_f32 v194, v194
 v_mfma_f32_16x16x32_bf16 a[76:79], a[236:239], v[200:203], a[76:79]
 v_cvt_pk_bf16_f32 v204, v192, v193
 v_add_f32 v55, v55, v193
 v_mfma_f32_16x16x32_bf16 a[80:83], a[240:243], v[200:203], a[80:83]
 v_exp_f32 v195, v195
 v_mfma_f32_16x16x32_bf16 a[84:87], a[244:247], v[200:203], a[84:87]
 v_exp_f32 v196, v196
 v_mfma_f32_16x16x32_bf16 a[88:91], a[248:251], v[200:203], a[88:91]
 v_cvt_pk_bf16_f32 v205, v194, v195
 v_add_f32 v55, v55, v194
 v_mfma_f32_16x16x32_bf16 a[92:95], a[252:255], v[200:203], a[92:95]
 v_exp_f32 v197, v197
 v_mfma_f32_16x16x32_bf16 v[184:187], a[192:195], v[128:131], v[176:179]
 v_exp_f32 v198, v198
 v_mfma_f32_16x16x32_bf16 v[188:191], a[196:199], v[128:131], v[176:179]
 v_cvt_pk_bf16_f32 v206, v196, v197
 v_add_f32 v55, v55, v195
 v_mfma_f32_16x16x32_bf16 v[184:187], a[200:203], v[136:139], v[184:187]
 v_exp_f32 v199, v199
 v_mfma_f32_16x16x32_bf16 v[188:191], a[204:207], v[136:139], v[188:191]
 v_add_f32 v55, v55, v192
 v_cvt_pk_bf16_f32 v207, v198, v199
 v_mfma_f32_16x16x32_bf16 v[184:187], a[208:211], v[144:147], v[184:187]
 v_add_f32 v55, v55, v196
 v_add_f32 v55, v55, v197
 v_mfma_f32_16x16x32_bf16 v[188:191], a[212:215], v[144:147], v[188:191]
 v_add_f32 v55, v55, v198
 v_add_f32 v55, v55, v199
 v_mfma_f32_16x16x32_bf16 v[184:187], a[216:219], v[152:155], v[184:187]
 v_mfma_f32_16x16x32_bf16 v[188:191], a[220:223], v[152:155], v[188:191]
 v_mfma_f32_16x16x32_bf16 a[96:99], a[224:227], v[204:207], a[96:99]
 v_exp_f32 v184, v184
 v_mfma_f32_16x16x32_bf16 a[100:103], a[228:231], v[204:207], a[100:103]
 v_exp_f32 v185, v185
 v_mfma_f32_16x16x32_bf16 a[104:107], a[232:235], v[204:207], a[104:107]
 v_exp_f32 v186, v186
 v_cvt_pk_bf16_f32 v200, v184, v185
 v_mfma_f32_16x16x32_bf16 a[108:111], a[236:239], v[204:207], a[108:111]
 v_exp_f32 v187, v187
 v_add_f32 v56, v56, v185
 v_mfma_f32_16x16x32_bf16 a[112:115], a[240:243], v[204:207], a[112:115]
 v_exp_f32 v188, v188
 v_cvt_pk_bf16_f32 v201, v186, v187
 v_mfma_f32_16x16x32_bf16 a[116:119], a[244:247], v[204:207], a[116:119]
 v_exp_f32 v189, v189
 v_add_f32 v56, v56, v186
 v_mfma_f32_16x16x32_bf16 a[120:123], a[248:251], v[204:207], a[120:123]
 v_exp_f32 v190, v190
 v_cvt_pk_bf16_f32 v202, v188, v189
 v_mfma_f32_16x16x32_bf16 a[124:127], a[252:255], v[204:207], a[124:127]
 v_exp_f32 v191, v191
 v_add_f32 v56, v56, v184
 v_mfma_f32_16x16x32_bf16 v[192:195], a[192:195], v[132:135], v[180:183]
 ds_read_b64 a[192:193], v32 offset:32768
 v_cvt_pk_bf16_f32 v203, v190, v191
 v_add_f32 v56, v56, v187
 v_mfma_f32_16x16x32_bf16 v[196:199], a[196:199], v[132:135], v[180:183]
 ds_read_b64 a[196:197], v32 offset:36864
 v_add_f32 v56, v56, v188
 v_add_f32 v56, v56, v189
 v_mfma_f32_16x16x32_bf16 v[192:195], a[200:203], v[140:143], v[192:195]
 ds_read_b64 a[200:201], v34 offset:32768
 v_add_f32 v56, v56, v190
 v_add_f32 v56, v56, v191
 v_mfma_f32_16x16x32_bf16 v[196:199], a[204:207], v[140:143], v[196:199]
 ds_read_b64 a[204:205], v34 offset:36864
 v_mfma_f32_16x16x32_bf16 v[192:195], a[208:211], v[148:151], v[192:195]
 ds_read_b64 a[194:195], v33 offset:32768
 ds_read_b64 a[208:209], v36 offset:32768
 v_mfma_f32_16x16x32_bf16 v[196:199], a[212:215], v[148:151], v[196:199]
 ds_read_b64 a[198:199], v33 offset:36864
 ds_read_b64 a[212:213], v36 offset:36864
 v_mfma_f32_16x16x32_bf16 v[192:195], a[216:219], v[156:159], v[192:195]
 ds_read_b64 a[202:203], v35 offset:32768
 ds_read_b64 a[216:217], v38 offset:32768
 v_mfma_f32_16x16x32_bf16 v[196:199], a[220:223], v[156:159], v[196:199]
 ds_read_b64 a[206:207], v35 offset:36864
 ds_read_b64 a[220:221], v38 offset:36864
 v_mfma_f32_16x16x32_bf16 a[128:131], a[224:227], v[200:203], a[128:131]
 ds_read_b64 a[210:211], v37 offset:32768
 v_exp_f32 v192, v192
 v_mfma_f32_16x16x32_bf16 a[132:135], a[228:231], v[200:203], a[132:135]
 ds_read_b64 a[214:215], v37 offset:36864
 v_exp_f32 v193, v193
 v_mfma_f32_16x16x32_bf16 a[136:139], a[232:235], v[200:203], a[136:139]
 ds_read_b64 a[218:219], v39 offset:32768
 v_exp_f32 v194, v194
 v_mfma_f32_16x16x32_bf16 a[140:143], a[236:239], v[200:203], a[140:143]
 ds_read_b64 a[222:223], v39 offset:36864
 v_cvt_pk_bf16_f32 v204, v192, v193
 v_add_f32 v57, v57, v193
 v_mfma_f32_16x16x32_bf16 a[144:147], a[240:243], v[200:203], a[144:147]
 v_exp_f32 v195, v195
 v_add_f32 v57, v57, v194
 v_mfma_f32_16x16x32_bf16 a[148:151], a[244:247], v[200:203], a[148:151]
 v_exp_f32 v196, v196
 v_cvt_pk_bf16_f32 v205, v194, v195
 v_mfma_f32_16x16x32_bf16 a[152:155], a[248:251], v[200:203], a[152:155]
 v_exp_f32 v197, v197
 v_add_f32 v57, v57, v195
 v_mfma_f32_16x16x32_bf16 a[156:159], a[252:255], v[200:203], a[156:159]
 v_exp_f32 v198, v198
 s_waitcnt lgkmcnt(5)
 v_mfma_f32_16x16x32_bf16 v[184:187], a[192:195], v[64:67], v[160:163]
 v_cvt_pk_bf16_f32 v206, v196, v197
 v_exp_f32 v199, v199
 v_mfma_f32_16x16x32_bf16 v[188:191], a[196:199], v[64:67], v[160:163]
 v_add_f32 v57, v57, v192
 v_cvt_pk_bf16_f32 v207, v198, v199
 v_add_f32 v57, v57, v196
 v_mfma_f32_16x16x32_bf16 v[184:187], a[200:203], v[72:75], v[184:187]
 v_add_f32 v57, v57, v197
 v_add_f32 v57, v57, v198
 v_add_f32 v57, v57, v199
 v_mfma_f32_16x16x32_bf16 v[188:191], a[204:207], v[72:75], v[188:191]
 s_waitcnt lgkmcnt(0)
 v_mfma_f32_16x16x32_bf16 v[184:187], a[208:211], v[80:83], v[184:187]
 v_mfma_f32_16x16x32_bf16 v[188:191], a[212:215], v[80:83], v[188:191]
 s_cmp_lt_u32 s57, 22
 s_cselect_b32 s30, 262144, 0
 s_add_u32 s57, s57, 1
 v_mfma_f32_16x16x32_bf16 v[184:187], a[216:219], v[88:91], v[184:187]
 s_add_u32 m0, s96, 0
 v_mfma_f32_16x16x32_bf16 v[188:191], a[220:223], v[88:91], v[188:191]
 s_waitcnt vmcnt(16)
 s_barrier
 v_mfma_f32_16x16x32_bf16 a[160:163], a[224:227], v[204:207], a[160:163]
 ds_read_b64_tr_b16 a[224:225], v40 offset:32768
 v_exp_f32 v184, v184
 v_mfma_f32_16x16x32_bf16 a[164:167], a[228:231], v[204:207], a[164:167]
 ds_read_b64_tr_b16 a[228:229], v41 offset:32768
 v_exp_f32 v185, v185
 v_mfma_f32_16x16x32_bf16 a[168:171], a[232:235], v[204:207], a[168:171]
 ds_read_b64_tr_b16 a[232:233], v42 offset:32768
 v_exp_f32 v186, v186
 v_mfma_f32_16x16x32_bf16 a[172:175], a[236:239], v[204:207], a[172:175]
 ds_read_b64_tr_b16 a[236:237], v43 offset:32768
 v_cvt_pk_bf16_f32 v200, v184, v185
 v_add_f32 v52, v52, v185
 v_mfma_f32_16x16x32_bf16 a[176:179], a[240:243], v[204:207], a[176:179]
 ds_read_b64_tr_b16 a[226:227], v40 offset:36864
 ds_read_b64_tr_b16 a[240:241], v44 offset:32768
 v_add_f32 v52, v52, v186
 v_mfma_f32_16x16x32_bf16 a[180:183], a[244:247], v[204:207], a[180:183]
 ds_read_b64_tr_b16 a[230:231], v41 offset:36864
 ds_read_b64_tr_b16 a[244:245], v45 offset:32768
 v_mfma_f32_16x16x32_bf16 a[184:187], a[248:251], v[204:207], a[184:187]
 ds_read_b64_tr_b16 a[234:235], v42 offset:36864
 ds_read_b64_tr_b16 a[248:249], v46 offset:32768
 v_mfma_f32_16x16x32_bf16 a[188:191], a[252:255], v[204:207], a[188:191]
 ds_read_b64_tr_b16 a[238:239], v43 offset:36864
 ds_read_b64_tr_b16 a[252:253], v47 offset:32768
 v_mfma_f32_16x16x32_bf16 v[192:195], a[192:195], v[68:71], v[164:167]
 ds_read_b64_tr_b16 a[242:243], v44 offset:36864
 v_exp_f32 v187, v187
 v_mfma_f32_16x16x32_bf16 v[196:199], a[196:199], v[68:71], v[164:167]
 ds_read_b64_tr_b16 a[246:247], v45 offset:36864
 v_exp_f32 v188, v188
 v_mfma_f32_16x16x32_bf16 v[192:195], a[200:203], v[76:79], v[192:195]
 ds_read_b64_tr_b16 a[250:251], v46 offset:36864
 v_cvt_pk_bf16_f32 v201, v186, v187
 v_add_f32 v52, v52, v187
 v_mfma_f32_16x16x32_bf16 v[196:199], a[204:207], v[76:79], v[196:199]
 ds_read_b64_tr_b16 a[254:255], v47 offset:36864
 v_exp_f32 v189, v189
 v_mfma_f32_16x16x32_bf16 v[192:195], a[208:211], v[84:87], v[192:195]
 buffer_load_dwordx4 v48, s[28:31], s50 offen nt lds
 v_exp_f32 v190, v190
 v_mfma_f32_16x16x32_bf16 v[196:199], a[212:215], v[84:87], v[196:199]
 v_cvt_pk_bf16_f32 v202, v188, v189
 v_exp_f32 v191, v191
 v_mfma_f32_16x16x32_bf16 v[192:195], a[216:219], v[92:95], v[192:195]
 buffer_load_dwordx4 v49, s[28:31], s50 offen offset:1024 nt lds
 v_add_f32 v52, v52, v184
 v_cvt_pk_bf16_f32 v203, v190, v191
 v_mfma_f32_16x16x32_bf16 v[196:199], a[220:223], v[92:95], v[196:199]
 v_add_f32 v52, v52, v188
 v_add_f32 v52, v52, v189
 s_waitcnt lgkmcnt(5)
 v_mfma_f32_16x16x32_bf16 a[0:3], a[224:227], v[200:203], a[0:3]
 buffer_load_dwordx4 v50, s[28:31], s50 offen offset:2048 nt lds
 v_exp_f32 v192, v192
 v_mfma_f32_16x16x32_bf16 a[4:7], a[228:231], v[200:203], a[4:7]
 v_exp_f32 v193, v193
 v_add_f32 v52, v52, v190
 v_mfma_f32_16x16x32_bf16 a[8:11], a[232:235], v[200:203], a[8:11]
 buffer_load_dwordx4 v51, s[28:31], s50 offen offset:3072 nt lds
 v_exp_f32 v194, v194
 v_mfma_f32_16x16x32_bf16 a[12:15], a[236:239], v[200:203], a[12:15]
 v_cvt_pk_bf16_f32 v204, v192, v193
 v_add_f32 v52, v52, v191
 s_waitcnt lgkmcnt(0)
 v_mfma_f32_16x16x32_bf16 a[16:19], a[240:243], v[200:203], a[16:19]
 s_add_u32 m0, s96, 4096
 v_exp_f32 v195, v195
 v_mfma_f32_16x16x32_bf16 a[20:23], a[244:247], v[200:203], a[20:23]
 v_exp_f32 v196, v196
 v_cvt_pk_bf16_f32 v205, v194, v195
 v_mfma_f32_16x16x32_bf16 a[24:27], a[248:251], v[200:203], a[24:27]
 buffer_load_dwordx4 v48, s[28:31], s51 offen nt lds
 v_exp_f32 v197, v197
 v_mfma_f32_16x16x32_bf16 a[28:31], a[252:255], v[200:203], a[28:31]
 v_exp_f32 v198, v198
 v_cvt_pk_bf16_f32 v206, v196, v197
 v_mfma_f32_16x16x32_bf16 v[184:187], a[192:195], v[96:99], v[168:171]
 buffer_load_dwordx4 v49, s[28:31], s51 offen offset:1024 nt lds
 v_exp_f32 v199, v199
 v_mfma_f32_16x16x32_bf16 v[188:191], a[196:199], v[96:99], v[168:171]
 v_add_f32 v53, v53, v192
 v_cvt_pk_bf16_f32 v207, v198, v199
 v_mfma_f32_16x16x32_bf16 v[184:187], a[200:203], v[104:107], v[184:187]
 buffer_load_dwordx4 v50, s[28:31], s51 offen offset:2048 nt lds
 v_add_f32 v53, v53, v193
 v_mfma_f32_16x16x32_bf16 v[188:191], a[204:207], v[104:107], v[188:191]
 v_add_f32 v53, v53, v194
 v_add_f32 v53, v53, v195
 v_mfma_f32_16x16x32_bf16 v[184:187], a[208:211], v[112:115], v[184:187]
 buffer_load_dwordx4 v51, s[28:31], s51 offen offset:3072 nt lds
 v_add_f32 v53, v53, v196
 v_mfma_f32_16x16x32_bf16 v[188:191], a[212:215], v[112:115], v[188:191]
 v_add_f32 v53, v53, v197
 v_add_f32 v53, v53, v198
 v_mfma_f32_16x16x32_bf16 v[184:187], a[216:219], v[120:123], v[184:187]
 v_add_f32 v53, v53, v199
 v_mfma_f32_16x16x32_bf16 v[188:191], a[220:223], v[120:123], v[188:191]
 s_add_u32 s50, s50, 8192
 s_and_b32 s50, s50, 262143
 s_add_u32 s51, s50, 4096
 v_mfma_f32_16x16x32_bf16 a[32:35], a[224:227], v[204:207], a[32:35]
 v_exp_f32 v184, v184
 v_mfma_f32_16x16x32_bf16 a[36:39], a[228:231], v[204:207], a[36:39]
 v_exp_f32 v185, v185
 v_mfma_f32_16x16x32_bf16 a[40:43], a[232:235], v[204:207], a[40:43]
 v_exp_f32 v186, v186
 v_mfma_f32_16x16x32_bf16 a[44:47], a[236:239], v[204:207], a[44:47]
 v_cvt_pk_bf16_f32 v200, v184, v185
 v_add_f32 v54, v54, v185
 v_mfma_f32_16x16x32_bf16 a[48:51], a[240:243], v[204:207], a[48:51]
 v_exp_f32 v187, v187
 v_mfma_f32_16x16x32_bf16 a[52:55], a[244:247], v[204:207], a[52:55]
 v_exp_f32 v188, v188
 v_mfma_f32_16x16x32_bf16 a[56:59], a[248:251], v[204:207], a[56:59]
 v_cvt_pk_bf16_f32 v201, v186, v187
 v_add_f32 v54, v54, v186
 v_mfma_f32_16x16x32_bf16 a[60:63], a[252:255], v[204:207], a[60:63]
 v_exp_f32 v189, v189
 v_mfma_f32_16x16x32_bf16 v[192:195], a[192:195], v[100:103], v[172:175]
 v_exp_f32 v190, v190
 v_mfma_f32_16x16x32_bf16 v[196:199], a[196:199], v[100:103], v[172:175]
 v_cvt_pk_bf16_f32 v202, v188, v189
 v_add_f32 v54, v54, v187
 v_mfma_f32_16x16x32_bf16 v[192:195], a[200:203], v[108:111], v[192:195]
 v_exp_f32 v191, v191
 v_mfma_f32_16x16x32_bf16 v[196:199], a[204:207], v[108:111], v[196:199]
 v_add_f32 v54, v54, v184
 v_cvt_pk_bf16_f32 v203, v190, v191
 v_mfma_f32_16x16x32_bf16 v[192:195], a[208:211], v[116:119], v[192:195]
 v_add_f32 v54, v54, v188
 v_add_f32 v54, v54, v189
 v_mfma_f32_16x16x32_bf16 v[196:199], a[212:215], v[116:119], v[196:199]
 v_add_f32 v54, v54, v190
 v_add_f32 v54, v54, v191
 v_mfma_f32_16x16x32_bf16 v[192:195], a[216:219], v[124:127], v[192:195]
 v_mfma_f32_16x16x32_bf16 v[196:199], a[220:223], v[124:127], v[196:199]
 v_mfma_f32_16x16x32_bf16 a[64:67], a[224:227], v[200:203], a[64:67]
 v_exp_f32 v192, v192
 v_mfma_f32_16x16x32_bf16 a[68:71], a[228:231], v[200:203], a[68:71]
 v_exp_f32 v193, v193
 v_mfma_f32_16x16x32_bf16 a[72:75], a[232:235], v[200:203], a[72:75]
 v_exp_f32 v194, v194
 v_mfma_f32_16x16x32_bf16 a[76:79], a[236:239], v[200:203], a[76:79]
 v_cvt_pk_bf16_f32 v204, v192, v193
 v_add_f32 v55, v55, v193
 v_mfma_f32_16x16x32_bf16 a[80:83], a[240:243], v[200:203], a[80:83]
 v_exp_f32 v195, v195
 v_mfma_f32_16x16x32_bf16 a[84:87], a[244:247], v[200:203], a[84:87]
 v_exp_f32 v196, v196
 v_mfma_f32_16x16x32_bf16 a[88:91], a[248:251], v[200:203], a[88:91]
 v_cvt_pk_bf16_f32 v205, v194, v195
 v_add_f32 v55, v55, v194
 v_mfma_f32_16x16x32_bf16 a[92:95], a[252:255], v[200:203], a[92:95]
 v_exp_f32 v197, v197
 v_mfma_f32_16x16x32_bf16 v[184:187], a[192:195], v[128:131], v[176:179]
 v_exp_f32 v198, v198
 v_mfma_f32_16x16x32_bf16 v[188:191], a[196:199], v[128:131], v[176:179]
 v_cvt_pk_bf16_f32 v206, v196, v197
 v_add_f32 v55, v55, v195
 v_mfma_f32_16x16x32_bf16 v[184:187], a[200:203], v[136:139], v[184:187]
 v_exp_f32 v199, v199
 v_mfma_f32_16x16x32_bf16 v[188:191], a[204:207], v[136:139], v[188:191]
 v_add_f32 v55, v55, v192
 v_cvt_pk_bf16_f32 v207, v198, v199
 v_mfma_f32_16x16x32_bf16 v[184:187], a[208:211], v[144:147], v[184:187]
 v_add_f32 v55, v55, v196
 v_add_f32 v55, v55, v197
 v_mfma_f32_16x16x32_bf16 v[188:191], a[212:215], v[144:147], v[188:191]
 v_add_f32 v55, v55, v198
 v_add_f32 v55, v55, v199
 v_mfma_f32_16x16x32_bf16 v[184:187], a[216:219], v[152:155], v[184:187]
 v_mfma_f32_16x16x32_bf16 v[188:191], a[220:223], v[152:155], v[188:191]
 v_mfma_f32_16x16x32_bf16 a[96:99], a[224:227], v[204:207], a[96:99]
 v_exp_f32 v184, v184
 v_mfma_f32_16x16x32_bf16 a[100:103], a[228:231], v[204:207], a[100:103]
 v_exp_f32 v185, v185
 v_mfma_f32_16x16x32_bf16 a[104:107], a[232:235], v[204:207], a[104:107]
 v_exp_f32 v186, v186
 v_cvt_pk_bf16_f32 v200, v184, v185
 v_mfma_f32_16x16x32_bf16 a[108:111], a[236:239], v[204:207], a[108:111]
 v_exp_f32 v187, v187
 v_add_f32 v56, v56, v185
 v_mfma_f32_16x16x32_bf16 a[112:115], a[240:243], v[204:207], a[112:115]
 v_exp_f32 v188, v188
 v_cvt_pk_bf16_f32 v201, v186, v187
 v_mfma_f32_16x16x32_bf16 a[116:119], a[244:247], v[204:207], a[116:119]
 v_exp_f32 v189, v189
 v_add_f32 v56, v56, v186
 v_mfma_f32_16x16x32_bf16 a[120:123], a[248:251], v[204:207], a[120:123]
 v_exp_f32 v190, v190
 v_cvt_pk_bf16_f32 v202, v188, v189
 v_mfma_f32_16x16x32_bf16 a[124:127], a[252:255], v[204:207], a[124:127]
 v_exp_f32 v191, v191
 v_add_f32 v56, v56, v184
 v_mfma_f32_16x16x32_bf16 v[192:195], a[192:195], v[132:135], v[180:183]
 ds_read_b64 a[192:193], v32 offset:49152
 v_cvt_pk_bf16_f32 v203, v190, v191
 v_add_f32 v56, v56, v187
 v_mfma_f32_16x16x32_bf16 v[196:199], a[196:199], v[132:135], v[180:183]
 ds_read_b64 a[196:197], v32 offset:53248
 v_add_f32 v56, v56, v188
 v_add_f32 v56, v56, v189
 v_mfma_f32_16x16x32_bf16 v[192:195], a[200:203], v[140:143], v[192:195]
 ds_read_b64 a[200:201], v34 offset:49152
 v_add_f32 v56, v56, v190
 v_add_f32 v56, v56, v191
 v_mfma_f32_16x16x32_bf16 v[196:199], a[204:207], v[140:143], v[196:199]
 ds_read_b64 a[204:205], v34 offset:53248
 v_mfma_f32_16x16x32_bf16 v[192:195], a[208:211], v[148:151], v[192:195]
 ds_read_b64 a[194:195], v33 offset:49152
 ds_read_b64 a[208:209], v36 offset:49152
 v_mfma_f32_16x16x32_bf16 v[196:199], a[212:215], v[148:151], v[196:199]
 ds_read_b64 a[198:199], v33 offset:53248
 ds_read_b64 a[212:213], v36 offset:53248
 v_mfma_f32_16x16x32_bf16 v[192:195], a[216:219], v[156:159], v[192:195]
 ds_read_b64 a[202:203], v35 offset:49152
 ds_read_b64 a[216:217], v38 offset:49152
 v_mfma_f32_16x16x32_bf16 v[196:199], a[220:223], v[156:159], v[196:199]
 ds_read_b64 a[206:207], v35 offset:53248
 ds_read_b64 a[220:221], v38 offset:53248
 v_mfma_f32_16x16x32_bf16 a[128:131], a[224:227], v[200:203], a[128:131]
 ds_read_b64 a[210:211], v37 offset:49152
 v_exp_f32 v192, v192
 v_mfma_f32_16x16x32_bf16 a[132:135], a[228:231], v[200:203], a[132:135]
 ds_read_b64 a[214:215], v37 offset:53248
 v_exp_f32 v193, v193
 v_mfma_f32_16x16x32_bf16 a[136:139], a[232:235], v[200:203], a[136:139]
 ds_read_b64 a[218:219], v39 offset:49152
 v_exp_f32 v194, v194
 v_mfma_f32_16x16x32_bf16 a[140:143], a[236:239], v[200:203], a[140:143]
 ds_read_b64 a[222:223], v39 offset:53248
 v_cvt_pk_bf16_f32 v204, v192, v193
 v_add_f32 v57, v57, v193
 v_mfma_f32_16x16x32_bf16 a[144:147], a[240:243], v[200:203], a[144:147]
 v_exp_f32 v195, v195
 v_add_f32 v57, v57, v194
 v_mfma_f32_16x16x32_bf16 a[148:151], a[244:247], v[200:203], a[148:151]
 v_exp_f32 v196, v196
 v_cvt_pk_bf16_f32 v205, v194, v195
 v_mfma_f32_16x16x32_bf16 a[152:155], a[248:251], v[200:203], a[152:155]
 v_exp_f32 v197, v197
 v_add_f32 v57, v57, v195
 v_mfma_f32_16x16x32_bf16 a[156:159], a[252:255], v[200:203], a[156:159]
 v_exp_f32 v198, v198
 s_waitcnt lgkmcnt(5)
 v_mfma_f32_16x16x32_bf16 v[184:187], a[192:195], v[64:67], v[160:163]
 v_cvt_pk_bf16_f32 v206, v196, v197
 v_exp_f32 v199, v199
 v_mfma_f32_16x16x32_bf16 v[188:191], a[196:199], v[64:67], v[160:163]
 v_add_f32 v57, v57, v192
 v_cvt_pk_bf16_f32 v207, v198, v199
 v_add_f32 v57, v57, v196
 v_mfma_f32_16x16x32_bf16 v[184:187], a[200:203], v[72:75], v[184:187]
 v_add_f32 v57, v57, v197
 v_add_f32 v57, v57, v198
 v_add_f32 v57, v57, v199
 v_mfma_f32_16x16x32_bf16 v[188:191], a[204:207], v[72:75], v[188:191]
 s_waitcnt lgkmcnt(0)
 v_mfma_f32_16x16x32_bf16 v[184:187], a[208:211], v[80:83], v[184:187]
 v_mfma_f32_16x16x32_bf16 v[188:191], a[212:215], v[80:83], v[188:191]
 s_cmp_lt_u32 s57, 22
 s_cselect_b32 s30, 262144, 0
 s_add_u32 s57, s57, 1
 v_mfma_f32_16x16x32_bf16 v[184:187], a[216:219], v[88:91], v[184:187]
 s_add_u32 m0, s97, 0
 v_mfma_f32_16x16x32_bf16 v[188:191], a[220:223], v[88:91], v[188:191]
 s_waitcnt vmcnt(16)
 s_barrier
 v_mfma_f32_16x16x32_bf16 a[160:163], a[224:227], v[204:207], a[160:163]
 ds_read_b64_tr_b16 a[224:225], v40 offset:49152
 v_exp_f32 v184, v184
 v_mfma_f32_16x16x32_bf16 a[164:167], a[228:231], v[204:207], a[164:167]
 ds_read_b64_tr_b16 a[228:229], v41 offset:49152
 v_exp_f32 v185, v185
 v_mfma_f32_16x16x32_bf16 a[168:171], a[232:235], v[204:207], a[168:171]
 ds_read_b64_tr_b16 a[232:233], v42 offset:49152
 v_exp_f32 v186, v186
 v_mfma_f32_16x16x32_bf16 a[172:175], a[236:239], v[204:207], a[172:175]
 ds_read_b64_tr_b16 a[236:237], v43 offset:49152
 v_cvt_pk_bf16_f32 v200, v184, v185
 v_add_f32 v52, v52, v185
 v_mfma_f32_16x16x32_bf16 a[176:179], a[240:243], v[204:207], a[176:179]
 ds_read_b64_tr_b16 a[226:227], v40 offset:53248
 ds_read_b64_tr_b16 a[240:241], v44 offset:49152
 v_add_f32 v52, v52, v186
 v_mfma_f32_16x16x32_bf16 a[180:183], a[244:247], v[204:207], a[180:183]
 ds_read_b64_tr_b16 a[230:231], v41 offset:53248
 ds_read_b64_tr_b16 a[244:245], v45 offset:49152
 v_mfma_f32_16x16x32_bf16 a[184:187], a[248:251], v[204:207], a[184:187]
 ds_read_b64_tr_b16 a[234:235], v42 offset:53248
 ds_read_b64_tr_b16 a[248:249], v46 offset:49152
 v_mfma_f32_16x16x32_bf16 a[188:191], a[252:255], v[204:207], a[188:191]
 ds_read_b64_tr_b16 a[238:239], v43 offset:53248
 ds_read_b64_tr_b16 a[252:253], v47 offset:49152
 v_mfma_f32_16x16x32_bf16 v[192:195], a[192:195], v[68:71], v[164:167]
 ds_read_b64_tr_b16 a[242:243], v44 offset:53248
 v_exp_f32 v187, v187
 v_mfma_f32_16x16x32_bf16 v[196:199], a[196:199], v[68:71], v[164:167]
 ds_read_b64_tr_b16 a[246:247], v45 offset:53248
 v_exp_f32 v188, v188
 v_mfma_f32_16x16x32_bf16 v[192:195], a[200:203], v[76:79], v[192:195]
 ds_read_b64_tr_b16 a[250:251], v46 offset:53248
 v_cvt_pk_bf16_f32 v201, v186, v187
 v_add_f32 v52, v52, v187
 v_mfma_f32_16x16x32_bf16 v[196:199], a[204:207], v[76:79], v[196:199]
 ds_read_b64_tr_b16 a[254:255], v47 offset:53248
 v_exp_f32 v189, v189
 v_mfma_f32_16x16x32_bf16 v[192:195], a[208:211], v[84:87], v[192:195]
 buffer_load_dwordx4 v48, s[28:31], s50 offen nt lds
 v_exp_f32 v190, v190
 v_mfma_f32_16x16x32_bf16 v[196:199], a[212:215], v[84:87], v[196:199]
 v_cvt_pk_bf16_f32 v202, v188, v189
 v_exp_f32 v191, v191
 v_mfma_f32_16x16x32_bf16 v[192:195], a[216:219], v[92:95], v[192:195]
 buffer_load_dwordx4 v49, s[28:31], s50 offen offset:1024 nt lds
 v_add_f32 v52, v52, v184
 v_cvt_pk_bf16_f32 v203, v190, v191
 v_mfma_f32_16x16x32_bf16 v[196:199], a[220:223], v[92:95], v[196:199]
 v_add_f32 v52, v52, v188
 v_add_f32 v52, v52, v189
 s_waitcnt lgkmcnt(5)
 v_mfma_f32_16x16x32_bf16 a[0:3], a[224:227], v[200:203], a[0:3]
 buffer_load_dwordx4 v50, s[28:31], s50 offen offset:2048 nt lds
 v_exp_f32 v192, v192
 v_mfma_f32_16x16x32_bf16 a[4:7], a[228:231], v[200:203], a[4:7]
 v_exp_f32 v193, v193
 v_add_f32 v52, v52, v190
 v_mfma_f32_16x16x32_bf16 a[8:11], a[232:235], v[200:203], a[8:11]
 buffer_load_dwordx4 v51, s[28:31], s50 offen offset:3072 nt lds
 v_exp_f32 v194, v194
 v_mfma_f32_16x16x32_bf16 a[12:15], a[236:239], v[200:203], a[12:15]
 v_cvt_pk_bf16_f32 v204, v192, v193
 v_add_f32 v52, v52, v191
 s_waitcnt lgkmcnt(0)
 v_mfma_f32_16x16x32_bf16 a[16:19], a[240:243], v[200:203], a[16:19]
 s_add_u32 m0, s97, 4096
 v_exp_f32 v195, v195
 v_mfma_f32_16x16x32_bf16 a[20:23], a[244:247], v[200:203], a[20:23]
 v_exp_f32 v196, v196
 v_cvt_pk_bf16_f32 v205, v194, v195
 v_mfma_f32_16x16x32_bf16 a[24:27], a[248:251], v[200:203], a[24:27]
 buffer_load_dwordx4 v48, s[28:31], s51 offen nt lds
 v_exp_f32 v197, v197
 v_mfma_f32_16x16x32_bf16 a[28:31], a[252:255], v[200:203], a[28:31]
 v_exp_f32 v198, v198
 v_cvt_pk_bf16_f32 v206, v196, v197
 v_mfma_f32_16x16x32_bf16 v[184:187], a[192:195], v[96:99], v[168:171]
 buffer_load_dwordx4 v49, s[28:31], s51 offen offset:1024 nt lds
 v_exp_f32 v199, v199
 v_mfma_f32_16x16x32_bf16 v[188:191], a[196:199], v[96:99], v[168:171]
 v_add_f32 v53, v53, v192
 v_cvt_pk_bf16_f32 v207, v198, v199
 v_mfma_f32_16x16x32_bf16 v[184:187], a[200:203], v[104:107], v[184:187]
 buffer_load_dwordx4 v50, s[28:31], s51 offen offset:2048 nt lds
 v_add_f32 v53, v53, v193
 v_mfma_f32_16x16x32_bf16 v[188:191], a[204:207], v[104:107], v[188:191]
 v_add_f32 v53, v53, v194
 v_add_f32 v53, v53, v195
 v_mfma_f32_16x16x32_bf16 v[184:187], a[208:211], v[112:115], v[184:187]
 buffer_load_dwordx4 v51, s[28:31], s51 offen offset:3072 nt lds
 v_add_f32 v53, v53, v196
 v_mfma_f32_16x16x32_bf16 v[188:191], a[212:215], v[112:115], v[188:191]
 v_add_f32 v53, v53, v197
 v_add_f32 v53, v53, v198
 v_mfma_f32_16x16x32_bf16 v[184:187], a[216:219], v[120:123], v[184:187]
 v_add_f32 v53, v53, v199
 v_mfma_f32_16x16x32_bf16 v[188:191], a[220:223], v[120:123], v[188:191]
 s_add_u32 s50, s50, 8192
 s_and_b32 s50, s50, 262143
 s_add_u32 s51, s50, 4096
 v_mfma_f32_16x16x32_bf16 a[32:35], a[224:227], v[204:207], a[32:35]
 v_exp_f32 v184, v184
 v_mfma_f32_16x16x32_bf16 a[36:39], a[228:231], v[204:207], a[36:39]
 v_exp_f32 v185, v185
 v_mfma_f32_16x16x32_bf16 a[40:43], a[232:235], v[204:207], a[40:43]
 v_exp_f32 v186, v186
 v_mfma_f32_16x16x32_bf16 a[44:47], a[236:239], v[204:207], a[44:47]
 v_cvt_pk_bf16_f32 v200, v184, v185
 v_add_f32 v54, v54, v185
 v_mfma_f32_16x16x32_bf16 a[48:51], a[240:243], v[204:207], a[48:51]
 v_exp_f32 v187, v187
 v_mfma_f32_16x16x32_bf16 a[52:55], a[244:247], v[204:207], a[52:55]
 v_exp_f32 v188, v188
 v_mfma_f32_16x16x32_bf16 a[56:59], a[248:251], v[204:207], a[56:59]
 v_cvt_pk_bf16_f32 v201, v186, v187
 v_add_f32 v54, v54, v186
 v_mfma_f32_16x16x32_bf16 a[60:63], a[252:255], v[204:207], a[60:63]
 v_exp_f32 v189, v189
 v_mfma_f32_16x16x32_bf16 v[192:195], a[192:195], v[100:103], v[172:175]
 v_exp_f32 v190, v190
 v_mfma_f32_16x16x32_bf16 v[196:199], a[196:199], v[100:103], v[172:175]
 v_cvt_pk_bf16_f32 v202, v188, v189
 v_add_f32 v54, v54, v187
 v_mfma_f32_16x16x32_bf16 v[192:195], a[200:203], v[108:111], v[192:195]
 v_exp_f32 v191, v191
 v_mfma_f32_16x16x32_bf16 v[196:199], a[204:207], v[108:111], v[196:199]
 v_add_f32 v54, v54, v184
 v_cvt_pk_bf16_f32 v203, v190, v191
 v_mfma_f32_16x16x32_bf16 v[192:195], a[208:211], v[116:119], v[192:195]
 v_add_f32 v54, v54, v188
 v_add_f32 v54, v54, v189
 v_mfma_f32_16x16x32_bf16 v[196:199], a[212:215], v[116:119], v[196:199]
 v_add_f32 v54, v54, v190
 v_add_f32 v54, v54, v191
 v_mfma_f32_16x16x32_bf16 v[192:195], a[216:219], v[124:127], v[192:195]
 v_mfma_f32_16x16x32_bf16 v[196:199], a[220:223], v[124:127], v[196:199]
 v_mfma_f32_16x16x32_bf16 a[64:67], a[224:227], v[200:203], a[64:67]
 v_exp_f32 v192, v192
 v_mfma_f32_16x16x32_bf16 a[68:71], a[228:231], v[200:203], a[68:71]
 v_exp_f32 v193, v193
 v_mfma_f32_16x16x32_bf16 a[72:75], a[232:235], v[200:203], a[72:75]
 v_exp_f32 v194, v194
 v_mfma_f32_16x16x32_bf16 a[76:79], a[236:239], v[200:203], a[76:79]
 v_cvt_pk_bf16_f32 v204, v192, v193
 v_add_f32 v55, v55, v193
 v_mfma_f32_16x16x32_bf16 a[80:83], a[240:243], v[200:203], a[80:83]
 v_exp_f32 v195, v195
 v_mfma_f32_16x16x32_bf16 a[84:87], a[244:247], v[200:203], a[84:87]
 v_exp_f32 v196, v196
 v_mfma_f32_16x16x32_bf16 a[88:91], a[248:251], v[200:203], a[88:91]
 v_cvt_pk_bf16_f32 v205, v194, v195
 v_add_f32 v55, v55, v194
 v_mfma_f32_16x16x32_bf16 a[92:95], a[252:255], v[200:203], a[92:95]
 v_exp_f32 v197, v197
 v_mfma_f32_16x16x32_bf16 v[184:187], a[192:195], v[128:131], v[176:179]
 v_exp_f32 v198, v198
 v_mfma_f32_16x16x32_bf16 v[188:191], a[196:199], v[128:131], v[176:179]
 v_cvt_pk_bf16_f32 v206, v196, v197
 v_add_f32 v55, v55, v195
 v_mfma_f32_16x16x32_bf16 v[184:187], a[200:203], v[136:139], v[184:187]
 v_exp_f32 v199, v199
 v_mfma_f32_16x16x32_bf16 v[188:191], a[204:207], v[136:139], v[188:191]
 v_add_f32 v55, v55, v192
 v_cvt_pk_bf16_f32 v207, v198, v199
 v_mfma_f32_16x16x32_bf16 v[184:187], a[208:211], v[144:147], v[184:187]
 v_add_f32 v55, v55, v196
 v_add_f32 v55, v55, v197
 v_mfma_f32_16x16x32_bf16 v[188:191], a[212:215], v[144:147], v[188:191]
 v_add_f32 v55, v55, v198
 v_add_f32 v55, v55, v199
 v_mfma_f32_16x16x32_bf16 v[184:187], a[216:219], v[152:155], v[184:187]
 v_mfma_f32_16x16x32_bf16 v[188:191], a[220:223], v[152:155], v[188:191]
 v_mfma_f32_16x16x32_bf16 a[96:99], a[224:227], v[204:207], a[96:99]
 v_exp_f32 v184, v184
 v_mfma_f32_16x16x32_bf16 a[100:103], a[228:231], v[204:207], a[100:103]
 v_exp_f32 v185, v185
 v_mfma_f32_16x16x32_bf16 a[104:107], a[232:235], v[204:207], a[104:107]
 v_exp_f32 v186, v186
 v_cvt_pk_bf16_f32 v200, v184, v185
 v_mfma_f32_16x16x32_bf16 a[108:111], a[236:239], v[204:207], a[108:111]
 v_exp_f32 v187, v187
 v_add_f32 v56, v56, v185
 v_mfma_f32_16x16x32_bf16 a[112:115], a[240:243], v[204:207], a[112:115]
 v_exp_f32 v188, v188
 v_cvt_pk_bf16_f32 v201, v186, v187
 v_mfma_f32_16x16x32_bf16 a[116:119], a[244:247], v[204:207], a[116:119]
 v_exp_f32 v189, v189
 v_add_f32 v56, v56, v186
 v_mfma_f32_16x16x32_bf16 a[120:123], a[248:251], v[204:207], a[120:123]
 v_exp_f32 v190, v190
 v_cvt_pk_bf16_f32 v202, v188, v189
 v_mfma_f32_16x16x32_bf16 a[124:127], a[252:255], v[204:207], a[124:127]
 v_exp_f32 v191, v191
 v_add_f32 v56, v56, v184
 v_mfma_f32_16x16x32_bf16 v[192:195], a[192:195], v[132:135], v[180:183]
 ds_read_b64 a[192:193], v32
 v_cvt_pk_bf16_f32 v203, v190, v191
 v_add_f32 v56, v56, v187
 v_mfma_f32_16x16x32_bf16 v[196:199], a[196:199], v[132:135], v[180:183]
 ds_read_b64 a[196:197], v32 offset:4096
 v_add_f32 v56, v56, v188
 v_add_f32 v56, v56, v189
 v_mfma_f32_16x16x32_bf16 v[192:195], a[200:203], v[140:143], v[192:195]
 ds_read_b64 a[200:201], v34
 v_add_f32 v56, v56, v190
 v_add_f32 v56, v56, v191
 v_mfma_f32_16x16x32_bf16 v[196:199], a[204:207], v[140:143], v[196:199]
 ds_read_b64 a[204:205], v34 offset:4096
 v_mfma_f32_16x16x32_bf16 v[192:195], a[208:211], v[148:151], v[192:195]
 ds_read_b64 a[194:195], v33
 ds_read_b64 a[208:209], v36
 v_mfma_f32_16x16x32_bf16 v[196:199], a[212:215], v[148:151], v[196:199]
 ds_read_b64 a[198:199], v33 offset:4096
 ds_read_b64 a[212:213], v36 offset:4096
 v_mfma_f32_16x16x32_bf16 v[192:195], a[216:219], v[156:159], v[192:195]
 ds_read_b64 a[202:203], v35
 ds_read_b64 a[216:217], v38
 v_mfma_f32_16x16x32_bf16 v[196:199], a[220:223], v[156:159], v[196:199]
 ds_read_b64 a[206:207], v35 offset:4096
 ds_read_b64 a[220:221], v38 offset:4096
 v_mfma_f32_16x16x32_bf16 a[128:131], a[224:227], v[200:203], a[128:131]
 ds_read_b64 a[210:211], v37
 v_exp_f32 v192, v192
 v_mfma_f32_16x16x32_bf16 a[132:135], a[228:231], v[200:203], a[132:135]
 ds_read_b64 a[214:215], v37 offset:4096
 v_exp_f32 v193, v193
 v_mfma_f32_16x16x32_bf16 a[136:139], a[232:235], v[200:203], a[136:139]
 ds_read_b64 a[218:219], v39
 v_exp_f32 v194, v194
 v_mfma_f32_16x16x32_bf16 a[140:143], a[236:239], v[200:203], a[140:143]
 ds_read_b64 a[222:223], v39 offset:4096
 v_cvt_pk_bf16_f32 v204, v192, v193
 v_add_f32 v57, v57, v193
 v_mfma_f32_16x16x32_bf16 a[144:147], a[240:243], v[200:203], a[144:147]
 v_exp_f32 v195, v195
 v_add_f32 v57, v57, v194
 v_mfma_f32_16x16x32_bf16 a[148:151], a[244:247], v[200:203], a[148:151]
 v_exp_f32 v196, v196
 v_cvt_pk_bf16_f32 v205, v194, v195
 v_mfma_f32_16x16x32_bf16 a[152:155], a[248:251], v[200:203], a[152:155]
 v_exp_f32 v197, v197
 v_add_f32 v57, v57, v195
 v_mfma_f32_16x16x32_bf16 a[156:159], a[252:255], v[200:203], a[156:159]
 v_exp_f32 v198, v198
 s_add_u32 s45, s45, 1
 s_cmp_lt_u32 s45, 6
 s_cbranch_scc1 L1_loopB
 s_waitcnt lgkmcnt(5)
 v_mfma_f32_16x16x32_bf16 v[184:187], a[192:195], v[64:67], v[160:163]
 v_cvt_pk_bf16_f32 v206, v196, v197
 v_exp_f32 v199, v199
 v_mfma_f32_16x16x32_bf16 v[188:191], a[196:199], v[64:67], v[160:163]
 v_add_f32 v57, v57, v192
 v_cvt_pk_bf16_f32 v207, v198, v199
 v_add_f32 v57, v57, v196
 v_mfma_f32_16x16x32_bf16 v[184:187], a[200:203], v[72:75], v[184:187]
 v_add_f32 v57, v57, v197
 v_add_f32 v57, v57, v198
 v_add_f32 v57, v57, v199
 v_mfma_f32_16x16x32_bf16 v[188:191], a[204:207], v[72:75], v[188:191]
 s_waitcnt lgkmcnt(0)
 v_mfma_f32_16x16x32_bf16 v[184:187], a[208:211], v[80:83], v[184:187]
 v_mfma_f32_16x16x32_bf16 v[188:191], a[212:215], v[80:83], v[188:191]
 v_mfma_f32_16x16x32_bf16 v[184:187], a[216:219], v[88:91], v[184:187]
 v_mfma_f32_16x16x32_bf16 v[188:191], a[220:223], v[88:91], v[188:191]
 s_waitcnt vmcnt(16)
 s_barrier
 v_mfma_f32_16x16x32_bf16 a[160:163], a[224:227], v[204:207], a[160:163]
 ds_read_b64_tr_b16 a[224:225], v40
 s_add_u32 m0, s74, 131072
 s_nop 0
 v_exp_f32 v184, v184
 v_mfma_f32_16x16x32_bf16 a[164:167], a[228:231], v[204:207], a[164:167]
 ds_read_b64_tr_b16 a[228:229], v41
 v_exp_f32 v185, v185
 v_mfma_f32_16x16x32_bf16 a[168:171], a[232:235], v[204:207], a[168:171]
 ds_read_b64_tr_b16 a[232:233], v42
 buffer_load_dwordx4 v18, s[20:23], s76 offen lds
 v_exp_f32 v186, v186
 v_mfma_f32_16x16x32_bf16 a[172:175], a[236:239], v[204:207], a[172:175]
 ds_read_b64_tr_b16 a[236:237], v43
 v_cvt_pk_bf16_f32 v200, v184, v185
 v_add_f32 v52, v52, v185
 v_mfma_f32_16x16x32_bf16 a[176:179], a[240:243], v[204:207], a[176:179]
 ds_read_b64_tr_b16 a[226:227], v40 offset:4096
 ds_read_b64_tr_b16 a[240:241], v44
 buffer_load_dwordx4 v19, s[20:23], s76 offen offset:1024 lds
 v_add_f32 v52, v52, v186
 v_mfma_f32_16x16x32_bf16 a[180:183], a[244:247], v[204:207], a[180:183]
 ds_read_b64_tr_b16 a[230:231], v41 offset:4096
 ds_read_b64_tr_b16 a[244:245], v45
 v_mfma_f32_16x16x32_bf16 a[184:187], a[248:251], v[204:207], a[184:187]
 ds_read_b64_tr_b16 a[234:235], v42 offset:4096
 ds_read_b64_tr_b16 a[248:249], v46
 buffer_load_dwordx4 v20, s[20:23], s76 offen offset:2048 lds
 v_mfma_f32_16x16x32_bf16 a[188:191], a[252:255], v[204:207], a[188:191]
 ds_read_b64_tr_b16 a[238:239], v43 offset:4096
 ds_read_b64_tr_b16 a[252:253], v47
 v_mfma_f32_16x16x32_bf16 v[192:195], a[192:195], v[68:71], v[164:167]
 ds_read_b64_tr_b16 a[242:243], v44 offset:4096
 buffer_load_dwordx4 v21, s[20:23], s76 offen offset:3072 lds
 v_exp_f32 v187, v187
 v_mfma_f32_16x16x32_bf16 v[196:199], a[196:199], v[68:71], v[164:167]
 ds_read_b64_tr_b16 a[246:247], v45 offset:4096
 v_exp_f32 v188, v188
 v_mfma_f32_16x16x32_bf16 v[192:195], a[200:203], v[76:79], v[192:195]
 ds_read_b64_tr_b16 a[250:251], v46 offset:4096
 s_add_u32 m0, s74, 135168
 s_nop 0
 v_cvt_pk_bf16_f32 v201, v186, v187
 v_add_f32 v52, v52, v187
 v_mfma_f32_16x16x32_bf16 v[196:199], a[204:207], v[76:79], v[196:199]
 ds_read_b64_tr_b16 a[254:255], v47 offset:4096
 v_exp_f32 v189, v189
 v_mfma_f32_16x16x32_bf16 v[192:195], a[208:211], v[84:87], v[192:195]
 buffer_load_dwordx4 v22, s[20:23], s76 offen lds
 v_exp_f32 v190, v190
 v_mfma_f32_16x16x32_bf16 v[196:199], a[212:215], v[84:87], v[196:199]
 v_cvt_pk_bf16_f32 v202, v188, v189
 v_exp_f32 v191, v191
 v_mfma_f32_16x16x32_bf16 v[192:195], a[216:219], v[92:95], v[192:195]
 buffer_load_dwordx4 v23, s[20:23], s76 offen offset:1024 lds
 v_add_f32 v52, v52, v184
 v_cvt_pk_bf16_f32 v203, v190, v191
 v_mfma_f32_16x16x32_bf16 v[196:199], a[220:223], v[92:95], v[196:199]
 v_add_f32 v52, v52, v188
 v_add_f32 v52, v52, v189
 s_waitcnt lgkmcnt(5)
 v_mfma_f32_16x16x32_bf16 a[0:3], a[224:227], v[200:203], a[0:3]
 buffer_load_dwordx4 v24, s[20:23], s76 offen offset:2048 lds
 v_exp_f32 v192, v192
 v_mfma_f32_16x16x32_bf16 a[4:7], a[228:231], v[200:203], a[4:7]
 v_exp_f32 v193, v193
 v_add_f32 v52, v52, v190
 v_mfma_f32_16x16x32_bf16 a[8:11], a[232:235], v[200:203], a[8:11]
 buffer_load_dwordx4 v25, s[20:23], s76 offen offset:3072 lds
 v_exp_f32 v194, v194
 v_mfma_f32_16x16x32_bf16 a[12:15], a[236:239], v[200:203], a[12:15]
 v_cvt_pk_bf16_f32 v204, v192, v193
 v_add_f32 v52, v52, v191
 s_waitcnt lgkmcnt(0)
 v_mfma_f32_16x16x32_bf16 a[16:19], a[240:243], v[200:203], a[16:19]
 s_add_u32 s76, s76, 65536
 v_exp_f32 v195, v195
 v_mfma_f32_16x16x32_bf16 a[20:23], a[244:247], v[200:203], a[20:23]
 v_exp_f32 v196, v196
 v_cvt_pk_bf16_f32 v205, v194, v195
 v_mfma_f32_16x16x32_bf16 a[24:27], a[248:251], v[200:203], a[24:27]
 v_exp_f32 v197, v197
 v_mfma_f32_16x16x32_bf16 a[28:31], a[252:255], v[200:203], a[28:31]
 v_exp_f32 v198, v198
 v_cvt_pk_bf16_f32 v206, v196, v197
 v_mfma_f32_16x16x32_bf16 v[184:187], a[192:195], v[96:99], v[168:171]
 v_exp_f32 v199, v199
 v_mfma_f32_16x16x32_bf16 v[188:191], a[196:199], v[96:99], v[168:171]
 v_add_f32 v53, v53, v192
 v_cvt_pk_bf16_f32 v207, v198, v199
 v_mfma_f32_16x16x32_bf16 v[184:187], a[200:203], v[104:107], v[184:187]
 v_add_f32 v53, v53, v193
 v_mfma_f32_16x16x32_bf16 v[188:191], a[204:207], v[104:107], v[188:191]
 v_add_f32 v53, v53, v194
 v_add_f32 v53, v53, v195
 v_mfma_f32_16x16x32_bf16 v[184:187], a[208:211], v[112:115], v[184:187]
 v_add_f32 v53, v53, v196
 v_mfma_f32_16x16x32_bf16 v[188:191], a[212:215], v[112:115], v[188:191]
 v_add_f32 v53, v53, v197
 v_add_f32 v53, v53, v198
 v_mfma_f32_16x16x32_bf16 v[184:187], a[216:219], v[120:123], v[184:187]
 v_add_f32 v53, v53, v199
 v_mfma_f32_16x16x32_bf16 v[188:191], a[220:223], v[120:123], v[188:191]
 v_mfma_f32_16x16x32_bf16 a[32:35], a[224:227], v[204:207], a[32:35]
 v_exp_f32 v184, v184
 v_mfma_f32_16x16x32_bf16 a[36:39], a[228:231], v[204:207], a[36:39]
 v_exp_f32 v185, v185
 v_mfma_f32_16x16x32_bf16 a[40:43], a[232:235], v[204:207], a[40:43]
 v_exp_f32 v186, v186
 v_mfma_f32_16x16x32_bf16 a[44:47], a[236:239], v[204:207], a[44:47]
 v_cvt_pk_bf16_f32 v200, v184, v185
 v_add_f32 v54, v54, v185
 v_mfma_f32_16x16x32_bf16 a[48:51], a[240:243], v[204:207], a[48:51]
 v_exp_f32 v187, v187
 v_mfma_f32_16x16x32_bf16 a[52:55], a[244:247], v[204:207], a[52:55]
 v_exp_f32 v188, v188
 v_mfma_f32_16x16x32_bf16 a[56:59], a[248:251], v[204:207], a[56:59]
 v_cvt_pk_bf16_f32 v201, v186, v187
 v_add_f32 v54, v54, v186
 v_mfma_f32_16x16x32_bf16 a[60:63], a[252:255], v[204:207], a[60:63]
 v_exp_f32 v189, v189
 v_mfma_f32_16x16x32_bf16 v[192:195], a[192:195], v[100:103], v[172:175]
 v_exp_f32 v190, v190
 v_mfma_f32_16x16x32_bf16 v[196:199], a[196:199], v[100:103], v[172:175]
 v_cvt_pk_bf16_f32 v202, v188, v189
 v_add_f32 v54, v54, v187
 v_mfma_f32_16x16x32_bf16 v[192:195], a[200:203], v[108:111], v[192:195]
 v_exp_f32 v191, v191
 v_mfma_f32_16x16x32_bf16 v[196:199], a[204:207], v[108:111], v[196:199]
 v_add_f32 v54, v54, v184
 v_cvt_pk_bf16_f32 v203, v190, v191
 v_mfma_f32_16x16x32_bf16 v[192:195], a[208:211], v[116:119], v[192:195]
 v_add_f32 v54, v54, v188
 v_add_f32 v54, v54, v189
 v_mfma_f32_16x16x32_bf16 v[196:199], a[212:215], v[116:119], v[196:199]
 v_add_f32 v54, v54, v190
 v_add_f32 v54, v54, v191
 v_mfma_f32_16x16x32_bf16 v[192:195], a[216:219], v[124:127], v[192:195]
 v_mfma_f32_16x16x32_bf16 v[196:199], a[220:223], v[124:127], v[196:199]
 v_mfma_f32_16x16x32_bf16 a[64:67], a[224:227], v[200:203], a[64:67]
 v_exp_f32 v192, v192
 v_mfma_f32_16x16x32_bf16 a[68:71], a[228:231], v[200:203], a[68:71]
 v_exp_f32 v193, v193
 v_mfma_f32_16x16x32_bf16 a[72:75], a[232:235], v[200:203], a[72:75]
 v_exp_f32 v194, v194
 v_mfma_f32_16x16x32_bf16 a[76:79], a[236:239], v[200:203], a[76:79]
 v_cvt_pk_bf16_f32 v204, v192, v193
 v_add_f32 v55, v55, v193
 v_mfma_f32_16x16x32_bf16 a[80:83], a[240:243], v[200:203], a[80:83]
 v_exp_f32 v195, v195
 v_mfma_f32_16x16x32_bf16 a[84:87], a[244:247], v[200:203], a[84:87]
 v_exp_f32 v196, v196
 v_mfma_f32_16x16x32_bf16 a[88:91], a[248:251], v[200:203], a[88:91]
 v_cvt_pk_bf16_f32 v205, v194, v195
 v_add_f32 v55, v55, v194
 v_mfma_f32_16x16x32_bf16 a[92:95], a[252:255], v[200:203], a[92:95]
 v_exp_f32 v197, v197
 v_mfma_f32_16x16x32_bf16 v[184:187], a[192:195], v[128:131], v[176:179]
 v_exp_f32 v198, v198
 v_mfma_f32_16x16x32_bf16 v[188:191], a[196:199], v[128:131], v[176:179]
 v_cvt_pk_bf16_f32 v206, v196, v197
 v_add_f32 v55, v55, v195
 v_mfma_f32_16x16x32_bf16 v[184:187], a[200:203], v[136:139], v[184:187]
 v_exp_f32 v199, v199
 v_mfma_f32_16x16x32_bf16 v[188:191], a[204:207], v[136:139], v[188:191]
 v_add_f32 v55, v55, v192
 v_cvt_pk_bf16_f32 v207, v198, v199
 v_mfma_f32_16x16x32_bf16 v[184:187], a[208:211], v[144:147], v[184:187]
 v_add_f32 v55, v55, v196
 v_add_f32 v55, v55, v197
 v_mfma_f32_16x16x32_bf16 v[188:191], a[212:215], v[144:147], v[188:191]
 v_add_f32 v55, v55, v198
 v_add_f32 v55, v55, v199
 v_mfma_f32_16x16x32_bf16 v[184:187], a[216:219], v[152:155], v[184:187]
 v_mfma_f32_16x16x32_bf16 v[188:191], a[220:223], v[152:155], v[188:191]
 v_mfma_f32_16x16x32_bf16 a[96:99], a[224:227], v[204:207], a[96:99]
 v_exp_f32 v184, v184
 v_mfma_f32_16x16x32_bf16 a[100:103], a[228:231], v[204:207], a[100:103]
 v_exp_f32 v185, v185
 v_mfma_f32_16x16x32_bf16 a[104:107], a[232:235], v[204:207], a[104:107]
 v_exp_f32 v186, v186
 v_cvt_pk_bf16_f32 v200, v184, v185
 v_mfma_f32_16x16x32_bf16 a[108:111], a[236:239], v[204:207], a[108:111]
 v_exp_f32 v187, v187
 v_add_f32 v56, v56, v185
 v_mfma_f32_16x16x32_bf16 a[112:115], a[240:243], v[204:207], a[112:115]
 v_exp_f32 v188, v188
 v_cvt_pk_bf16_f32 v201, v186, v187
 v_mfma_f32_16x16x32_bf16 a[116:119], a[244:247], v[204:207], a[116:119]
 v_exp_f32 v189, v189
 v_add_f32 v56, v56, v186
 v_mfma_f32_16x16x32_bf16 a[120:123], a[248:251], v[204:207], a[120:123]
 v_exp_f32 v190, v190
 v_cvt_pk_bf16_f32 v202, v188, v189
 v_mfma_f32_16x16x32_bf16 a[124:127], a[252:255], v[204:207], a[124:127]
 v_exp_f32 v191, v191
 v_add_f32 v56, v56, v184
 v_mfma_f32_16x16x32_bf16 v[192:195], a[192:195], v[132:135], v[180:183]
 ds_read_b64 a[192:193], v32 offset:16384
 v_cvt_pk_bf16_f32 v203, v190, v191
 v_add_f32 v56, v56, v187
 v_mfma_f32_16x16x32_bf16 v[196:199], a[196:199], v[132:135], v[180:183]
 ds_read_b64 a[196:197], v32 offset:20480
 v_add_f32 v56, v56, v188
 v_add_f32 v56, v56, v189
 v_mfma_f32_16x16x32_bf16 v[192:195], a[200:203], v[140:143], v[192:195]
 ds_read_b64 a[200:201], v34 offset:16384
 v_add_f32 v56, v56, v190
 v_add_f32 v56, v56, v191
 v_mfma_f32_16x16x32_bf16 v[196:199], a[204:207], v[140:143], v[196:199]
 ds_read_b64 a[204:205], v34 offset:20480
 v_mfma_f32_16x16x32_bf16 v[192:195], a[208:211], v[148:151], v[192:195]
 ds_read_b64 a[194:195], v33 offset:16384
 ds_read_b64 a[208:209], v36 offset:16384
 v_mfma_f32_16x16x32_bf16 v[196:199], a[212:215], v[148:151], v[196:199]
 ds_read_b64 a[198:199], v33 offset:20480
 ds_read_b64 a[212:213], v36 offset:20480
 v_mfma_f32_16x16x32_bf16 v[192:195], a[216:219], v[156:159], v[192:195]
 ds_read_b64 a[202:203], v35 offset:16384
 ds_read_b64 a[216:217], v38 offset:16384
 v_mfma_f32_16x16x32_bf16 v[196:199], a[220:223], v[156:159], v[196:199]
 ds_read_b64 a[206:207], v35 offset:20480
 ds_read_b64 a[220:221], v38 offset:20480
 v_mfma_f32_16x16x32_bf16 a[128:131], a[224:227], v[200:203], a[128:131]
 ds_read_b64 a[210:211], v37 offset:16384
 v_exp_f32 v192, v192
 v_mfma_f32_16x16x32_bf16 a[132:135], a[228:231], v[200:203], a[132:135]
 ds_read_b64 a[214:215], v37 offset:20480
 v_exp_f32 v193, v193
 v_mfma_f32_16x16x32_bf16 a[136:139], a[232:235], v[200:203], a[136:139]
 ds_read_b64 a[218:219], v39 offset:16384
 v_exp_f32 v194, v194
 v_mfma_f32_16x16x32_bf16 a[140:143], a[236:239], v[200:203], a[140:143]
 ds_read_b64 a[222:223], v39 offset:20480
 v_cvt_pk_bf16_f32 v204, v192, v193
 v_add_f32 v57, v57, v193
 v_mfma_f32_16x16x32_bf16 a[144:147], a[240:243], v[200:203], a[144:147]
 v_exp_f32 v195, v195
 v_add_f32 v57, v57, v194
 v_mfma_f32_16x16x32_bf16 a[148:151], a[244:247], v[200:203], a[148:151]
 v_exp_f32 v196, v196
 v_cvt_pk_bf16_f32 v205, v194, v195
 v_mfma_f32_16x16x32_bf16 a[152:155], a[248:251], v[200:203], a[152:155]
 v_exp_f32 v197, v197
 v_add_f32 v57, v57, v195
 v_mfma_f32_16x16x32_bf16 a[156:159], a[252:255], v[200:203], a[156:159]
 v_exp_f32 v198, v198
 s_waitcnt lgkmcnt(5)
 v_mfma_f32_16x16x32_bf16 v[184:187], a[192:195], v[64:67], v[160:163]
 v_cvt_pk_bf16_f32 v206, v196, v197
 v_exp_f32 v199, v199
 v_mfma_f32_16x16x32_bf16 v[188:191], a[196:199], v[64:67], v[160:163]
 v_add_f32 v57, v57, v192
 v_cvt_pk_bf16_f32 v207, v198, v199
 v_add_f32 v57, v57, v196
 v_mfma_f32_16x16x32_bf16 v[184:187], a[200:203], v[72:75], v[184:187]
 v_add_f32 v57, v57, v197
 v_add_f32 v57, v57, v198
 v_add_f32 v57, v57, v199
 v_mfma_f32_16x16x32_bf16 v[188:191], a[204:207], v[72:75], v[188:191]
 s_waitcnt lgkmcnt(0)
 v_mfma_f32_16x16x32_bf16 v[184:187], a[208:211], v[80:83], v[184:187]
 v_mfma_f32_16x16x32_bf16 v[188:191], a[212:215], v[80:83], v[188:191]
 v_mfma_f32_16x16x32_bf16 v[184:187], a[216:219], v[88:91], v[184:187]
 v_mfma_f32_16x16x32_bf16 v[188:191], a[220:223], v[88:91], v[188:191]
 s_waitcnt vmcnt(8)
 s_barrier
 v_mfma_f32_16x16x32_bf16 a[160:163], a[224:227], v[204:207], a[160:163]
 ds_read_b64_tr_b16 a[224:225], v40 offset:16384
 s_add_u32 m0, s74, 32768
 s_nop 0
 v_exp_f32 v184, v184
 v_mfma_f32_16x16x32_bf16 a[164:167], a[228:231], v[204:207], a[164:167]
 ds_read_b64_tr_b16 a[228:229], v41 offset:16384
 v_exp_f32 v185, v185
 v_mfma_f32_16x16x32_bf16 a[168:171], a[232:235], v[204:207], a[168:171]
 ds_read_b64_tr_b16 a[232:233], v42 offset:16384
 buffer_load_dwordx4 v18, s[20:23], s76 offen lds
 v_exp_f32 v186, v186
 v_mfma_f32_16x16x32_bf16 a[172:175], a[236:239], v[204:207], a[172:175]
 ds_read_b64_tr_b16 a[236:237], v43 offset:16384
 v_cvt_pk_bf16_f32 v200, v184, v185
 v_add_f32 v52, v52, v185
 v_mfma_f32_16x16x32_bf16 a[176:179], a[240:243], v[204:207], a[176:179]
 ds_read_b64_tr_b16 a[226:227], v40 offset:20480
 ds_read_b64_tr_b16 a[240:241], v44 offset:16384
 buffer_load_dwordx4 v19, s[20:23], s76 offen offset:1024 lds
 v_add_f32 v52, v52, v186
 v_mfma_f32_16x16x32_bf16 a[180:183], a[244:247], v[204:207], a[180:183]
 ds_read_b64_tr_b16 a[230:231], v41 offset:20480
 ds_read_b64_tr_b16 a[244:245], v45 offset:16384
 v_mfma_f32_16x16x32_bf16 a[184:187], a[248:251], v[204:207], a[184:187]
 ds_read_b64_tr_b16 a[234:235], v42 offset:20480
 ds_read_b64_tr_b16 a[248:249], v46 offset:16384
 buffer_load_dwordx4 v20, s[20:23], s76 offen offset:2048 lds
 v_mfma_f32_16x16x32_bf16 a[188:191], a[252:255], v[204:207], a[188:191]
 ds_read_b64_tr_b16 a[238:239], v43 offset:20480
 ds_read_b64_tr_b16 a[252:253], v47 offset:16384
 v_mfma_f32_16x16x32_bf16 v[192:195], a[192:195], v[68:71], v[164:167]
 ds_read_b64_tr_b16 a[242:243], v44 offset:20480
 buffer_load_dwordx4 v21, s[20:23], s76 offen offset:3072 lds
 v_exp_f32 v187, v187
 v_mfma_f32_16x16x32_bf16 v[196:199], a[196:199], v[68:71], v[164:167]
 ds_read_b64_tr_b16 a[246:247], v45 offset:20480
 v_exp_f32 v188, v188
 v_mfma_f32_16x16x32_bf16 v[192:195], a[200:203], v[76:79], v[192:195]
 ds_read_b64_tr_b16 a[250:251], v46 offset:20480
 s_add_u32 m0, s74, 36864
 s_nop 0
 v_cvt_pk_bf16_f32 v201, v186, v187
 v_add_f32 v52, v52, v187
 v_mfma_f32_16x16x32_bf16 v[196:199], a[204:207], v[76:79], v[196:199]
 ds_read_b64_tr_b16 a[254:255], v47 offset:20480
 v_exp_f32 v189, v189
 v_mfma_f32_16x16x32_bf16 v[192:195], a[208:211], v[84:87], v[192:195]
 buffer_load_dwordx4 v22, s[20:23], s76 offen lds
 v_exp_f32 v190, v190
 v_mfma_f32_16x16x32_bf16 v[196:199], a[212:215], v[84:87], v[196:199]
 v_cvt_pk_bf16_f32 v202, v188, v189
 v_exp_f32 v191, v191
 v_mfma_f32_16x16x32_bf16 v[192:195], a[216:219], v[92:95], v[192:195]
 buffer_load_dwordx4 v23, s[20:23], s76 offen offset:1024 lds
 v_add_f32 v52, v52, v184
 v_cvt_pk_bf16_f32 v203, v190, v191
 v_mfma_f32_16x16x32_bf16 v[196:199], a[220:223], v[92:95], v[196:199]
 v_add_f32 v52, v52, v188
 v_add_f32 v52, v52, v189
 s_waitcnt lgkmcnt(5)
 v_mfma_f32_16x16x32_bf16 a[0:3], a[224:227], v[200:203], a[0:3]
 buffer_load_dwordx4 v24, s[20:23], s76 offen offset:2048 lds
 v_exp_f32 v192, v192
 v_mfma_f32_16x16x32_bf16 a[4:7], a[228:231], v[200:203], a[4:7]
 v_exp_f32 v193, v193
 v_add_f32 v52, v52, v190
 v_mfma_f32_16x16x32_bf16 a[8:11], a[232:235], v[200:203], a[8:11]
 buffer_load_dwordx4 v25, s[20:23], s76 offen offset:3072 lds
 v_exp_f32 v194, v194
 v_mfma_f32_16x16x32_bf16 a[12:15], a[236:239], v[200:203], a[12:15]
 v_cvt_pk_bf16_f32 v204, v192, v193
 v_add_f32 v52, v52, v191
 s_waitcnt lgkmcnt(0)
 v_mfma_f32_16x16x32_bf16 a[16:19], a[240:243], v[200:203], a[16:19]
 s_add_u32 s76, s76, 65536
 v_exp_f32 v195, v195
 v_mfma_f32_16x16x32_bf16 a[20:23], a[244:247], v[200:203], a[20:23]
 v_exp_f32 v196, v196
 v_cvt_pk_bf16_f32 v205, v194, v195
 v_mfma_f32_16x16x32_bf16 a[24:27], a[248:251], v[200:203], a[24:27]
 s_add_u32 m0, s74, 98304
 s_nop 0
 v_exp_f32 v197, v197
 v_mfma_f32_16x16x32_bf16 a[28:31], a[252:255], v[200:203], a[28:31]
 v_exp_f32 v198, v198
 v_cvt_pk_bf16_f32 v206, v196, v197
 v_mfma_f32_16x16x32_bf16 v[184:187], a[192:195], v[96:99], v[168:171]
 buffer_load_dwordx4 v18, s[20:23], s76 offen lds
 v_exp_f32 v199, v199
 v_mfma_f32_16x16x32_bf16 v[188:191], a[196:199], v[96:99], v[168:171]
 v_add_f32 v53, v53, v192
 v_cvt_pk_bf16_f32 v207, v198, v199
 v_mfma_f32_16x16x32_bf16 v[184:187], a[200:203], v[104:107], v[184:187]
 buffer_load_dwordx4 v19, s[20:23], s76 offen offset:1024 lds
 v_add_f32 v53, v53, v193
 v_mfma_f32_16x16x32_bf16 v[188:191], a[204:207], v[104:107], v[188:191]
 v_add_f32 v53, v53, v194
 v_add_f32 v53, v53, v195
 v_mfma_f32_16x16x32_bf16 v[184:187], a[208:211], v[112:115], v[184:187]
 buffer_load_dwordx4 v20, s[20:23], s76 offen offset:2048 lds
 v_add_f32 v53, v53, v196
 v_mfma_f32_16x16x32_bf16 v[188:191], a[212:215], v[112:115], v[188:191]
 v_add_f32 v53, v53, v197
 v_add_f32 v53, v53, v198
 v_mfma_f32_16x16x32_bf16 v[184:187], a[216:219], v[120:123], v[184:187]
 buffer_load_dwordx4 v21, s[20:23], s76 offen offset:3072 lds
 v_add_f32 v53, v53, v199
 v_mfma_f32_16x16x32_bf16 v[188:191], a[220:223], v[120:123], v[188:191]
 v_mfma_f32_16x16x32_bf16 a[32:35], a[224:227], v[204:207], a[32:35]
 s_add_u32 m0, s74, 102400
 s_nop 0
 v_exp_f32 v184, v184
 v_mfma_f32_16x16x32_bf16 a[36:39], a[228:231], v[204:207], a[36:39]
 v_exp_f32 v185, v185
 v_mfma_f32_16x16x32_bf16 a[40:43], a[232:235], v[204:207], a[40:43]
 buffer_load_dwordx4 v22, s[20:23], s76 offen lds
 v_exp_f32 v186, v186
 v_mfma_f32_16x16x32_bf16 a[44:47], a[236:239], v[204:207], a[44:47]
 v_cvt_pk_bf16_f32 v200, v184, v185
 v_add_f32 v54, v54, v185
 v_mfma_f32_16x16x32_bf16 a[48:51], a[240:243], v[204:207], a[48:51]
 buffer_load_dwordx4 v23, s[20:23], s76 offen offset:1024 lds
 v_exp_f32 v187, v187
 v_mfma_f32_16x16x32_bf16 a[52:55], a[244:247], v[204:207], a[52:55]
 v_exp_f32 v188, v188
 v_mfma_f32_16x16x32_bf16 a[56:59], a[248:251], v[204:207], a[56:59]
 buffer_load_dwordx4 v24, s[20:23], s76 offen offset:2048 lds
 v_cvt_pk_bf16_f32 v201, v186, v187
 v_add_f32 v54, v54, v186
 v_mfma_f32_16x16x32_bf16 a[60:63], a[252:255], v[204:207], a[60:63]
 v_exp_f32 v189, v189
 v_mfma_f32_16x16x32_bf16 v[192:195], a[192:195], v[100:103], v[172:175]
 buffer_load_dwordx4 v25, s[20:23], s76 offen offset:3072 lds
 v_exp_f32 v190, v190
 v_mfma_f32_16x16x32_bf16 v[196:199], a[196:199], v[100:103], v[172:175]
 v_cvt_pk_bf16_f32 v202, v188, v189
 v_add_f32 v54, v54, v187
 v_mfma_f32_16x16x32_bf16 v[192:195], a[200:203], v[108:111], v[192:195]
 s_add_u32 s76, s76, 65536
 v_exp_f32 v191, v191
 v_mfma_f32_16x16x32_bf16 v[196:199], a[204:207], v[108:111], v[196:199]
 v_add_f32 v54, v54, v184
 v_cvt_pk_bf16_f32 v203, v190, v191
 v_mfma_f32_16x16x32_bf16 v[192:195], a[208:211], v[116:119], v[192:195]
 v_add_f32 v54, v54, v188
 v_add_f32 v54, v54, v189
 v_mfma_f32_16x16x32_bf16 v[196:199], a[212:215], v[116:119], v[196:199]
 v_add_f32 v54, v54, v190
 v_add_f32 v54, v54, v191
 v_mfma_f32_16x16x32_bf16 v[192:195], a[216:219], v[124:127], v[192:195]
 v_mfma_f32_16x16x32_bf16 v[196:199], a[220:223], v[124:127], v[196:199]
 v_mfma_f32_16x16x32_bf16 a[64:67], a[224:227], v[200:203], a[64:67]
 v_exp_f32 v192, v192
 v_mfma_f32_16x16x32_bf16 a[68:71], a[228:231], v[200:203], a[68:71]
 v_exp_f32 v193, v193
 v_mfma_f32_16x16x32_bf16 a[72:75], a[232:235], v[200:203], a[72:75]
 v_exp_f32 v194, v194
 v_mfma_f32_16x16x32_bf16 a[76:79], a[236:239], v[200:203], a[76:79]
 v_cvt_pk_bf16_f32 v204, v192, v193
 v_add_f32 v55, v55, v193
 v_mfma_f32_16x16x32_bf16 a[80:83], a[240:243], v[200:203], a[80:83]
 v_exp_f32 v195, v195
 v_mfma_f32_16x16x32_bf16 a[84:87], a[244:247], v[200:203], a[84:87]
 v_exp_f32 v196, v196
 v_mfma_f32_16x16x32_bf16 a[88:91], a[248:251], v[200:203], a[88:91]
 v_cvt_pk_bf16_f32 v205, v194, v195
 v_add_f32 v55, v55, v194
 v_mfma_f32_16x16x32_bf16 a[92:95], a[252:255], v[200:203], a[92:95]
 v_exp_f32 v197, v197
 v_mfma_f32_16x16x32_bf16 v[184:187], a[192:195], v[128:131], v[176:179]
 v_exp_f32 v198, v198
 v_mfma_f32_16x16x32_bf16 v[188:191], a[196:199], v[128:131], v[176:179]
 v_cvt_pk_bf16_f32 v206, v196, v197
 v_add_f32 v55, v55, v195
 v_mfma_f32_16x16x32_bf16 v[184:187], a[200:203], v[136:139], v[184:187]
 v_exp_f32 v199, v199
 v_mfma_f32_16x16x32_bf16 v[188:191], a[204:207], v[136:139], v[188:191]
 v_add_f32 v55, v55, v192
 v_cvt_pk_bf16_f32 v207, v198, v199
 v_mfma_f32_16x16x32_bf16 v[184:187], a[208:211], v[144:147], v[184:187]
 v_add_f32 v55, v55, v196
 v_add_f32 v55, v55, v197
 v_mfma_f32_16x16x32_bf16 v[188:191], a[212:215], v[144:147], v[188:191]
 v_add_f32 v55, v55, v198
 v_add_f32 v55, v55, v199
 v_mfma_f32_16x16x32_bf16 v[184:187], a[216:219], v[152:155], v[184:187]
 v_mfma_f32_16x16x32_bf16 v[188:191], a[220:223], v[152:155], v[188:191]
 v_mfma_f32_16x16x32_bf16 a[96:99], a[224:227], v[204:207], a[96:99]
 v_exp_f32 v184, v184
 v_mfma_f32_16x16x32_bf16 a[100:103], a[228:231], v[204:207], a[100:103]
 v_exp_f32 v185, v185
 v_mfma_f32_16x16x32_bf16 a[104:107], a[232:235], v[204:207], a[104:107]
 v_exp_f32 v186, v186
 v_cvt_pk_bf16_f32 v200, v184, v185
 v_mfma_f32_16x16x32_bf16 a[108:111], a[236:239], v[204:207], a[108:111]
 v_exp_f32 v187, v187
 v_add_f32 v56, v56, v185
 v_mfma_f32_16x16x32_bf16 a[112:115], a[240:243], v[204:207], a[112:115]
 v_exp_f32 v188, v188
 v_cvt_pk_bf16_f32 v201, v186, v187
 v_mfma_f32_16x16x32_bf16 a[116:119], a[244:247], v[204:207], a[116:119]
 v_exp_f32 v189, v189
 v_add_f32 v56, v56, v186
 v_mfma_f32_16x16x32_bf16 a[120:123], a[248:251], v[204:207], a[120:123]
 v_exp_f32 v190, v190
 v_cvt_pk_bf16_f32 v202, v188, v189
 v_mfma_f32_16x16x32_bf16 a[124:127], a[252:255], v[204:207], a[124:127]
 v_exp_f32 v191, v191
 v_add_f32 v56, v56, v184
 v_mfma_f32_16x16x32_bf16 v[192:195], a[192:195], v[132:135], v[180:183]
 v_cvt_pk_bf16_f32 v203, v190, v191
 v_add_f32 v56, v56, v187
 v_mfma_f32_16x16x32_bf16 v[196:199], a[196:199], v[132:135], v[180:183]
 v_add_f32 v56, v56, v188
 v_add_f32 v56, v56, v189
 v_mfma_f32_16x16x32_bf16 v[192:195], a[200:203], v[140:143], v[192:195]
 v_add_f32 v56, v56, v190
 v_add_f32 v56, v56, v191
 v_mfma_f32_16x16x32_bf16 v[196:199], a[204:207], v[140:143], v[196:199]
 v_mfma_f32_16x16x32_bf16 v[192:195], a[208:211], v[148:151], v[192:195]
 v_mfma_f32_16x16x32_bf16 v[196:199], a[212:215], v[148:151], v[196:199]
 v_mfma_f32_16x16x32_bf16 v[192:195], a[216:219], v[156:159], v[192:195]
 v_mfma_f32_16x16x32_bf16 v[196:199], a[220:223], v[156:159], v[196:199]
 v_mfma_f32_16x16x32_bf16 a[128:131], a[224:227], v[200:203], a[128:131]
 v_exp_f32 v192, v192
 v_mfma_f32_16x16x32_bf16 a[132:135], a[228:231], v[200:203], a[132:135]
 v_exp_f32 v193, v193
 v_mfma_f32_16x16x32_bf16 a[136:139], a[232:235], v[200:203], a[136:139]
 v_exp_f32 v194, v194
 v_mfma_f32_16x16x32_bf16 a[140:143], a[236:239], v[200:203], a[140:143]
 v_cvt_pk_bf16_f32 v204, v192, v193
 v_add_f32 v57, v57, v193
 v_mfma_f32_16x16x32_bf16 a[144:147], a[240:243], v[200:203], a[144:147]
 v_exp_f32 v195, v195
 v_add_f32 v57, v57, v194
 v_mfma_f32_16x16x32_bf16 a[148:151], a[244:247], v[200:203], a[148:151]
 v_exp_f32 v196, v196
 v_cvt_pk_bf16_f32 v205, v194, v195
 v_mfma_f32_16x16x32_bf16 a[152:155], a[248:251], v[200:203], a[152:155]
 v_exp_f32 v197, v197
 v_add_f32 v57, v57, v195
 v_mfma_f32_16x16x32_bf16 a[156:159], a[252:255], v[200:203], a[156:159]
 v_exp_f32 v198, v198
 v_cvt_pk_bf16_f32 v206, v196, v197
 v_exp_f32 v199, v199
 v_add_f32 v57, v57, v192
 v_cvt_pk_bf16_f32 v207, v198, v199
 v_add_f32 v57, v57, v196
 v_add_f32 v57, v57, v197
 v_add_f32 v57, v57, v198
 v_add_f32 v57, v57, v199
 s_nop 1
 v_mfma_f32_16x16x32_bf16 a[160:163], a[224:227], v[204:207], a[160:163]
 v_mov_b32 v3, v52
 s_nop 1
 v_permlane16_swap_b32 v52, v3
 v_mfma_f32_16x16x32_bf16 a[164:167], a[228:231], v[204:207], a[164:167]
 s_nop 1
 v_add_f32 v52, v52, v3
 v_mov_b32 v3, v52
 s_nop 1
 v_mfma_f32_16x16x32_bf16 a[168:171], a[232:235], v[204:207], a[168:171]
 v_permlane32_swap_b32 v52, v3
 s_nop 1
 v_add_f32 v52, v52, v3
 v_mfma_f32_16x16x32_bf16 a[172:175], a[236:239], v[204:207], a[172:175]
 v_cmp_ngt_f32 s[98:99], s53, v52
 v_rcp_f32 v232, v52
 v_rcp_f32 v233, v52
 v_mfma_f32_16x16x32_bf16 a[176:179], a[240:243], v[204:207], a[176:179]
 v_mov_b32 v3, v53
 s_nop 1
 v_permlane16_swap_b32 v53, v3
 s_nop 1
 v_mfma_f32_16x16x32_bf16 a[180:183], a[244:247], v[204:207], a[180:183]
 v_add_f32 v53, v53, v3
 v_mov_b32 v3, v53
 s_nop 1
 v_mfma_f32_16x16x32_bf16 a[184:187], a[248:251], v[204:207], a[184:187]
 v_permlane32_swap_b32 v53, v3
 s_nop 1
 v_add_f32 v53, v53, v3
 v_cmp_ngt_f32 s[100:101], s53, v53
 v_mfma_f32_16x16x32_bf16 a[188:191], a[252:255], v[204:207], a[188:191]
 v_rcp_f32 v234, v53
 v_rcp_f32 v235, v53
 s_or_b64 s[98:99], s[98:99], s[100:101]
 v_mov_b32 v3, v54
 s_nop 1
 v_permlane16_swap_b32 v54, v3
 s_nop 1
 v_add_f32 v54, v54, v3
 v_mov_b32 v3, v54
 s_nop 1
 v_permlane32_swap_b32 v54, v3
 s_nop 1
 v_add_f32 v54, v54, v3
 v_cmp_ngt_f32 s[100:101], s53, v54
 v_rcp_f32 v236, v54
 v_rcp_f32 v237, v54
 s_or_b64 s[98:99], s[98:99], s[100:101]
 v_mov_b32 v3, v55
 s_nop 1
 v_permlane16_swap_b32 v55, v3
 s_nop 1
 v_add_f32 v55, v55, v3
 v_mov_b32 v3, v55
 s_nop 1
 v_permlane32_swap_b32 v55, v3
 s_nop 1
 v_add_f32 v55, v55, v3
 v_cmp_ngt_f32 s[100:101], s53, v55
 v_rcp_f32 v238, v55
 v_rcp_f32 v239, v55
 s_or_b64 s[98:99], s[98:99], s[100:101]
 v_mov_b32 v3, v56
 s_nop 1
 v_permlane16_swap_b32 v56, v3
 s_nop 1
 v_add_f32 v56, v56, v3
 v_mov_b32 v3, v56
 s_nop 1
 v_permlane32_swap_b32 v56, v3
 s_nop 1
 v_add_f32 v56, v56, v3
 v_cmp_ngt_f32 s[100:101], s53, v56
 v_rcp_f32 v240, v56
 v_rcp_f32 v241, v56
 s_or_b64 s[98:99], s[98:99], s[100:101]
 v_mov_b32 v3, v57
 s_nop 1
 v_permlane16_swap_b32 v57, v3
 s_nop 1
 v_add_f32 v57, v57, v3
 v_mov_b32 v3, v57
 s_nop 1
 v_permlane32_swap_b32 v57, v3
 s_nop 1
 v_add_f32 v57, v57, v3
 v_cmp_ngt_f32 s[100:101], s53, v57
 v_rcp_f32 v242, v57
 v_rcp_f32 v243, v57
 s_or_b64 s[98:99], s[98:99], s[100:101]
 s_cmp_lg_u64 s[98:99], 0
 s_cselect_b32 s42, 1, 0
 s_andn2_b32 s42, s42, s59
 v_mov_b32 v3, s42
 ds_write_b32 v62, v3
 v_readfirstlane_b32 s93, v63
 s_or_b32 s93, s93, s36
 s_cbranch_scc0 L1_tagslow
L1_tagok:
 ds_write_b32 v62, v63 offset:16
 s_add_u32 s42, s56, 0
 v_accvgpr_read_b32 v208, a0
 v_accvgpr_read_b32 v209, a1
 v_accvgpr_read_b32 v210, a2
 v_accvgpr_read_b32 v211, a3
 v_accvgpr_read_b32 v212, a4
 v_accvgpr_read_b32 v213, a5
 v_accvgpr_read_b32 v214, a6
 v_accvgpr_read_b32 v215, a7
 v_pk_mul_f32 v[208:209], v[208:209], v[232:233]
 v_pk_mul_f32 v[210:211], v[210:211], v[232:233]
 v_pk_mul_f32 v[212:213], v[212:213], v[232:233]
 v_pk_mul_f32 v[214:215], v[214:215], v[232:233]
 v_cvt_pk_bf16_f32 v224, v208, v209
 v_cvt_pk_bf16_f32 v225, v210, v211
 v_cvt_pk_bf16_f32 v226, v212, v213
 v_cvt_pk_bf16_f32 v227, v214, v215
 buffer_store_dwordx4 v[224:227], v59, s[32:35], s42 offen sc1
 v_accvgpr_read_b32 v216, a8
 v_accvgpr_read_b32 v217, a9
 v_accvgpr_read_b32 v218, a10
 v_accvgpr_read_b32 v219, a11
 v_accvgpr_read_b32 v220, a12
 v_accvgpr_read_b32 v221, a13
 v_accvgpr_read_b32 v222, a14
 v_accvgpr_read_b32 v223, a15
 v_pk_mul_f32 v[216:217], v[216:217], v[232:233]
 v_pk_mul_f32 v[218:219], v[218:219], v[232:233]
 v_pk_mul_f32 v[220:221], v[220:221], v[232:233]
 v_pk_mul_f32 v[222:223], v[222:223], v[232:233]
 v_cvt_pk_bf16_f32 v228, v216, v217
 v_cvt_pk_bf16_f32 v229, v218, v219
 v_cvt_pk_bf16_f32 v230, v220, v221
 v_cvt_pk_bf16_f32 v231, v222, v223
 buffer_store_dwordx4 v[228:231], v59, s[32:35], s42 offen offset:1024 sc1
 v_accvgpr_read_b32 v208, a16
 v_accvgpr_read_b32 v209, a17
 v_accvgpr_read_b32 v210, a18
 v_accvgpr_read_b32 v211, a19
 v_accvgpr_read_b32 v212, a20
 v_accvgpr_read_b32 v213, a21
 v_accvgpr_read_b32 v214, a22
 v_accvgpr_read_b32 v215, a23
 v_pk_mul_f32 v[208:209], v[208:209], v[232:233]
 v_pk_mul_f32 v[210:211], v[210:211], v[232:233]
 v_pk_mul_f32 v[212:213], v[212:213], v[232:233]
 v_pk_mul_f32 v[214:215], v[214:215], v[232:233]
 v_cvt_pk_bf16_f32 v224, v208, v209
 v_cvt_pk_bf16_f32 v225, v210, v211
 v_cvt_pk_bf16_f32 v226, v212, v213
 v_cvt_pk_bf16_f32 v227, v214, v215
 buffer_store_dwordx4 v[224:227], v59, s[32:35], s42 offen offset:2048 sc1
 v_accvgpr_read_b32 v216, a24
 v_accvgpr_read_b32 v217, a25
 v_accvgpr_read_b32 v218, a26
 v_accvgpr_read_b32 v219, a27
 v_accvgpr_read_b32 v220, a28
 v_accvgpr_read_b32 v221, a29
 v_accvgpr_read_b32 v222, a30
 v_accvgpr_read_b32 v223, a31
 v_pk_mul_f32 v[216:217], v[216:217], v[232:233]
 v_pk_mul_f32 v[218:219], v[218:219], v[232:233]
 v_pk_mul_f32 v[220:221], v[220:221], v[232:233]
 v_pk_mul_f32 v[222:223], v[222:223], v[232:233]
 v_cvt_pk_bf16_f32 v228, v216, v217
 v_cvt_pk_bf16_f32 v229, v218, v219
 v_cvt_pk_bf16_f32 v230, v220, v221
 v_cvt_pk_bf16_f32 v231, v222, v223
 buffer_store_dwordx4 v[228:231], v59, s[32:35], s42 offen offset:3072 sc1
 v_mfma_f32_32x32x16_bf16 a[0:15], v[252:255], v[252:255], 0
 v_mfma_f32_32x32x16_bf16 a[16:31], v[252:255], v[252:255], 0
 s_waitcnt lgkmcnt(0)
 s_barrier
 v_and_b32 v2, 0xfffffff0, v62
 ds_read_b128 v[244:247], v2
 ds_read_b32 v63, v2 offset:16
 s_add_u32 s42, s56, 131072
 v_accvgpr_read_b32 v208, a32
 v_accvgpr_read_b32 v209, a33
 v_accvgpr_read_b32 v210, a34
 v_accvgpr_read_b32 v211, a35
 v_accvgpr_read_b32 v212, a36
 v_accvgpr_read_b32 v213, a37
 v_accvgpr_read_b32 v214, a38
 v_accvgpr_read_b32 v215, a39
 v_pk_mul_f32 v[208:209], v[208:209], v[234:235]
 v_pk_mul_f32 v[210:211], v[210:211], v[234:235]
 v_pk_mul_f32 v[212:213], v[212:213], v[234:235]
 v_pk_mul_f32 v[214:215], v[214:215], v[234:235]
 v_cvt_pk_bf16_f32 v224, v208, v209
 v_cvt_pk_bf16_f32 v225, v210, v211
 v_cvt_pk_bf16_f32 v226, v212, v213
 v_cvt_pk_bf16_f32 v227, v214, v215
 buffer_store_dwordx4 v[224:227], v59, s[32:35], s42 offen sc1
 v_accvgpr_read_b32 v216, a40
 v_accvgpr_read_b32 v217, a41
 v_accvgpr_read_b32 v218, a42
 v_accvgpr_read_b32 v219, a43
 v_accvgpr_read_b32 v220, a44
 v_accvgpr_read_b32 v221, a45
 v_accvgpr_read_b32 v222, a46
 v_accvgpr_read_b32 v223, a47
 v_pk_mul_f32 v[216:217], v[216:217], v[234:235]
 v_pk_mul_f32 v[218:219], v[218:219], v[234:235]
 v_pk_mul_f32 v[220:221], v[220:221], v[234:235]
 v_pk_mul_f32 v[222:223], v[222:223], v[234:235]
 v_cvt_pk_bf16_f32 v228, v216, v217
 v_cvt_pk_bf16_f32 v229, v218, v219
 v_cvt_pk_bf16_f32 v230, v220, v221
 v_cvt_pk_bf16_f32 v231, v222, v223
 buffer_store_dwordx4 v[228:231], v59, s[32:35], s42 offen offset:1024 sc1
 v_accvgpr_read_b32 v208, a48
 v_accvgpr_read_b32 v209, a49
 v_accvgpr_read_b32 v210, a50
 v_accvgpr_read_b32 v211, a51
 v_accvgpr_read_b32 v212, a52
 v_accvgpr_read_b32 v213, a53
 v_accvgpr_read_b32 v214, a54
 v_accvgpr_read_b32 v215, a55
 v_pk_mul_f32 v[208:209], v[208:209], v[234:235]
 v_pk_mul_f32 v[210:211], v[210:211], v[234:235]
 v_pk_mul_f32 v[212:213], v[212:213], v[234:235]
 v_pk_mul_f32 v[214:215], v[214:215], v[234:235]
 v_cvt_pk_bf16_f32 v224, v208, v209
 v_cvt_pk_bf16_f32 v225, v210, v211
 v_cvt_pk_bf16_f32 v226, v212, v213
 v_cvt_pk_bf16_f32 v227, v214, v215
 buffer_store_dwordx4 v[224:227], v59, s[32:35], s42 offen offset:2048 sc1
 v_accvgpr_read_b32 v216, a56
 v_accvgpr_read_b32 v217, a57
 v_accvgpr_read_b32 v218, a58
 v_accvgpr_read_b32 v219, a59
 v_accvgpr_read_b32 v220, a60
 v_accvgpr_read_b32 v221, a61
 v_accvgpr_read_b32 v222, a62
 v_accvgpr_read_b32 v223, a63
 v_pk_mul_f32 v[216:217], v[216:217], v[234:235]
 v_pk_mul_f32 v[218:219], v[218:219], v[234:235]
 v_pk_mul_f32 v[220:221], v[220:221], v[234:235]
 v_pk_mul_f32 v[222:223], v[222:223], v[234:235]
 v_cvt_pk_bf16_f32 v228, v216, v217
 v_cvt_pk_bf16_f32 v229, v218, v219
 v_cvt_pk_bf16_f32 v230, v220, v221
 v_cvt_pk_bf16_f32 v231, v222, v223
 buffer_store_dwordx4 v[228:231], v59, s[32:35], s42 offen offset:3072 sc1
 v_mfma_f32_32x32x16_bf16 a[32:47], v[252:255], v[252:255], 0
 v_mfma_f32_32x32x16_bf16 a[48:63], v[252:255], v[252:255], 0
 s_waitcnt lgkmcnt(0)
 v_or3_b32 v2, v244, v245, v246
 v_or_b32 v2, v2, v247
 s_nop 0
 v_readfirstlane_b32 s43, v2
 s_cmp_lg_u32 s43, 0
 s_cbranch_scc1 L1_fallback
 v_and_b32 v39, 3, v1
 v_lshlrev_b32 v39, 2, v39
 v_mov_b32 v38, v63
 s_mov_b32 s75, 0
 s_mov_b32 s50, 1
 v_add_u32 v168, 0xfffe8000, v10
 v_add_u32 v169, 0xfffe8000, v11
 v_add_u32 v170, 0xfffe8000, v12
 v_add_u32 v171, 0xfffe8000, v13
 v_add_u32 v172, 0xfffe8000, v14
 v_add_u32 v173, 0xfffe8000, v15
 v_add_u32 v174, 0xfffe8000, v16
 v_add_u32 v175, 0xfffe8000, v17
 v_lshlrev_b32 v179, 8, v1
 s_mov_b32 s93, 0
 buffer_load_dword v37, v39, s[84:87], s92 offen sc1
 s_add_u32 s42, s56, 262144
 v_accvgpr_read_b32 v208, a64
 v_accvgpr_read_b32 v209, a65
 v_accvgpr_read_b32 v210, a66
 v_accvgpr_read_b32 v211, a67
 v_accvgpr_read_b32 v212, a68
 v_accvgpr_read_b32 v213, a69
 v_accvgpr_read_b32 v214, a70
 v_accvgpr_read_b32 v215, a71
 v_pk_mul_f32 v[208:209], v[208:209], v[236:237]
 v_pk_mul_f32 v[210:211], v[210:211], v[236:237]
 v_pk_mul_f32 v[212:213], v[212:213], v[236:237]
 v_pk_mul_f32 v[214:215], v[214:215], v[236:237]
 v_cvt_pk_bf16_f32 v224, v208, v209
 v_cvt_pk_bf16_f32 v225, v210, v211
 v_cvt_pk_bf16_f32 v226, v212, v213
 v_cvt_pk_bf16_f32 v227, v214, v215
 buffer_store_dwordx4 v[224:227], v59, s[32:35], s42 offen sc1
 v_accvgpr_read_b32 v216, a72
 v_accvgpr_read_b32 v217, a73
 v_accvgpr_read_b32 v218, a74
 v_accvgpr_read_b32 v219, a75
 v_accvgpr_read_b32 v220, a76
 v_accvgpr_read_b32 v221, a77
 v_accvgpr_read_b32 v222, a78
 v_accvgpr_read_b32 v223, a79
 v_pk_mul_f32 v[216:217], v[216:217], v[236:237]
 v_pk_mul_f32 v[218:219], v[218:219], v[236:237]
 v_pk_mul_f32 v[220:221], v[220:221], v[236:237]
 v_pk_mul_f32 v[222:223], v[222:223], v[236:237]
 v_cvt_pk_bf16_f32 v228, v216, v217
 v_cvt_pk_bf16_f32 v229, v218, v219
 v_cvt_pk_bf16_f32 v230, v220, v221
 v_cvt_pk_bf16_f32 v231, v222, v223
 buffer_store_dwordx4 v[228:231], v59, s[32:35], s42 offen offset:1024 sc1
 v_accvgpr_read_b32 v208, a80
 v_accvgpr_read_b32 v209, a81
 v_accvgpr_read_b32 v210, a82
 v_accvgpr_read_b32 v211, a83
 v_accvgpr_read_b32 v212, a84
 v_accvgpr_read_b32 v213, a85
 v_accvgpr_read_b32 v214, a86
 v_accvgpr_read_b32 v215, a87
 v_pk_mul_f32 v[208:209], v[208:209], v[236:237]
 v_pk_mul_f32 v[210:211], v[210:211], v[236:237]
 v_pk_mul_f32 v[212:213], v[212:213], v[236:237]
 v_pk_mul_f32 v[214:215], v[214:215], v[236:237]
 v_cvt_pk_bf16_f32 v224, v208, v209
 v_cvt_pk_bf16_f32 v225, v210, v211
 v_cvt_pk_bf16_f32 v226, v212, v213
 v_cvt_pk_bf16_f32 v227, v214, v215
 buffer_store_dwordx4 v[224:227], v59, s[32:35], s42 offen offset:2048 sc1
 v_accvgpr_read_b32 v216, a88
 v_accvgpr_read_b32 v217, a89
 v_accvgpr_read_b32 v218, a90
 v_accvgpr_read_b32 v219, a91
 v_accvgpr_read_b32 v220, a92
 v_accvgpr_read_b32 v221, a93
 v_accvgpr_read_b32 v222, a94
 v_accvgpr_read_b32 v223, a95
 v_pk_mul_f32 v[216:217], v[216:217], v[236:237]
 v_pk_mul_f32 v[218:219], v[218:219], v[236:237]
 v_pk_mul_f32 v[220:221], v[220:221], v[236:237]
 v_pk_mul_f32 v[222:223], v[222:223], v[236:237]
 v_cvt_pk_bf16_f32 v228, v216, v217
 v_cvt_pk_bf16_f32 v229, v218, v219
 v_cvt_pk_bf16_f32 v230, v220, v221
 v_cvt_pk_bf16_f32 v231, v222, v223
 buffer_store_dwordx4 v[228:231], v59, s[32:35], s42 offen offset:3072 sc1
 v_mfma_f32_32x32x16_bf16 a[64:79], v[252:255], v[252:255], 0
 v_mfma_f32_32x32x16_bf16 a[80:95], v[252:255], v[252:255], 0
 s_add_u32 s42, s56, 393216
 v_accvgpr_read_b32 v208, a96
 v_accvgpr_read_b32 v209, a97
 v_accvgpr_read_b32 v210, a98
 v_accvgpr_read_b32 v211, a99
 v_accvgpr_read_b32 v212, a100
 v_accvgpr_read_b32 v213, a101
 v_accvgpr_read_b32 v214, a102
 v_accvgpr_read_b32 v215, a103
 v_pk_mul_f32 v[208:209], v[208:209], v[238:239]
 v_pk_mul_f32 v[210:211], v[210:211], v[238:239]
 v_pk_mul_f32 v[212:213], v[212:213], v[238:239]
 v_pk_mul_f32 v[214:215], v[214:215], v[238:239]
 v_cvt_pk_bf16_f32 v224, v208, v209
 v_cvt_pk_bf16_f32 v225, v210, v211
 v_cvt_pk_bf16_f32 v226, v212, v213
 v_cvt_pk_bf16_f32 v227, v214, v215
 buffer_store_dwordx4 v[224:227], v59, s[32:35], s42 offen sc1
 v_accvgpr_read_b32 v216, a104
 v_accvgpr_read_b32 v217, a105
 v_accvgpr_read_b32 v218, a106
 v_accvgpr_read_b32 v219, a107
 v_accvgpr_read_b32 v220, a108
 v_accvgpr_read_b32 v221, a109
 v_accvgpr_read_b32 v222, a110
 v_accvgpr_read_b32 v223, a111
 v_pk_mul_f32 v[216:217], v[216:217], v[238:239]
 v_pk_mul_f32 v[218:219], v[218:219], v[238:239]
 v_pk_mul_f32 v[220:221], v[220:221], v[238:239]
 v_pk_mul_f32 v[222:223], v[222:223], v[238:239]
 v_cvt_pk_bf16_f32 v228, v216, v217
 v_cvt_pk_bf16_f32 v229, v218, v219
 v_cvt_pk_bf16_f32 v230, v220, v221
 v_cvt_pk_bf16_f32 v231, v222, v223
 buffer_store_dwordx4 v[228:231], v59, s[32:35], s42 offen offset:1024 sc1
 v_accvgpr_read_b32 v208, a112
 v_accvgpr_read_b32 v209, a113
 v_accvgpr_read_b32 v210, a114
 v_accvgpr_read_b32 v211, a115
 v_accvgpr_read_b32 v212, a116
 v_accvgpr_read_b32 v213, a117
 v_accvgpr_read_b32 v214, a118
 v_accvgpr_read_b32 v215, a119
 v_pk_mul_f32 v[208:209], v[208:209], v[238:239]
 v_pk_mul_f32 v[210:211], v[210:211], v[238:239]
 v_pk_mul_f32 v[212:213], v[212:213], v[238:239]
 v_pk_mul_f32 v[214:215], v[214:215], v[238:239]
 v_cvt_pk_bf16_f32 v224, v208, v209
 v_cvt_pk_bf16_f32 v225, v210, v211
 v_cvt_pk_bf16_f32 v226, v212, v213
 v_cvt_pk_bf16_f32 v227, v214, v215
 buffer_store_dwordx4 v[224:227], v59, s[32:35], s42 offen offset:2048 sc1
 v_accvgpr_read_b32 v216, a120
 v_accvgpr_read_b32 v217, a121
 v_accvgpr_read_b32 v218, a122
 v_accvgpr_read_b32 v219, a123
 v_accvgpr_read_b32 v220, a124
 v_accvgpr_read_b32 v221, a125
 v_accvgpr_read_b32 v222, a126
 v_accvgpr_read_b32 v223, a127
 v_pk_mul_f32 v[216:217], v[216:217], v[238:239]
 v_pk_mul_f32 v[218:219], v[218:219], v[238:239]
 v_pk_mul_f32 v[220:221], v[220:221], v[238:239]
 v_pk_mul_f32 v[222:223], v[222:223], v[238:239]
 v_cvt_pk_bf16_f32 v228, v216, v217
 v_cvt_pk_bf16_f32 v229, v218, v219
 v_cvt_pk_bf16_f32 v230, v220, v221
 v_cvt_pk_bf16_f32 v231, v222, v223
 buffer_store_dwordx4 v[228:231], v59, s[32:35], s42 offen offset:3072 sc1
 v_mfma_f32_32x32x16_bf16 a[96:111], v[252:255], v[252:255], 0
 v_mfma_f32_32x32x16_bf16 a[112:127], v[252:255], v[252:255], 0
 s_add_u32 s42, s56, 524288
 v_accvgpr_read_b32 v208, a128
 v_accvgpr_read_b32 v209, a129
 v_accvgpr_read_b32 v210, a130
 v_accvgpr_read_b32 v211, a131
 v_accvgpr_read_b32 v212, a132
 v_accvgpr_read_b32 v213, a133
 v_accvgpr_read_b32 v214, a134
 v_accvgpr_read_b32 v215, a135
 v_pk_mul_f32 v[208:209], v[208:209], v[240:241]
 v_pk_mul_f32 v[210:211], v[210:211], v[240:241]
 v_pk_mul_f32 v[212:213], v[212:213], v[240:241]
 v_pk_mul_f32 v[214:215], v[214:215], v[240:241]
 v_cvt_pk_bf16_f32 v224, v208, v209
 v_cvt_pk_bf16_f32 v225, v210, v211
 v_cvt_pk_bf16_f32 v226, v212, v213
 v_cvt_pk_bf16_f32 v227, v214, v215
 buffer_store_dwordx4 v[224:227], v59, s[32:35], s42 offen sc1
 v_accvgpr_read_b32 v216, a136
 v_accvgpr_read_b32 v217, a137
 v_accvgpr_read_b32 v218, a138
 v_accvgpr_read_b32 v219, a139
 v_accvgpr_read_b32 v220, a140
 v_accvgpr_read_b32 v221, a141
 v_accvgpr_read_b32 v222, a142
 v_accvgpr_read_b32 v223, a143
 v_pk_mul_f32 v[216:217], v[216:217], v[240:241]
 v_pk_mul_f32 v[218:219], v[218:219], v[240:241]
 v_pk_mul_f32 v[220:221], v[220:221], v[240:241]
 v_pk_mul_f32 v[222:223], v[222:223], v[240:241]
 v_cvt_pk_bf16_f32 v228, v216, v217
 v_cvt_pk_bf16_f32 v229, v218, v219
 v_cvt_pk_bf16_f32 v230, v220, v221
 v_cvt_pk_bf16_f32 v231, v222, v223
 buffer_store_dwordx4 v[228:231], v59, s[32:35], s42 offen offset:1024 sc1
 v_accvgpr_read_b32 v208, a144
 v_accvgpr_read_b32 v209, a145
 v_accvgpr_read_b32 v210, a146
 v_accvgpr_read_b32 v211, a147
 v_accvgpr_read_b32 v212, a148
 v_accvgpr_read_b32 v213, a149
 v_accvgpr_read_b32 v214, a150
 v_accvgpr_read_b32 v215, a151
 v_pk_mul_f32 v[208:209], v[208:209], v[240:241]
 v_pk_mul_f32 v[210:211], v[210:211], v[240:241]
 v_pk_mul_f32 v[212:213], v[212:213], v[240:241]
 v_pk_mul_f32 v[214:215], v[214:215], v[240:241]
 v_cvt_pk_bf16_f32 v224, v208, v209
 v_cvt_pk_bf16_f32 v225, v210, v211
 v_cvt_pk_bf16_f32 v226, v212, v213
 v_cvt_pk_bf16_f32 v227, v214, v215
 buffer_store_dwordx4 v[224:227], v59, s[32:35], s42 offen offset:2048 sc1
 v_accvgpr_read_b32 v216, a152
 v_accvgpr_read_b32 v217, a153
 v_accvgpr_read_b32 v218, a154
 v_accvgpr_read_b32 v219, a155
 v_accvgpr_read_b32 v220, a156
 v_accvgpr_read_b32 v221, a157
 v_accvgpr_read_b32 v222, a158
 v_accvgpr_read_b32 v223, a159
 v_pk_mul_f32 v[216:217], v[216:217], v[240:241]
 v_pk_mul_f32 v[218:219], v[218:219], v[240:241]
 v_pk_mul_f32 v[220:221], v[220:221], v[240:241]
 v_pk_mul_f32 v[222:223], v[222:223], v[240:241]
 v_cvt_pk_bf16_f32 v228, v216, v217
 v_cvt_pk_bf16_f32 v229, v218, v219
 v_cvt_pk_bf16_f32 v230, v220, v221
 v_cvt_pk_bf16_f32 v231, v222, v223
 buffer_store_dwordx4 v[228:231], v59, s[32:35], s42 offen offset:3072 sc1
 v_mfma_f32_32x32x16_bf16 a[128:143], v[252:255], v[252:255], 0
 v_mfma_f32_32x32x16_bf16 a[144:159], v[252:255], v[252:255], 0
 s_add_u32 s42, s56, 655360
 v_accvgpr_read_b32 v208, a160
 v_accvgpr_read_b32 v209, a161
 v_accvgpr_read_b32 v210, a162
 v_accvgpr_read_b32 v211, a163
 v_accvgpr_read_b32 v212, a164
 v_accvgpr_read_b32 v213, a165
 v_accvgpr_read_b32 v214, a166
 v_accvgpr_read_b32 v215, a167
 v_pk_mul_f32 v[208:209], v[208:209], v[242:243]
 v_pk_mul_f32 v[210:211], v[210:211], v[242:243]
 v_pk_mul_f32 v[212:213], v[212:213], v[242:243]
 v_pk_mul_f32 v[214:215], v[214:215], v[242:243]
 v_cvt_pk_bf16_f32 v224, v208, v209
 v_cvt_pk_bf16_f32 v225, v210, v211
 v_cvt_pk_bf16_f32 v226, v212, v213
 v_cvt_pk_bf16_f32 v227, v214, v215
 buffer_store_dwordx4 v[224:227], v59, s[32:35], s42 offen sc1
 v_accvgpr_read_b32 v216, a168
 v_accvgpr_read_b32 v217, a169
 v_accvgpr_read_b32 v218, a170
 v_accvgpr_read_b32 v219, a171
 v_accvgpr_read_b32 v220, a172
 v_accvgpr_read_b32 v221, a173
 v_accvgpr_read_b32 v222, a174
 v_accvgpr_read_b32 v223, a175
 v_pk_mul_f32 v[216:217], v[216:217], v[242:243]
 v_pk_mul_f32 v[218:219], v[218:219], v[242:243]
 v_pk_mul_f32 v[220:221], v[220:221], v[242:243]
 v_pk_mul_f32 v[222:223], v[222:223], v[242:243]
 v_cvt_pk_bf16_f32 v228, v216, v217
 v_cvt_pk_bf16_f32 v229, v218, v219
 v_cvt_pk_bf16_f32 v230, v220, v221
 v_cvt_pk_bf16_f32 v231, v222, v223
 buffer_store_dwordx4 v[228:231], v59, s[32:35], s42 offen offset:1024 sc1
 v_accvgpr_read_b32 v208, a176
 v_accvgpr_read_b32 v209, a177
 v_accvgpr_read_b32 v210, a178
 v_accvgpr_read_b32 v211, a179
 v_accvgpr_read_b32 v212, a180
 v_accvgpr_read_b32 v213, a181
 v_accvgpr_read_b32 v214, a182
 v_accvgpr_read_b32 v215, a183
 v_pk_mul_f32 v[208:209], v[208:209], v[242:243]
 v_pk_mul_f32 v[210:211], v[210:211], v[242:243]
 v_pk_mul_f32 v[212:213], v[212:213], v[242:243]
 v_pk_mul_f32 v[214:215], v[214:215], v[242:243]
 v_cvt_pk_bf16_f32 v224, v208, v209
 v_cvt_pk_bf16_f32 v225, v210, v211
 v_cvt_pk_bf16_f32 v226, v212, v213
 v_cvt_pk_bf16_f32 v227, v214, v215
 buffer_store_dwordx4 v[224:227], v59, s[32:35], s42 offen offset:2048 sc1
 v_accvgpr_read_b32 v216, a184
 v_accvgpr_read_b32 v217, a185
 v_accvgpr_read_b32 v218, a186
 v_accvgpr_read_b32 v219, a187
 v_accvgpr_read_b32 v220, a188
 v_accvgpr_read_b32 v221, a189
 v_accvgpr_read_b32 v222, a190
 v_accvgpr_read_b32 v223, a191
 v_pk_mul_f32 v[216:217], v[216:217], v[242:243]
 v_pk_mul_f32 v[218:219], v[218:219], v[242:243]
 v_pk_mul_f32 v[220:221], v[220:221], v[242:243]
 v_pk_mul_f32 v[222:223], v[222:223], v[242:243]
 v_cvt_pk_bf16_f32 v228, v216, v217
 v_cvt_pk_bf16_f32 v229, v218, v219
 v_cvt_pk_bf16_f32 v230, v220, v221
 v_cvt_pk_bf16_f32 v231, v222, v223
 buffer_store_dwordx4 v[228:231], v59, s[32:35], s42 offen offset:3072 sc1
 v_mfma_f32_32x32x16_bf16 a[160:175], v[252:255], v[252:255], 0
 v_mfma_f32_32x32x16_bf16 a[176:191], v[252:255], v[252:255], 0
 s_waitcnt vmcnt(16)
 v_cmp_ne_u32 vcc, v37, v38
 s_and_b32 s48, vcc_lo, s50
 s_cbranch_scc1 L2_slow0
L2_back0:
 buffer_load_dwordx4 v[72:75], v26, s[24:27], s77 offen sc1
 buffer_load_dwordx4 v[76:79], v27, s[24:27], s77 offen sc1
 buffer_load_dwordx4 v[80:83], v28, s[24:27], s77 offen sc1
 buffer_load_dwordx4 v[84:87], v29, s[24:27], s77 offen sc1
 buffer_load_dwordx4 v[88:91], v30, s[24:27], s77 offen sc1
 buffer_load_dwordx4 v[92:95], v31, s[24:27], s77 offen sc1
 s_add_u32 s77, s77, 1024
 buffer_load_dwordx4 v[96:99], v26, s[24:27], s77 offen sc1
 buffer_load_dwordx4 v[100:103], v27, s[24:27], s77 offen sc1
 buffer_load_dwordx4 v[104:107], v28, s[24:27], s77 offen sc1
 buffer_load_dwordx4 v[108:111], v29, s[24:27], s77 offen sc1
 buffer_load_dwordx4 v[112:115], v30, s[24:27], s77 offen sc1
 buffer_load_dwordx4 v[116:119], v31, s[24:27], s77 offen sc1
 s_add_u32 s77, s77, 1024
 buffer_load_dwordx4 v[120:123], v26, s[24:27], s77 offen sc1
 buffer_load_dwordx4 v[124:127], v27, s[24:27], s77 offen sc1
 buffer_load_dwordx4 v[128:131], v28, s[24:27], s77 offen sc1
 buffer_load_dwordx4 v[132:135], v29, s[24:27], s77 offen sc1
 buffer_load_dwordx4 v[136:139], v30, s[24:27], s77 offen sc1
 buffer_load_dwordx4 v[140:143], v31, s[24:27], s77 offen sc1
 s_add_u32 s77, s77, 1024
 s_add_u32 m0, s74, 0
 s_nop 0
 buffer_load_dwordx4 v18, s[20:23], s76 offen lds
 buffer_load_dwordx4 v19, s[20:23], s76 offen offset:1024 lds
 buffer_load_dwordx4 v20, s[20:23], s76 offen offset:2048 lds
 buffer_load_dwordx4 v21, s[20:23], s76 offen offset:3072 lds
 s_add_u32 m0, s74, 4096
 s_nop 0
 buffer_load_dwordx4 v22, s[20:23], s76 offen lds
 buffer_load_dwordx4 v23, s[20:23], s76 offen offset:1024 lds
 buffer_load_dwordx4 v24, s[20:23], s76 offen offset:2048 lds
 buffer_load_dwordx4 v25, s[20:23], s76 offen offset:3072 lds
 s_add_u32 s76, s76, 65536
 ds_read_b64_tr_b16 v[40:41], v10 offset:32768
 ds_read_b64_tr_b16 v[42:43], v10 offset:36864
 ds_read_b64_tr_b16 v[44:45], v11 offset:32768
 ds_read_b64_tr_b16 v[46:47], v11 offset:36864
 ds_read_b64_tr_b16 v[48:49], v12 offset:32768
 ds_read_b64_tr_b16 v[50:51], v12 offset:36864
 ds_read_b64_tr_b16 v[52:53], v13 offset:32768
 ds_read_b64_tr_b16 v[54:55], v13 offset:36864
 ds_read_b64_tr_b16 v[56:57], v14 offset:32768
 ds_read_b64_tr_b16 v[58:59], v14 offset:36864
 ds_read_b64_tr_b16 v[60:61], v15 offset:32768
 ds_read_b64_tr_b16 v[62:63], v15 offset:36864
 ds_read_b64_tr_b16 v[64:65], v16 offset:32768
 ds_read_b64_tr_b16 v[66:67], v16 offset:36864
 s_mov_b32 s28, s14
 s_mov_b32 s29, s15
 s_mov_b32 s30, 6291456
 s_mov_b32 s31, 0x20000
 v_add_u32 v35, s74, v4
 v_add_u32 v177, 32768, v35
 v_add_u32 v178, 98304, v35
 s_sub_u32 s48, s36, 1
 s_and_b32 s48, s48, 3
 s_mul_i32 s48, s48, 8192
 s_add_u32 s48, s48, 0
 v_add_u32 v32, s48, v4
 s_sub_u32 s48, s36, 2
 s_and_b32 s48, s48, 3
 s_mul_i32 s48, s48, 8192
 s_add_u32 s48, s48, 32768
 v_add_u32 v33, s48, v4
 s_sub_u32 s48, s36, 3
 s_and_b32 s48, s48, 3
 s_mul_i32 s48, s48, 8192
 s_add_u32 s48, s48, 98304
 v_add_u32 v34, s48, v4
 s_mul_i32 s48, s46, 196608
 s_lshl_b32 s49, s47, 8
 s_add_u32 s48, s48, s49
 s_lshl_b32 s49, s36, 6
 s_add_u32 s48, s48, s49
 v_and_b32 v9, 15, v1
 v_lshlrev_b32 v36, 11, v9
 v_add_u32 v36, s48, v36
 v_and_b32 v9, 1, v5
 v_lshl_add_u32 v36, v9, 5, v36
 v_lshrrev_b32 v9, 1, v5
 v_lshl_add_u32 v36, v9, 4, v36
 s_cmp_lg_u32 s93, 0
 s_cbranch_scc1 L2_sigd
 s_waitcnt vmcnt(26)
 s_barrier
 s_cmp_lg_u32 s36, 0
 s_cbranch_scc1 L1_nosiga
 s_mov_b64 exec, 0xffff
 buffer_store_dword v38, v179, s[84:87], s73 offen sc1
 s_mov_b64 exec, -1
L1_nosiga:
L2_sigd:
 s_waitcnt vmcnt(14)
 s_mov_b32 s45, 0
L2_loop:
 s_waitcnt vmcnt(29) lgkmcnt(2)
 v_mfma_f32_16x16x32_bf16 a[0:3], v[40:43], v[72:75], a[0:3]
 ds_read_b64_tr_b16 v[68:69], v17 offset:32768
 v_mfma_f32_16x16x32_bf16 a[32:35], v[40:43], v[76:79], a[32:35]
 ds_read_b64_tr_b16 v[70:71], v17 offset:36864
 v_mfma_f32_16x16x32_bf16 a[64:67], v[40:43], v[80:83], a[64:67]
 s_cmp_eq_u32 s45, 3
 s_cselect_b32 s49, 3145728, 0
 s_add_u32 s76, s76, s49
 v_mfma_f32_16x16x32_bf16 a[96:99], v[40:43], v[84:87], a[96:99]
 v_mfma_f32_16x16x32_bf16 a[128:131], v[40:43], v[88:91], a[128:131]
 s_add_u32 s49, s45, 3
 s_lshr_b32 s49, s49, 1
 s_bfm_b32 s50, s49, 0
 v_mfma_f32_16x16x32_bf16 a[160:163], v[40:43], v[92:95], a[160:163]
 s_waitcnt lgkmcnt(0)
 v_mfma_f32_16x16x32_bf16 a[4:7], v[44:47], v[72:75], a[4:7]
 ds_read_b64_tr_b16 v[40:41], v168 offset:32768
 v_mfma_f32_16x16x32_bf16 a[36:39], v[44:47], v[76:79], a[36:39]
 ds_read_b64_tr_b16 v[42:43], v168 offset:36864
 v_mfma_f32_16x16x32_bf16 a[68:71], v[44:47], v[80:83], a[68:71]
 s_add_u32 m0, s74, 131072
 v_mfma_f32_16x16x32_bf16 a[100:103], v[44:47], v[84:87], a[100:103]
 buffer_load_dwordx4 v18, s[20:23], s76 offen lds
 v_mfma_f32_16x16x32_bf16 a[132:135], v[44:47], v[88:91], a[132:135]
 v_mfma_f32_16x16x32_bf16 a[164:167], v[44:47], v[92:95], a[164:167]
 buffer_load_dwordx4 v19, s[20:23], s76 offen offset:1024 lds
 v_mfma_f32_16x16x32_bf16 a[8:11], v[48:51], v[72:75], a[8:11]
 ds_read_b64_tr_b16 v[44:45], v169 offset:32768
 v_mfma_f32_16x16x32_bf16 a[40:43], v[48:51], v[76:79], a[40:43]
 ds_read_b64_tr_b16 v[46:47], v169 offset:36864
 v_mfma_f32_16x16x32_bf16 a[72:75], v[48:51], v[80:83], a[72:75]
 buffer_load_dwordx4 v20, s[20:23], s76 offen offset:2048 lds
 v_mfma_f32_16x16x32_bf16 a[104:107], v[48:51], v[84:87], a[104:107]
 v_mfma_f32_16x16x32_bf16 a[136:139], v[48:51], v[88:91], a[136:139]
 buffer_load_dwordx4 v21, s[20:23], s76 offen offset:3072 lds
 v_mfma_f32_16x16x32_bf16 a[168:171], v[48:51], v[92:95], a[168:171]
 s_add_u32 m0, s74, 135168
 v_mfma_f32_16x16x32_bf16 a[12:15], v[52:55], v[72:75], a[12:15]
 ds_read_b64_tr_b16 v[48:49], v170 offset:32768
 v_mfma_f32_16x16x32_bf16 a[44:47], v[52:55], v[76:79], a[44:47]
 ds_read_b64_tr_b16 v[50:51], v170 offset:36864
 v_mfma_f32_16x16x32_bf16 a[76:79], v[52:55], v[80:83], a[76:79]
 v_mfma_f32_16x16x32_bf16 a[108:111], v[52:55], v[84:87], a[108:111]
 buffer_load_dwordx4 v22, s[20:23], s76 offen lds
 v_mfma_f32_16x16x32_bf16 a[140:143], v[52:55], v[88:91], a[140:143]
 buffer_load_dwordx4 v23, s[20:23], s76 offen offset:1024 lds
 v_mfma_f32_16x16x32_bf16 a[172:175], v[52:55], v[92:95], a[172:175]
 v_mfma_f32_16x16x32_bf16 a[16:19], v[56:59], v[72:75], a[16:19]
 ds_read_b64_tr_b16 v[52:53], v171 offset:32768
 v_mfma_f32_16x16x32_bf16 a[48:51], v[56:59], v[76:79], a[48:51]
 ds_read_b64_tr_b16 v[54:55], v171 offset:36864
 v_mfma_f32_16x16x32_bf16 a[80:83], v[56:59], v[80:83], a[80:83]
 buffer_load_dwordx4 v24, s[20:23], s76 offen offset:2048 lds
 v_mfma_f32_16x16x32_bf16 a[112:115], v[56:59], v[84:87], a[112:115]
 v_mfma_f32_16x16x32_bf16 a[144:147], v[56:59], v[88:91], a[144:147]
 buffer_load_dwordx4 v25, s[20:23], s76 offen offset:3072 lds
 v_mfma_f32_16x16x32_bf16 a[176:179], v[56:59], v[92:95], a[176:179]
 s_add_u32 s76, s76, 65536
 v_mfma_f32_16x16x32_bf16 a[20:23], v[60:63], v[72:75], a[20:23]
 ds_read_b64_tr_b16 v[56:57], v172 offset:32768
 v_mfma_f32_16x16x32_bf16 a[52:55], v[60:63], v[76:79], a[52:55]
 ds_read_b64_tr_b16 v[58:59], v172 offset:36864
 v_mfma_f32_16x16x32_bf16 a[84:87], v[60:63], v[80:83], a[84:87]
 v_mfma_f32_16x16x32_bf16 a[116:119], v[60:63], v[84:87], a[116:119]
 buffer_load_dwordx4 v[144:147], v26, s[24:27], s77 offen sc1
 v_mfma_f32_16x16x32_bf16 a[148:151], v[60:63], v[88:91], a[148:151]
 buffer_load_dwordx4 v[148:151], v27, s[24:27], s77 offen sc1
 v_mfma_f32_16x16x32_bf16 a[180:183], v[60:63], v[92:95], a[180:183]
 v_mfma_f32_16x16x32_bf16 a[24:27], v[64:67], v[72:75], a[24:27]
 ds_read_b64_tr_b16 v[60:61], v173 offset:32768
 v_mfma_f32_16x16x32_bf16 a[56:59], v[64:67], v[76:79], a[56:59]
 ds_read_b64_tr_b16 v[62:63], v173 offset:36864
 v_mfma_f32_16x16x32_bf16 a[88:91], v[64:67], v[80:83], a[88:91]
 buffer_load_dwordx4 v[152:155], v28, s[24:27], s77 offen sc1
 v_mfma_f32_16x16x32_bf16 a[120:123], v[64:67], v[84:87], a[120:123]
 buffer_load_dwordx4 v[156:159], v29, s[24:27], s77 offen sc1
 v_mfma_f32_16x16x32_bf16 a[152:155], v[64:67], v[88:91], a[152:155]
 v_mfma_f32_16x16x32_bf16 a[184:187], v[64:67], v[92:95], a[184:187]
 buffer_load_dwordx4 v[160:163], v30, s[24:27], s77 offen sc1
 v_mfma_f32_16x16x32_bf16 a[28:31], v[68:71], v[72:75], a[28:31]
 ds_read_b64_tr_b16 v[64:65], v174 offset:32768
 v_mfma_f32_16x16x32_bf16 a[60:63], v[68:71], v[76:79], a[60:63]
 ds_read_b64_tr_b16 v[66:67], v174 offset:36864
 v_mfma_f32_16x16x32_bf16 a[92:95], v[68:71], v[80:83], a[92:95]
 buffer_load_dwordx4 v[164:167], v31, s[24:27], s77 offen sc1
 v_mfma_f32_16x16x32_bf16 a[124:127], v[68:71], v[84:87], a[124:127]
 v_mfma_f32_16x16x32_bf16 a[156:159], v[68:71], v[88:91], a[156:159]
 s_add_u32 s77, s77, 1024
 v_mfma_f32_16x16x32_bf16 a[188:191], v[68:71], v[92:95], a[188:191]
 s_waitcnt vmcnt(29) lgkmcnt(2)
 v_mfma_f32_16x16x32_bf16 a[0:3], v[40:43], v[96:99], a[0:3]
 ds_read_b64_tr_b16 v[68:69], v175 offset:32768
 v_mfma_f32_16x16x32_bf16 a[32:35], v[40:43], v[100:103], a[32:35]
 ds_read_b64_tr_b16 v[70:71], v175 offset:36864
 v_mfma_f32_16x16x32_bf16 a[64:67], v[40:43], v[104:107], a[64:67]
 v_mfma_f32_16x16x32_bf16 a[96:99], v[40:43], v[108:111], a[96:99]
 v_mfma_f32_16x16x32_bf16 a[128:131], v[40:43], v[112:115], a[128:131]
 s_waitcnt vmcnt(28)
 v_cmp_ne_u32 vcc, v37, v38
 s_and_b32 s48, vcc_lo, s50
 s_cbranch_scc1 L2_slow1
L2_back1:
 v_mfma_f32_16x16x32_bf16 a[160:163], v[40:43], v[116:119], a[160:163]
 s_waitcnt lgkmcnt(0)
 v_mfma_f32_16x16x32_bf16 a[4:7], v[44:47], v[96:99], a[4:7]
 ds_read_b64_tr_b16 v[40:41], v10
 v_mfma_f32_16x16x32_bf16 a[36:39], v[44:47], v[100:103], a[36:39]
 ds_read_b64_tr_b16 v[42:43], v10 offset:4096
 v_mfma_f32_16x16x32_bf16 a[68:71], v[44:47], v[104:107], a[68:71]
 s_add_u32 m0, s74, 32768
 v_mfma_f32_16x16x32_bf16 a[100:103], v[44:47], v[108:111], a[100:103]
 buffer_load_dwordx4 v18, s[20:23], s76 offen lds
 v_mfma_f32_16x16x32_bf16 a[132:135], v[44:47], v[112:115], a[132:135]
 v_mfma_f32_16x16x32_bf16 a[164:167], v[44:47], v[116:119], a[164:167]
 buffer_load_dwordx4 v19, s[20:23], s76 offen offset:1024 lds
 v_mfma_f32_16x16x32_bf16 a[8:11], v[48:51], v[96:99], a[8:11]
 ds_read_b64_tr_b16 v[44:45], v11
 v_mfma_f32_16x16x32_bf16 a[40:43], v[48:51], v[100:103], a[40:43]
 ds_read_b64_tr_b16 v[46:47], v11 offset:4096
 v_mfma_f32_16x16x32_bf16 a[72:75], v[48:51], v[104:107], a[72:75]
 buffer_load_dwordx4 v20, s[20:23], s76 offen offset:2048 lds
 v_mfma_f32_16x16x32_bf16 a[104:107], v[48:51], v[108:111], a[104:107]
 v_mfma_f32_16x16x32_bf16 a[136:139], v[48:51], v[112:115], a[136:139]
 buffer_load_dwordx4 v21, s[20:23], s76 offen offset:3072 lds
 v_mfma_f32_16x16x32_bf16 a[168:171], v[48:51], v[116:119], a[168:171]
 s_add_u32 m0, s74, 36864
 v_mfma_f32_16x16x32_bf16 a[12:15], v[52:55], v[96:99], a[12:15]
 ds_read_b64_tr_b16 v[48:49], v12
 v_mfma_f32_16x16x32_bf16 a[44:47], v[52:55], v[100:103], a[44:47]
 ds_read_b64_tr_b16 v[50:51], v12 offset:4096
 v_mfma_f32_16x16x32_bf16 a[76:79], v[52:55], v[104:107], a[76:79]
 v_mfma_f32_16x16x32_bf16 a[108:111], v[52:55], v[108:111], a[108:111]
 buffer_load_dwordx4 v22, s[20:23], s76 offen lds
 v_mfma_f32_16x16x32_bf16 a[140:143], v[52:55], v[112:115], a[140:143]
 buffer_load_dwordx4 v23, s[20:23], s76 offen offset:1024 lds
 v_mfma_f32_16x16x32_bf16 a[172:175], v[52:55], v[116:119], a[172:175]
 v_mfma_f32_16x16x32_bf16 a[16:19], v[56:59], v[96:99], a[16:19]
 ds_read_b64_tr_b16 v[52:53], v13
 v_mfma_f32_16x16x32_bf16 a[48:51], v[56:59], v[100:103], a[48:51]
 ds_read_b64_tr_b16 v[54:55], v13 offset:4096
 v_mfma_f32_16x16x32_bf16 a[80:83], v[56:59], v[104:107], a[80:83]
 buffer_load_dwordx4 v24, s[20:23], s76 offen offset:2048 lds
 v_mfma_f32_16x16x32_bf16 a[112:115], v[56:59], v[108:111], a[112:115]
 v_mfma_f32_16x16x32_bf16 a[144:147], v[56:59], v[112:115], a[144:147]
 buffer_load_dwordx4 v25, s[20:23], s76 offen offset:3072 lds
 v_mfma_f32_16x16x32_bf16 a[176:179], v[56:59], v[116:119], a[176:179]
 s_add_u32 s76, s76, 65536
 v_mfma_f32_16x16x32_bf16 a[20:23], v[60:63], v[96:99], a[20:23]
 ds_read_b64_tr_b16 v[56:57], v14
 v_mfma_f32_16x16x32_bf16 a[52:55], v[60:63], v[100:103], a[52:55]
 ds_read_b64_tr_b16 v[58:59], v14 offset:4096
 v_mfma_f32_16x16x32_bf16 a[84:87], v[60:63], v[104:107], a[84:87]
 v_mfma_f32_16x16x32_bf16 a[116:119], v[60:63], v[108:111], a[116:119]
 buffer_load_dwordx4 v[72:75], v26, s[24:27], s77 offen sc1
 v_mfma_f32_16x16x32_bf16 a[148:151], v[60:63], v[112:115], a[148:151]
 buffer_load_dwordx4 v[76:79], v27, s[24:27], s77 offen sc1
 v_mfma_f32_16x16x32_bf16 a[180:183], v[60:63], v[116:119], a[180:183]
 v_mfma_f32_16x16x32_bf16 a[24:27], v[64:67], v[96:99], a[24:27]
 ds_read_b64_tr_b16 v[60:61], v15
 v_mfma_f32_16x16x32_bf16 a[56:59], v[64:67], v[100:103], a[56:59]
 ds_read_b64_tr_b16 v[62:63], v15 offset:4096
 v_mfma_f32_16x16x32_bf16 a[88:91], v[64:67], v[104:107], a[88:91]
 buffer_load_dwordx4 v[80:83], v28, s[24:27], s77 offen sc1
 v_mfma_f32_16x16x32_bf16 a[120:123], v[64:67], v[108:111], a[120:123]
 buffer_load_dwordx4 v[84:87], v29, s[24:27], s77 offen sc1
 v_mfma_f32_16x16x32_bf16 a[152:155], v[64:67], v[112:115], a[152:155]
 v_mfma_f32_16x16x32_bf16 a[184:187], v[64:67], v[116:119], a[184:187]
 buffer_load_dwordx4 v[88:91], v30, s[24:27], s77 offen sc1
 v_mfma_f32_16x16x32_bf16 a[28:31], v[68:71], v[96:99], a[28:31]
 ds_read_b64_tr_b16 v[64:65], v16
 v_mfma_f32_16x16x32_bf16 a[60:63], v[68:71], v[100:103], a[60:63]
 ds_read_b64_tr_b16 v[66:67], v16 offset:4096
 v_mfma_f32_16x16x32_bf16 a[92:95], v[68:71], v[104:107], a[92:95]
 buffer_load_dwordx4 v[92:95], v31, s[24:27], s77 offen sc1
 v_mfma_f32_16x16x32_bf16 a[124:127], v[68:71], v[108:111], a[124:127]
 v_mfma_f32_16x16x32_bf16 a[156:159], v[68:71], v[112:115], a[156:159]
 s_add_u32 s77, s77, 1024
 v_mfma_f32_16x16x32_bf16 a[188:191], v[68:71], v[116:119], a[188:191]
 s_waitcnt vmcnt(28) lgkmcnt(2)
 v_mfma_f32_16x16x32_bf16 a[0:3], v[40:43], v[120:123], a[0:3]
 ds_read_b64_tr_b16 v[68:69], v17
 v_mfma_f32_16x16x32_bf16 a[32:35], v[40:43], v[124:127], a[32:35]
 ds_read_b64_tr_b16 v[70:71], v17 offset:4096
 v_mfma_f32_16x16x32_bf16 a[64:67], v[40:43], v[128:131], a[64:67]
 v_mfma_f32_16x16x32_bf16 a[96:99], v[40:43], v[132:135], a[96:99]
 v_mfma_f32_16x16x32_bf16 a[128:131], v[40:43], v[136:139], a[128:131]
 v_mfma_f32_16x16x32_bf16 a[160:163], v[40:43], v[140:143], a[160:163]
 s_waitcnt lgkmcnt(0)
 v_mfma_f32_16x16x32_bf16 a[4:7], v[44:47], v[120:123], a[4:7]
 ds_read_b64_tr_b16 v[40:41], v168
 v_mfma_f32_16x16x32_bf16 a[36:39], v[44:47], v[124:127], a[36:39]
 ds_read_b64_tr_b16 v[42:43], v168 offset:4096
 v_mfma_f32_16x16x32_bf16 a[68:71], v[44:47], v[128:131], a[68:71]
 s_add_u32 m0, s74, 98304
 v_mfma_f32_16x16x32_bf16 a[100:103], v[44:47], v[132:135], a[100:103]
 buffer_load_dwordx4 v18, s[20:23], s76 offen lds
 v_mfma_f32_16x16x32_bf16 a[132:135], v[44:47], v[136:139], a[132:135]
 buffer_load_dwordx4 v19, s[20:23], s76 offen offset:1024 lds
 v_mfma_f32_16x16x32_bf16 a[164:167], v[44:47], v[140:143], a[164:167]
 v_mfma_f32_16x16x32_bf16 a[8:11], v[48:51], v[120:123], a[8:11]
 ds_read_b64_tr_b16 v[44:45], v169
 v_mfma_f32_16x16x32_bf16 a[40:43], v[48:51], v[124:127], a[40:43]
 ds_read_b64_tr_b16 v[46:47], v169 offset:4096
 v_mfma_f32_16x16x32_bf16 a[72:75], v[48:51], v[128:131], a[72:75]
 buffer_load_dwordx4 v20, s[20:23], s76 offen offset:2048 lds
 v_mfma_f32_16x16x32_bf16 a[104:107], v[48:51], v[132:135], a[104:107]
 buffer_load_dwordx4 v21, s[20:23], s76 offen offset:3072 lds
 v_mfma_f32_16x16x32_bf16 a[136:139], v[48:51], v[136:139], a[136:139]
 v_mfma_f32_16x16x32_bf16 a[168:171], v[48:51], v[140:143], a[168:171]
 s_add_u32 m0, s74, 102400
 v_mfma_f32_16x16x32_bf16 a[12:15], v[52:55], v[120:123], a[12:15]
 ds_read_b64_tr_b16 v[48:49], v170
 v_mfma_f32_16x16x32_bf16 a[44:47], v[52:55], v[124:127], a[44:47]
 ds_read_b64_tr_b16 v[50:51], v170 offset:4096
 v_mfma_f32_16x16x32_bf16 a[76:79], v[52:55], v[128:131], a[76:79]
 buffer_load_dwordx4 v22, s[20:23], s76 offen lds
 v_mfma_f32_16x16x32_bf16 a[108:111], v[52:55], v[132:135], a[108:111]
 v_mfma_f32_16x16x32_bf16 a[140:143], v[52:55], v[136:139], a[140:143]
 buffer_load_dwordx4 v23, s[20:23], s76 offen offset:1024 lds
 v_mfma_f32_16x16x32_bf16 a[172:175], v[52:55], v[140:143], a[172:175]
 buffer_load_dwordx4 v24, s[20:23], s76 offen offset:2048 lds
 v_mfma_f32_16x16x32_bf16 a[16:19], v[56:59], v[120:123], a[16:19]
 ds_read_b64_tr_b16 v[52:53], v171
 v_mfma_f32_16x16x32_bf16 a[48:51], v[56:59], v[124:127], a[48:51]
 ds_read_b64_tr_b16 v[54:55], v171 offset:4096
 v_mfma_f32_16x16x32_bf16 a[80:83], v[56:59], v[128:131], a[80:83]
 v_mfma_f32_16x16x32_bf16 a[112:115], v[56:59], v[132:135], a[112:115]
 buffer_load_dwordx4 v25, s[20:23], s76 offen offset:3072 lds
 v_mfma_f32_16x16x32_bf16 a[144:147], v[56:59], v[136:139], a[144:147]
 s_add_u32 s76, s76, 65536
 v_mfma_f32_16x16x32_bf16 a[176:179], v[56:59], v[140:143], a[176:179]
 v_mfma_f32_16x16x32_bf16 a[20:23], v[60:63], v[120:123], a[20:23]
 ds_read_b64_tr_b16 v[56:57], v172
 v_mfma_f32_16x16x32_bf16 a[52:55], v[60:63], v[124:127], a[52:55]
 ds_read_b64_tr_b16 v[58:59], v172 offset:4096
 v_mfma_f32_16x16x32_bf16 a[84:87], v[60:63], v[128:131], a[84:87]
 buffer_load_dwordx4 v[96:99], v26, s[24:27], s77 offen sc1
 v_mfma_f32_16x16x32_bf16 a[116:119], v[60:63], v[132:135], a[116:119]
 buffer_load_dwordx4 v[100:103], v27, s[24:27], s77 offen sc1
 v_mfma_f32_16x16x32_bf16 a[148:151], v[60:63], v[136:139], a[148:151]
 v_mfma_f32_16x16x32_bf16 a[180:183], v[60:63], v[140:143], a[180:183]
 buffer_load_dwordx4 v[104:107], v28, s[24:27], s77 offen sc1
 v_mfma_f32_16x16x32_bf16 a[24:27], v[64:67], v[120:123], a[24:27]
 ds_read_b64_tr_b16 v[60:61], v173
 v_mfma_f32_16x16x32_bf16 a[56:59], v[64:67], v[124:127], a[56:59]
 ds_read_b64_tr_b16 v[62:63], v173 offset:4096
 v_mfma_f32_16x16x32_bf16 a[88:91], v[64:67], v[128:131], a[88:91]
 buffer_load_dwordx4 v[108:111], v29, s[24:27], s77 offen sc1
 v_mfma_f32_16x16x32_bf16 a[120:123], v[64:67], v[132:135], a[120:123]
 v_mfma_f32_16x16x32_bf16 a[152:155], v[64:67], v[136:139], a[152:155]
 buffer_load_dwordx4 v[112:115], v30, s[24:27], s77 offen sc1
 v_mfma_f32_16x16x32_bf16 a[184:187], v[64:67], v[140:143], a[184:187]
 buffer_load_dwordx4 v[116:119], v31, s[24:27], s77 offen sc1
 v_mfma_f32_16x16x32_bf16 a[28:31], v[68:71], v[120:123], a[28:31]
 ds_read_b64_tr_b16 v[64:65], v174
 v_mfma_f32_16x16x32_bf16 a[60:63], v[68:71], v[124:127], a[60:63]
 ds_read_b64_tr_b16 v[66:67], v174 offset:4096
 v_mfma_f32_16x16x32_bf16 a[92:95], v[68:71], v[128:131], a[92:95]
 v_mfma_f32_16x16x32_bf16 a[124:127], v[68:71], v[132:135], a[124:127]
 s_add_u32 s77, s77, 1024
 v_mfma_f32_16x16x32_bf16 a[156:159], v[68:71], v[136:139], a[156:159]
 buffer_load_dword v37, v39, s[84:87], s92 offen sc1
 v_mfma_f32_16x16x32_bf16 a[188:191], v[68:71], v[140:143], a[188:191]
 s_waitcnt vmcnt(29) lgkmcnt(2)
 v_mfma_f32_16x16x32_bf16 a[0:3], v[40:43], v[144:147], a[0:3]
 ds_read_b64_tr_b16 v[68:69], v175
 v_mfma_f32_16x16x32_bf16 a[32:35], v[40:43], v[148:151], a[32:35]
 ds_read_b64_tr_b16 v[70:71], v175 offset:4096
 v_mfma_f32_16x16x32_bf16 a[64:67], v[40:43], v[152:155], a[64:67]
 v_mfma_f32_16x16x32_bf16 a[96:99], v[40:43], v[156:159], a[96:99]
 v_mfma_f32_16x16x32_bf16 a[128:131], v[40:43], v[160:163], a[128:131]
 v_mfma_f32_16x16x32_bf16 a[160:163], v[40:43], v[164:167], a[160:163]
 s_waitcnt lgkmcnt(0)
 v_mfma_f32_16x16x32_bf16 a[4:7], v[44:47], v[144:147], a[4:7]
 ds_read_b64_tr_b16 v[40:41], v10 offset:32768
 v_mfma_f32_16x16x32_bf16 a[36:39], v[44:47], v[148:151], a[36:39]
 ds_read_b64_tr_b16 v[42:43], v10 offset:36864
 v_mfma_f32_16x16x32_bf16 a[68:71], v[44:47], v[152:155], a[68:71]
 s_add_u32 m0, s74, 0
 v_mfma_f32_16x16x32_bf16 a[100:103], v[44:47], v[156:159], a[100:103]
 buffer_load_dwordx4 v18, s[20:23], s76 offen lds
 v_mfma_f32_16x16x32_bf16 a[132:135], v[44:47], v[160:163], a[132:135]
 v_mfma_f32_16x16x32_bf16 a[164:167], v[44:47], v[164:167], a[164:167]
 buffer_load_dwordx4 v19, s[20:23], s76 offen offset:1024 lds
 v_mfma_f32_16x16x32_bf16 a[8:11], v[48:51], v[144:147], a[8:11]
 ds_read_b64_tr_b16 v[44:45], v11 offset:32768
 v_mfma_f32_16x16x32_bf16 a[40:43], v[48:51], v[148:151], a[40:43]
 ds_read_b64_tr_b16 v[46:47], v11 offset:36864
 v_mfma_f32_16x16x32_bf16 a[72:75], v[48:51], v[152:155], a[72:75]
 buffer_load_dwordx4 v20, s[20:23], s76 offen offset:2048 lds
 v_mfma_f32_16x16x32_bf16 a[104:107], v[48:51], v[156:159], a[104:107]
 v_mfma_f32_16x16x32_bf16 a[136:139], v[48:51], v[160:163], a[136:139]
 buffer_load_dwordx4 v21, s[20:23], s76 offen offset:3072 lds
 v_mfma_f32_16x16x32_bf16 a[168:171], v[48:51], v[164:167], a[168:171]
 s_add_u32 m0, s74, 4096
 v_mfma_f32_16x16x32_bf16 a[12:15], v[52:55], v[144:147], a[12:15]
 ds_read_b64_tr_b16 v[48:49], v12 offset:32768
 v_mfma_f32_16x16x32_bf16 a[44:47], v[52:55], v[148:151], a[44:47]
 ds_read_b64_tr_b16 v[50:51], v12 offset:36864
 v_mfma_f32_16x16x32_bf16 a[76:79], v[52:55], v[152:155], a[76:79]
 v_mfma_f32_16x16x32_bf16 a[108:111], v[52:55], v[156:159], a[108:111]
 buffer_load_dwordx4 v22, s[20:23], s76 offen lds
 v_mfma_f32_16x16x32_bf16 a[140:143], v[52:55], v[160:163], a[140:143]
 buffer_load_dwordx4 v23, s[20:23], s76 offen offset:1024 lds
 v_mfma_f32_16x16x32_bf16 a[172:175], v[52:55], v[164:167], a[172:175]
 v_mfma_f32_16x16x32_bf16 a[16:19], v[56:59], v[144:147], a[16:19]
 ds_read_b64_tr_b16 v[52:53], v13 offset:32768
 v_mfma_f32_16x16x32_bf16 a[48:51], v[56:59], v[148:151], a[48:51]
 ds_read_b64_tr_b16 v[54:55], v13 offset:36864
 v_mfma_f32_16x16x32_bf16 a[80:83], v[56:59], v[152:155], a[80:83]
 buffer_load_dwordx4 v24, s[20:23], s76 offen offset:2048 lds
 v_mfma_f32_16x16x32_bf16 a[112:115], v[56:59], v[156:159], a[112:115]
 v_mfma_f32_16x16x32_bf16 a[144:147], v[56:59], v[160:163], a[144:147]
 buffer_load_dwordx4 v25, s[20:23], s76 offen offset:3072 lds
 v_mfma_f32_16x16x32_bf16 a[176:179], v[56:59], v[164:167], a[176:179]
 s_add_u32 s76, s76, 65536
 v_mfma_f32_16x16x32_bf16 a[20:23], v[60:63], v[144:147], a[20:23]
 ds_read_b64_tr_b16 v[56:57], v14 offset:32768
 v_mfma_f32_16x16x32_bf16 a[52:55], v[60:63], v[148:151], a[52:55]
 ds_read_b64_tr_b16 v[58:59], v14 offset:36864
 v_mfma_f32_16x16x32_bf16 a[84:87], v[60:63], v[152:155], a[84:87]
 v_mfma_f32_16x16x32_bf16 a[116:119], v[60:63], v[156:159], a[116:119]
 buffer_load_dwordx4 v[120:123], v26, s[24:27], s77 offen sc1
 v_mfma_f32_16x16x32_bf16 a[148:151], v[60:63], v[160:163], a[148:151]
 buffer_load_dwordx4 v[124:127], v27, s[24:27], s77 offen sc1
 v_mfma_f32_16x16x32_bf16 a[180:183], v[60:63], v[164:167], a[180:183]
 v_mfma_f32_16x16x32_bf16 a[24:27], v[64:67], v[144:147], a[24:27]
 ds_read_b64_tr_b16 v[60:61], v15 offset:32768
 v_mfma_f32_16x16x32_bf16 a[56:59], v[64:67], v[148:151], a[56:59]
 ds_read_b64_tr_b16 v[62:63], v15 offset:36864
 v_mfma_f32_16x16x32_bf16 a[88:91], v[64:67], v[152:155], a[88:91]
 buffer_load_dwordx4 v[128:131], v28, s[24:27], s77 offen sc1
 v_mfma_f32_16x16x32_bf16 a[120:123], v[64:67], v[156:159], a[120:123]
 buffer_load_dwordx4 v[132:135], v29, s[24:27], s77 offen sc1
 v_mfma_f32_16x16x32_bf16 a[152:155], v[64:67], v[160:163], a[152:155]
 v_mfma_f32_16x16x32_bf16 a[184:187], v[64:67], v[164:167], a[184:187]
 buffer_load_dwordx4 v[136:139], v30, s[24:27], s77 offen sc1
 v_mfma_f32_16x16x32_bf16 a[28:31], v[68:71], v[144:147], a[28:31]
 ds_read_b64_tr_b16 v[64:65], v16 offset:32768
 v_mfma_f32_16x16x32_bf16 a[60:63], v[68:71], v[148:151], a[60:63]
 ds_read_b64_tr_b16 v[66:67], v16 offset:36864
 v_mfma_f32_16x16x32_bf16 a[92:95], v[68:71], v[152:155], a[92:95]
 buffer_load_dwordx4 v[140:143], v31, s[24:27], s77 offen sc1
 v_mfma_f32_16x16x32_bf16 a[124:127], v[68:71], v[156:159], a[124:127]
 v_mfma_f32_16x16x32_bf16 a[156:159], v[68:71], v[160:163], a[156:159]
 s_add_u32 s77, s77, 1024
 v_mfma_f32_16x16x32_bf16 a[188:191], v[68:71], v[164:167], a[188:191]
 s_add_u32 s45, s45, 1
 s_cmp_lt_u32 s45, 7
 s_cbranch_scc1 L2_loop
 s_waitcnt vmcnt(29) lgkmcnt(2)
 v_mfma_f32_16x16x32_bf16 a[0:3], v[40:43], v[72:75], a[0:3]
 ds_read_b64_tr_b16 v[68:69], v17 offset:32768
 v_mfma_f32_16x16x32_bf16 a[32:35], v[40:43], v[76:79], a[32:35]
 ds_read_b64_tr_b16 v[70:71], v17 offset:36864
 v_mfma_f32_16x16x32_bf16 a[64:67], v[40:43], v[80:83], a[64:67]
 v_mfma_f32_16x16x32_bf16 a[96:99], v[40:43], v[84:87], a[96:99]
 v_mfma_f32_16x16x32_bf16 a[128:131], v[40:43], v[88:91], a[128:131]
 v_mfma_f32_16x16x32_bf16 a[160:163], v[40:43], v[92:95], a[160:163]
 s_waitcnt lgkmcnt(0)
 v_mfma_f32_16x16x32_bf16 a[4:7], v[44:47], v[72:75], a[4:7]
 ds_read_b64_tr_b16 v[40:41], v168 offset:32768
 v_mfma_f32_16x16x32_bf16 a[36:39], v[44:47], v[76:79], a[36:39]
 ds_read_b64_tr_b16 v[42:43], v168 offset:36864
 v_mfma_f32_16x16x32_bf16 a[68:71], v[44:47], v[80:83], a[68:71]
 buffer_load_dwordx4 v[144:147], v26, s[24:27], s77 offen sc1
 v_mfma_f32_16x16x32_bf16 a[100:103], v[44:47], v[84:87], a[100:103]
 buffer_load_dwordx4 v[148:151], v27, s[24:27], s77 offen sc1
 v_mfma_f32_16x16x32_bf16 a[132:135], v[44:47], v[88:91], a[132:135]
 v_mfma_f32_16x16x32_bf16 a[164:167], v[44:47], v[92:95], a[164:167]
 buffer_load_dwordx4 v[152:155], v28, s[24:27], s77 offen sc1
 v_mfma_f32_16x16x32_bf16 a[8:11], v[48:51], v[72:75], a[8:11]
 ds_read_b64_tr_b16 v[44:45], v169 offset:32768
 v_mfma_f32_16x16x32_bf16 a[40:43], v[48:51], v[76:79], a[40:43]
 ds_read_b64_tr_b16 v[46:47], v169 offset:36864
 v_mfma_f32_16x16x32_bf16 a[72:75], v[48:51], v[80:83], a[72:75]
 v_mfma_f32_16x16x32_bf16 a[104:107], v[48:51], v[84:87], a[104:107]
 buffer_load_dwordx4 v[156:159], v29, s[24:27], s77 offen sc1
 v_mfma_f32_16x16x32_bf16 a[136:139], v[48:51], v[88:91], a[136:139]
 buffer_load_dwordx4 v[160:163], v30, s[24:27], s77 offen sc1
 v_mfma_f32_16x16x32_bf16 a[168:171], v[48:51], v[92:95], a[168:171]
 v_mfma_f32_16x16x32_bf16 a[12:15], v[52:55], v[72:75], a[12:15]
 ds_read_b64_tr_b16 v[48:49], v170 offset:32768
 v_mfma_f32_16x16x32_bf16 a[44:47], v[52:55], v[76:79], a[44:47]
 ds_read_b64_tr_b16 v[50:51], v170 offset:36864
 v_mfma_f32_16x16x32_bf16 a[76:79], v[52:55], v[80:83], a[76:79]
 buffer_load_dwordx4 v[164:167], v31, s[24:27], s77 offen sc1
 v_mfma_f32_16x16x32_bf16 a[108:111], v[52:55], v[84:87], a[108:111]
 v_mfma_f32_16x16x32_bf16 a[140:143], v[52:55], v[88:91], a[140:143]
 s_add_u32 s77, s77, 1024
 v_mfma_f32_16x16x32_bf16 a[172:175], v[52:55], v[92:95], a[172:175]
 v_mfma_f32_16x16x32_bf16 a[16:19], v[56:59], v[72:75], a[16:19]
 ds_read_b64_tr_b16 v[52:53], v171 offset:32768
 v_mfma_f32_16x16x32_bf16 a[48:51], v[56:59], v[76:79], a[48:51]
 ds_read_b64_tr_b16 v[54:55], v171 offset:36864
 v_mfma_f32_16x16x32_bf16 a[80:83], v[56:59], v[80:83], a[80:83]
 v_mfma_f32_16x16x32_bf16 a[112:115], v[56:59], v[84:87], a[112:115]
 v_mfma_f32_16x16x32_bf16 a[144:147], v[56:59], v[88:91], a[144:147]
 v_mfma_f32_16x16x32_bf16 a[176:179], v[56:59], v[92:95], a[176:179]
 v_mfma_f32_16x16x32_bf16 a[20:23], v[60:63], v[72:75], a[20:23]
 ds_read_b64_tr_b16 v[56:57], v172 offset:32768
 v_mfma_f32_16x16x32_bf16 a[52:55], v[60:63], v[76:79], a[52:55]
 ds_read_b64_tr_b16 v[58:59], v172 offset:36864
 v_mfma_f32_16x16x32_bf16 a[84:87], v[60:63], v[80:83], a[84:87]
 v_mfma_f32_16x16x32_bf16 a[116:119], v[60:63], v[84:87], a[116:119]
 v_mfma_f32_16x16x32_bf16 a[148:151], v[60:63], v[88:91], a[148:151]
 v_mfma_f32_16x16x32_bf16 a[180:183], v[60:63], v[92:95], a[180:183]
 v_mfma_f32_16x16x32_bf16 a[24:27], v[64:67], v[72:75], a[24:27]
 ds_read_b64_tr_b16 v[60:61], v173 offset:32768
 v_mfma_f32_16x16x32_bf16 a[56:59], v[64:67], v[76:79], a[56:59]
 ds_read_b64_tr_b16 v[62:63], v173 offset:36864
 v_mfma_f32_16x16x32_bf16 a[88:91], v[64:67], v[80:83], a[88:91]
 v_mfma_f32_16x16x32_bf16 a[120:123], v[64:67], v[84:87], a[120:123]
 v_mfma_f32_16x16x32_bf16 a[152:155], v[64:67], v[88:91], a[152:155]
 v_mfma_f32_16x16x32_bf16 a[184:187], v[64:67], v[92:95], a[184:187]
 v_mfma_f32_16x16x32_bf16 a[28:31], v[68:71], v[72:75], a[28:31]
 ds_read_b64_tr_b16 v[64:65], v174 offset:32768
 v_mfma_f32_16x16x32_bf16 a[60:63], v[68:71], v[76:79], a[60:63]
 ds_read_b64_tr_b16 v[66:67], v174 offset:36864
 v_mfma_f32_16x16x32_bf16 a[92:95], v[68:71], v[80:83], a[92:95]
 v_mfma_f32_16x16x32_bf16 a[124:127], v[68:71], v[84:87], a[124:127]
 v_mfma_f32_16x16x32_bf16 a[156:159], v[68:71], v[88:91], a[156:159]
 v_mfma_f32_16x16x32_bf16 a[188:191], v[68:71], v[92:95], a[188:191]
 s_waitcnt vmcnt(21) lgkmcnt(2)
 v_mfma_f32_16x16x32_bf16 a[0:3], v[40:43], v[96:99], a[0:3]
 ds_read_b64_tr_b16 v[68:69], v175 offset:32768
 v_mfma_f32_16x16x32_bf16 a[32:35], v[40:43], v[100:103], a[32:35]
 ds_read_b64_tr_b16 v[70:71], v175 offset:36864
 v_mfma_f32_16x16x32_bf16 a[64:67], v[40:43], v[104:107], a[64:67]
 v_mfma_f32_16x16x32_bf16 a[96:99], v[40:43], v[108:111], a[96:99]
 v_mfma_f32_16x16x32_bf16 a[128:131], v[40:43], v[112:115], a[128:131]
 v_mfma_f32_16x16x32_bf16 a[160:163], v[40:43], v[116:119], a[160:163]
 s_waitcnt lgkmcnt(0)
 v_mfma_f32_16x16x32_bf16 a[4:7], v[44:47], v[96:99], a[4:7]
 ds_read_b64_tr_b16 v[40:41], v10
 v_mfma_f32_16x16x32_bf16 a[36:39], v[44:47], v[100:103], a[36:39]
 ds_read_b64_tr_b16 v[42:43], v10 offset:4096
 v_mfma_f32_16x16x32_bf16 a[68:71], v[44:47], v[104:107], a[68:71]
 v_mfma_f32_16x16x32_bf16 a[100:103], v[44:47], v[108:111], a[100:103]
 v_mfma_f32_16x16x32_bf16 a[132:135], v[44:47], v[112:115], a[132:135]
 v_mfma_f32_16x16x32_bf16 a[164:167], v[44:47], v[116:119], a[164:167]
 v_mfma_f32_16x16x32_bf16 a[8:11], v[48:51], v[96:99], a[8:11]
 ds_read_b64_tr_b16 v[44:45], v11
 v_mfma_f32_16x16x32_bf16 a[40:43], v[48:51], v[100:103], a[40:43]
 ds_read_b64_tr_b16 v[46:47], v11 offset:4096
 v_mfma_f32_16x16x32_bf16 a[72:75], v[48:51], v[104:107], a[72:75]
 v_mfma_f32_16x16x32_bf16 a[104:107], v[48:51], v[108:111], a[104:107]
 v_mfma_f32_16x16x32_bf16 a[136:139], v[48:51], v[112:115], a[136:139]
 v_mfma_f32_16x16x32_bf16 a[168:171], v[48:51], v[116:119], a[168:171]
 v_mfma_f32_16x16x32_bf16 a[12:15], v[52:55], v[96:99], a[12:15]
 ds_read_b64_tr_b16 v[48:49], v12
 v_mfma_f32_16x16x32_bf16 a[44:47], v[52:55], v[100:103], a[44:47]
 ds_read_b64_tr_b16 v[50:51], v12 offset:4096
 v_mfma_f32_16x16x32_bf16 a[76:79], v[52:55], v[104:107], a[76:79]
 v_mfma_f32_16x16x32_bf16 a[108:111], v[52:55], v[108:111], a[108:111]
 v_mfma_f32_16x16x32_bf16 a[140:143], v[52:55], v[112:115], a[140:143]
 v_mfma_f32_16x16x32_bf16 a[172:175], v[52:55], v[116:119], a[172:175]
 v_mfma_f32_16x16x32_bf16 a[16:19], v[56:59], v[96:99], a[16:19]
 ds_read_b64_tr_b16 v[52:53], v13
 v_mfma_f32_16x16x32_bf16 a[48:51], v[56:59], v[100:103], a[48:51]
 ds_read_b64_tr_b16 v[54:55], v13 offset:4096
 v_mfma_f32_16x16x32_bf16 a[80:83], v[56:59], v[104:107], a[80:83]
 v_mfma_f32_16x16x32_bf16 a[112:115], v[56:59], v[108:111], a[112:115]
 v_mfma_f32_16x16x32_bf16 a[144:147], v[56:59], v[112:115], a[144:147]
 v_mfma_f32_16x16x32_bf16 a[176:179], v[56:59], v[116:119], a[176:179]
 v_mfma_f32_16x16x32_bf16 a[20:23], v[60:63], v[96:99], a[20:23]
 ds_read_b64_tr_b16 v[56:57], v14
 v_mfma_f32_16x16x32_bf16 a[52:55], v[60:63], v[100:103], a[52:55]
 ds_read_b64_tr_b16 v[58:59], v14 offset:4096
 v_mfma_f32_16x16x32_bf16 a[84:87], v[60:63], v[104:107], a[84:87]
 v_mfma_f32_16x16x32_bf16 a[116:119], v[60:63], v[108:111], a[116:119]
 v_mfma_f32_16x16x32_bf16 a[148:151], v[60:63], v[112:115], a[148:151]
 v_mfma_f32_16x16x32_bf16 a[180:183], v[60:63], v[116:119], a[180:183]
 v_mfma_f32_16x16x32_bf16 a[24:27], v[64:67], v[96:99], a[24:27]
 ds_read_b64_tr_b16 v[60:61], v15
 v_mfma_f32_16x16x32_bf16 a[56:59], v[64:67], v[100:103], a[56:59]
 ds_read_b64_tr_b16 v[62:63], v15 offset:4096
 v_mfma_f32_16x16x32_bf16 a[88:91], v[64:67], v[104:107], a[88:91]
 v_mfma_f32_16x16x32_bf16 a[120:123], v[64:67], v[108:111], a[120:123]
 v_mfma_f32_16x16x32_bf16 a[152:155], v[64:67], v[112:115], a[152:155]
 v_mfma_f32_16x16x32_bf16 a[184:187], v[64:67], v[116:119], a[184:187]
 v_mfma_f32_16x16x32_bf16 a[28:31], v[68:71], v[96:99], a[28:31]
 ds_read_b64_tr_b16 v[64:65], v16
 v_mfma_f32_16x16x32_bf16 a[60:63], v[68:71], v[100:103], a[60:63]
 ds_read_b64_tr_b16 v[66:67], v16 offset:4096
 v_mfma_f32_16x16x32_bf16 a[92:95], v[68:71], v[104:107], a[92:95]
 v_mfma_f32_16x16x32_bf16 a[124:127], v[68:71], v[108:111], a[124:127]
 v_mfma_f32_16x16x32_bf16 a[156:159], v[68:71], v[112:115], a[156:159]
 v_mfma_f32_16x16x32_bf16 a[188:191], v[68:71], v[116:119], a[188:191]
 s_waitcnt vmcnt(6) lgkmcnt(2)
 v_mfma_f32_16x16x32_bf16 a[0:3], v[40:43], v[120:123], a[0:3]
 ds_read_b64_tr_b16 v[68:69], v17
 v_mfma_f32_16x16x32_bf16 a[32:35], v[40:43], v[124:127], a[32:35]
 ds_read_b64_tr_b16 v[70:71], v17 offset:4096
 v_mfma_f32_16x16x32_bf16 a[64:67], v[40:43], v[128:131], a[64:67]
 v_mfma_f32_16x16x32_bf16 a[96:99], v[40:43], v[132:135], a[96:99]
 v_mfma_f32_16x16x32_bf16 a[128:131], v[40:43], v[136:139], a[128:131]
 v_mfma_f32_16x16x32_bf16 a[160:163], v[40:43], v[140:143], a[160:163]
 s_waitcnt lgkmcnt(0)
 v_mfma_f32_16x16x32_bf16 a[4:7], v[44:47], v[120:123], a[4:7]
 ds_read_b64_tr_b16 v[40:41], v168
 v_mfma_f32_16x16x32_bf16 a[36:39], v[44:47], v[124:127], a[36:39]
 ds_read_b64_tr_b16 v[42:43], v168 offset:4096
 v_mfma_f32_16x16x32_bf16 a[68:71], v[44:47], v[128:131], a[68:71]
 v_mfma_f32_16x16x32_bf16 a[100:103], v[44:47], v[132:135], a[100:103]
 v_mfma_f32_16x16x32_bf16 a[132:135], v[44:47], v[136:139], a[132:135]
 v_mfma_f32_16x16x32_bf16 a[164:167], v[44:47], v[140:143], a[164:167]
 v_mfma_f32_16x16x32_bf16 a[8:11], v[48:51], v[120:123], a[8:11]
 ds_read_b64_tr_b16 v[44:45], v169
 v_mfma_f32_16x16x32_bf16 a[40:43], v[48:51], v[124:127], a[40:43]
 ds_read_b64_tr_b16 v[46:47], v169 offset:4096
 v_mfma_f32_16x16x32_bf16 a[72:75], v[48:51], v[128:131], a[72:75]
 v_mfma_f32_16x16x32_bf16 a[104:107], v[48:51], v[132:135], a[104:107]
 v_mfma_f32_16x16x32_bf16 a[136:139], v[48:51], v[136:139], a[136:139]
 v_mfma_f32_16x16x32_bf16 a[168:171], v[48:51], v[140:143], a[168:171]
 v_mfma_f32_16x16x32_bf16 a[12:15], v[52:55], v[120:123], a[12:15]
 ds_read_b64_tr_b16 v[48:49], v170
 v_mfma_f32_16x16x32_bf16 a[44:47], v[52:55], v[124:127], a[44:47]
 ds_read_b64_tr_b16 v[50:51], v170 offset:4096
 v_mfma_f32_16x16x32_bf16 a[76:79], v[52:55], v[128:131], a[76:79]
 v_mfma_f32_16x16x32_bf16 a[108:111], v[52:55], v[132:135], a[108:111]
 v_mfma_f32_16x16x32_bf16 a[140:143], v[52:55], v[136:139], a[140:143]
 v_mfma_f32_16x16x32_bf16 a[172:175], v[52:55], v[140:143], a[172:175]
 v_mfma_f32_16x16x32_bf16 a[16:19], v[56:59], v[120:123], a[16:19]
 ds_read_b64_tr_b16 v[52:53], v171
 v_mfma_f32_16x16x32_bf16 a[48:51], v[56:59], v[124:127], a[48:51]
 ds_read_b64_tr_b16 v[54:55], v171 offset:4096
 v_mfma_f32_16x16x32_bf16 a[80:83], v[56:59], v[128:131], a[80:83]
 v_mfma_f32_16x16x32_bf16 a[112:115], v[56:59], v[132:135], a[112:115]
 v_mfma_f32_16x16x32_bf16 a[144:147], v[56:59], v[136:139], a[144:147]
 v_mfma_f32_16x16x32_bf16 a[176:179], v[56:59], v[140:143], a[176:179]
 v_mfma_f32_16x16x32_bf16 a[20:23], v[60:63], v[120:123], a[20:23]
 ds_read_b64_tr_b16 v[56:57], v172
 v_mfma_f32_16x16x32_bf16 a[52:55], v[60:63], v[124:127], a[52:55]
 ds_read_b64_tr_b16 v[58:59], v172 offset:4096
 v_mfma_f32_16x16x32_bf16 a[84:87], v[60:63], v[128:131], a[84:87]
 v_mfma_f32_16x16x32_bf16 a[116:119], v[60:63], v[132:135], a[116:119]
 v_mfma_f32_16x16x32_bf16 a[148:151], v[60:63], v[136:139], a[148:151]
 v_mfma_f32_16x16x32_bf16 a[180:183], v[60:63], v[140:143], a[180:183]
 v_mfma_f32_16x16x32_bf16 a[24:27], v[64:67], v[120:123], a[24:27]
 ds_read_b64_tr_b16 v[60:61], v173
 v_mfma_f32_16x16x32_bf16 a[56:59], v[64:67], v[124:127], a[56:59]
 ds_read_b64_tr_b16 v[62:63], v173 offset:4096
 v_mfma_f32_16x16x32_bf16 a[88:91], v[64:67], v[128:131], a[88:91]
 v_mfma_f32_16x16x32_bf16 a[120:123], v[64:67], v[132:135], a[120:123]
 v_mfma_f32_16x16x32_bf16 a[152:155], v[64:67], v[136:139], a[152:155]
 v_mfma_f32_16x16x32_bf16 a[184:187], v[64:67], v[140:143], a[184:187]
 v_mfma_f32_16x16x32_bf16 a[28:31], v[68:71], v[120:123], a[28:31]
 ds_read_b64_tr_b16 v[64:65], v174
 v_mfma_f32_16x16x32_bf16 a[60:63], v[68:71], v[124:127], a[60:63]
 ds_read_b64_tr_b16 v[66:67], v174 offset:4096
 v_mfma_f32_16x16x32_bf16 a[92:95], v[68:71], v[128:131], a[92:95]
 v_mfma_f32_16x16x32_bf16 a[124:127], v[68:71], v[132:135], a[124:127]
 v_mfma_f32_16x16x32_bf16 a[156:159], v[68:71], v[136:139], a[156:159]
 v_mfma_f32_16x16x32_bf16 a[188:191], v[68:71], v[140:143], a[188:191]
 s_waitcnt vmcnt(0) lgkmcnt(2)
 v_mfma_f32_16x16x32_bf16 a[8:11], v[48:51], v[144:147], a[8:11]
 ds_read_b64_tr_b16 v[68:69], v175
 v_mfma_f32_16x16x32_bf16 a[40:43], v[48:51], v[148:151], a[40:43]
 ds_read_b64_tr_b16 v[70:71], v175 offset:4096
 v_mfma_f32_16x16x32_bf16 a[72:75], v[48:51], v[152:155], a[72:75]
 v_mfma_f32_16x16x32_bf16 a[104:107], v[48:51], v[156:159], a[104:107]
 v_mfma_f32_16x16x32_bf16 a[136:139], v[48:51], v[160:163], a[136:139]
 v_mfma_f32_16x16x32_bf16 a[168:171], v[48:51], v[164:167], a[168:171]
 s_waitcnt lgkmcnt(0)
 v_mfma_f32_16x16x32_bf16 a[12:15], v[52:55], v[144:147], a[12:15]
 v_mfma_f32_16x16x32_bf16 a[44:47], v[52:55], v[148:151], a[44:47]
 v_mfma_f32_16x16x32_bf16 a[76:79], v[52:55], v[152:155], a[76:79]
 ds_write_b128 v35, a[8:11]
 v_mfma_f32_16x16x32_bf16 a[108:111], v[52:55], v[156:159], a[108:111]
 ds_write_b128 v35, a[40:43] offset:2048
 v_mfma_f32_16x16x32_bf16 a[140:143], v[52:55], v[160:163], a[140:143]
 ds_write_b128 v35, a[72:75] offset:4096
 v_mfma_f32_16x16x32_bf16 a[172:175], v[52:55], v[164:167], a[172:175]
 ds_write_b128 v35, a[104:107] offset:6144
 v_mfma_f32_16x16x32_bf16 a[16:19], v[56:59], v[144:147], a[16:19]
 ds_write_b128 v35, a[136:139] offset:32768
 v_mfma_f32_16x16x32_bf16 a[48:51], v[56:59], v[148:151], a[48:51]
 ds_write_b128 v35, a[168:171] offset:34816
 v_mfma_f32_16x16x32_bf16 a[80:83], v[56:59], v[152:155], a[80:83]
 ds_write_b128 v35, a[12:15] offset:1024
 v_mfma_f32_16x16x32_bf16 a[112:115], v[56:59], v[156:159], a[112:115]
 ds_write_b128 v35, a[44:47] offset:3072
 v_mfma_f32_16x16x32_bf16 a[144:147], v[56:59], v[160:163], a[144:147]
 ds_write_b128 v35, a[76:79] offset:5120
 v_mfma_f32_16x16x32_bf16 a[176:179], v[56:59], v[164:167], a[176:179]
 ds_write_b128 v35, a[108:111] offset:7168
 v_mfma_f32_16x16x32_bf16 a[20:23], v[60:63], v[144:147], a[20:23]
 ds_write_b128 v35, a[140:143] offset:33792
 v_mfma_f32_16x16x32_bf16 a[52:55], v[60:63], v[148:151], a[52:55]
 ds_write_b128 v35, a[172:175] offset:35840
 v_mfma_f32_16x16x32_bf16 a[84:87], v[60:63], v[152:155], a[84:87]
 ds_write_b128 v177, a[16:19] offset:4096
 v_mfma_f32_16x16x32_bf16 a[116:119], v[60:63], v[156:159], a[116:119]
 ds_write_b128 v177, a[48:51] offset:6144
 v_mfma_f32_16x16x32_bf16 a[148:151], v[60:63], v[160:163], a[148:151]
 ds_write_b128 v177, a[80:83] offset:32768
 v_mfma_f32_16x16x32_bf16 a[180:183], v[60:63], v[164:167], a[180:183]
 ds_write_b128 v177, a[112:115] offset:34816
 v_mfma_f32_16x16x32_bf16 a[24:27], v[64:67], v[144:147], a[24:27]
 ds_write_b128 v177, a[144:147] offset:36864
 v_mfma_f32_16x16x32_bf16 a[56:59], v[64:67], v[148:151], a[56:59]
 ds_write_b128 v177, a[176:179] offset:38912
 v_mfma_f32_16x16x32_bf16 a[88:91], v[64:67], v[152:155], a[88:91]
 ds_write_b128 v177, a[20:23] offset:5120
 v_mfma_f32_16x16x32_bf16 a[120:123], v[64:67], v[156:159], a[120:123]
 ds_write_b128 v177, a[52:55] offset:7168
 v_mfma_f32_16x16x32_bf16 a[152:155], v[64:67], v[160:163], a[152:155]
 ds_write_b128 v177, a[84:87] offset:33792
 v_mfma_f32_16x16x32_bf16 a[184:187], v[64:67], v[164:167], a[184:187]
 ds_write_b128 v177, a[116:119] offset:35840
 v_mfma_f32_16x16x32_bf16 a[28:31], v[68:71], v[144:147], a[28:31]
 ds_write_b128 v177, a[148:151] offset:37888
 v_mfma_f32_16x16x32_bf16 a[60:63], v[68:71], v[148:151], a[60:63]
 ds_write_b128 v177, a[180:183] offset:39936
 v_mfma_f32_16x16x32_bf16 a[92:95], v[68:71], v[152:155], a[92:95]
 ds_write_b128 v178, a[24:27]
 v_mfma_f32_16x16x32_bf16 a[124:127], v[68:71], v[156:159], a[124:127]
 ds_write_b128 v178, a[56:59] offset:2048
 v_mfma_f32_16x16x32_bf16 a[156:159], v[68:71], v[160:163], a[156:159]
 ds_write_b128 v178, a[88:91] offset:4096
 v_mfma_f32_16x16x32_bf16 a[188:191], v[68:71], v[164:167], a[188:191]
 ds_write_b128 v178, a[120:123] offset:6144
 v_mfma_f32_16x16x32_bf16 a[0:3], v[40:43], v[144:147], a[0:3]
 ds_write_b128 v178, a[152:155] offset:32768
 v_mfma_f32_16x16x32_bf16 a[32:35], v[40:43], v[148:151], a[32:35]
 ds_write_b128 v178, a[184:187] offset:34816
 v_mfma_f32_16x16x32_bf16 a[64:67], v[40:43], v[152:155], a[64:67]
 ds_write_b128 v178, a[28:31] offset:1024
 v_mfma_f32_16x16x32_bf16 a[96:99], v[40:43], v[156:159], a[96:99]
 ds_write_b128 v178, a[60:63] offset:3072
 v_mfma_f32_16x16x32_bf16 a[128:131], v[40:43], v[160:163], a[128:131]
 ds_write_b128 v178, a[92:95] offset:5120
 v_mfma_f32_16x16x32_bf16 a[160:163], v[40:43], v[164:167], a[160:163]
 ds_write_b128 v178, a[124:127] offset:7168
 v_mfma_f32_16x16x32_bf16 a[4:7], v[44:47], v[144:147], a[4:7]
 ds_write_b128 v178, a[156:159] offset:33792
 v_mfma_f32_16x16x32_bf16 a[36:39], v[44:47], v[148:151], a[36:39]
 ds_write_b128 v178, a[188:191] offset:35840
 v_mfma_f32_16x16x32_bf16 a[68:71], v[44:47], v[152:155], a[68:71]
 v_mfma_f32_16x16x32_bf16 a[100:103], v[44:47], v[156:159], a[100:103]
 v_mfma_f32_16x16x32_bf16 a[132:135], v[44:47], v[160:163], a[132:135]
 v_mfma_f32_16x16x32_bf16 a[164:167], v[44:47], v[164:167], a[164:167]
 s_waitcnt lgkmcnt(0)
 s_barrier
 ds_read_b128 v[96:99], v32
 ds_read_b128 v[100:103], v32 offset:1024
 ds_read_b128 v[144:147], v33 offset:4096
 ds_read_b128 v[148:151], v33 offset:5120
 ds_read_b128 v[192:195], v34
 ds_read_b128 v[196:199], v34 offset:1024
 ds_read_b128 v[104:107], v32 offset:2048
 ds_read_b128 v[108:111], v32 offset:3072
 ds_read_b128 v[152:155], v33 offset:6144
 ds_read_b128 v[156:159], v33 offset:7168
 ds_read_b128 v[200:203], v34 offset:2048
 ds_read_b128 v[204:207], v34 offset:3072
 ds_read_b128 v[112:115], v32 offset:4096
 ds_read_b128 v[116:119], v32 offset:5120
 ds_read_b128 v[160:163], v33 offset:32768
 ds_read_b128 v[164:167], v33 offset:33792
 ds_read_b128 v[208:211], v34 offset:4096
 ds_read_b128 v[212:215], v34 offset:5120
 ds_read_b128 v[120:123], v32 offset:6144
 ds_read_b128 v[124:127], v32 offset:7168
 ds_read_b128 v[168:171], v33 offset:34816
 ds_read_b128 v[172:175], v33 offset:35840
 ds_read_b128 v[216:219], v34 offset:6144
 ds_read_b128 v[220:223], v34 offset:7168
 ds_read_b128 v[128:131], v32 offset:32768
 ds_read_b128 v[132:135], v32 offset:33792
 ds_read_b128 v[176:179], v33 offset:36864
 ds_read_b128 v[180:183], v33 offset:37888
 ds_read_b128 v[224:227], v34 offset:32768
 ds_read_b128 v[228:231], v34 offset:33792
 ds_read_b128 v[136:139], v32 offset:34816
 ds_read_b128 v[140:143], v32 offset:35840
 ds_read_b128 v[184:187], v33 offset:38912
 ds_read_b128 v[188:191], v33 offset:39936
 ds_read_b128 v[232:235], v34 offset:34816
 ds_read_b128 v[236:239], v34 offset:35840
 v_accvgpr_read_b32 v40, a0
 v_accvgpr_read_b32 v41, a1
 v_accvgpr_read_b32 v42, a2
 v_accvgpr_read_b32 v43, a3
 v_accvgpr_read_b32 v44, a4
 v_accvgpr_read_b32 v45, a5
 v_accvgpr_read_b32 v46, a6
 v_accvgpr_read_b32 v47, a7
 v_accvgpr_read_b32 v48, a32
 v_accvgpr_read_b32 v49, a33
 v_accvgpr_read_b32 v50, a34
 v_accvgpr_read_b32 v51, a35
 v_accvgpr_read_b32 v52, a36
 v_accvgpr_read_b32 v53, a37
 v_accvgpr_read_b32 v54, a38
 v_accvgpr_read_b32 v55, a39
 v_accvgpr_read_b32 v56, a64
 v_accvgpr_read_b32 v57, a65
 v_accvgpr_read_b32 v58, a66
 v_accvgpr_read_b32 v59, a67
 v_accvgpr_read_b32 v60, a68
 v_accvgpr_read_b32 v61, a69
 v_accvgpr_read_b32 v62, a70
 v_accvgpr_read_b32 v63, a71
 v_accvgpr_read_b32 v64, a96
 v_accvgpr_read_b32 v65, a97
 v_accvgpr_read_b32 v66, a98
 v_accvgpr_read_b32 v67, a99
 v_accvgpr_read_b32 v68, a100
 v_accvgpr_read_b32 v69, a101
 v_accvgpr_read_b32 v70, a102
 v_accvgpr_read_b32 v71, a103
 v_accvgpr_read_b32 v72, a128
 v_accvgpr_read_b32 v73, a129
 v_accvgpr_read_b32 v74, a130
 v_accvgpr_read_b32 v75, a131
 v_accvgpr_read_b32 v76, a132
 v_accvgpr_read_b32 v77, a133
 v_accvgpr_read_b32 v78, a134
 v_accvgpr_read_b32 v79, a135
 v_accvgpr_read_b32 v80, a160
 v_accvgpr_read_b32 v81, a161
 v_accvgpr_read_b32 v82, a162
 v_accvgpr_read_b32 v83, a163
 v_accvgpr_read_b32 v84, a164
 v_accvgpr_read_b32 v85, a165
 v_accvgpr_read_b32 v86, a166
 v_accvgpr_read_b32 v87, a167
 s_waitcnt lgkmcnt(15)
 v_pk_add_f32 v[40:41], v[40:41], v[96:97]
 v_pk_add_f32 v[42:43], v[42:43], v[98:99]
 v_pk_add_f32 v[44:45], v[44:45], v[100:101]
 v_pk_add_f32 v[46:47], v[46:47], v[102:103]
 v_pk_add_f32 v[40:41], v[40:41], v[144:145]
 v_pk_add_f32 v[42:43], v[42:43], v[146:147]
 v_pk_add_f32 v[44:45], v[44:45], v[148:149]
 v_pk_add_f32 v[46:47], v[46:47], v[150:151]
 v_pk_add_f32 v[40:41], v[40:41], v[192:193]
 v_pk_add_f32 v[42:43], v[42:43], v[194:195]
 v_pk_add_f32 v[44:45], v[44:45], v[196:197]
 v_pk_add_f32 v[46:47], v[46:47], v[198:199]
 v_cvt_pk_bf16_f32 v10, v40, v41
 v_cvt_pk_bf16_f32 v11, v42, v43
 v_cvt_pk_bf16_f32 v12, v44, v45
 v_cvt_pk_bf16_f32 v13, v46, v47
 s_mov_b32 s48, 0
 s_nop 0
 v_permlane16_swap_b32 v10, v12
 v_permlane16_swap_b32 v11, v13
 buffer_store_dwordx4 v[10:13], v36, s[28:31], s48 offen sc1 nt
 v_pk_add_f32 v[48:49], v[48:49], v[104:105]
 v_pk_add_f32 v[50:51], v[50:51], v[106:107]
 v_pk_add_f32 v[52:53], v[52:53], v[108:109]
 v_pk_add_f32 v[54:55], v[54:55], v[110:111]
 v_pk_add_f32 v[48:49], v[48:49], v[152:153]
 v_pk_add_f32 v[50:51], v[50:51], v[154:155]
 v_pk_add_f32 v[52:53], v[52:53], v[156:157]
 v_pk_add_f32 v[54:55], v[54:55], v[158:159]
 v_pk_add_f32 v[48:49], v[48:49], v[200:201]
 v_pk_add_f32 v[50:51], v[50:51], v[202:203]
 v_pk_add_f32 v[52:53], v[52:53], v[204:205]
 v_pk_add_f32 v[54:55], v[54:55], v[206:207]
 v_cvt_pk_bf16_f32 v14, v48, v49
 v_cvt_pk_bf16_f32 v15, v50, v51
 v_cvt_pk_bf16_f32 v16, v52, v53
 v_cvt_pk_bf16_f32 v17, v54, v55
 s_mov_b32 s48, 32768
 s_nop 0
 v_permlane16_swap_b32 v14, v16
 v_permlane16_swap_b32 v15, v17
 buffer_store_dwordx4 v[14:17], v36, s[28:31], s48 offen sc1 nt
 v_pk_add_f32 v[56:57], v[56:57], v[112:113]
 v_pk_add_f32 v[58:59], v[58:59], v[114:115]
 v_pk_add_f32 v[60:61], v[60:61], v[116:117]
 v_pk_add_f32 v[62:63], v[62:63], v[118:119]
 v_pk_add_f32 v[56:57], v[56:57], v[160:161]
 v_pk_add_f32 v[58:59], v[58:59], v[162:163]
 v_pk_add_f32 v[60:61], v[60:61], v[164:165]
 v_pk_add_f32 v[62:63], v[62:63], v[166:167]
 v_pk_add_f32 v[56:57], v[56:57], v[208:209]
 v_pk_add_f32 v[58:59], v[58:59], v[210:211]
 v_pk_add_f32 v[60:61], v[60:61], v[212:213]
 v_pk_add_f32 v[62:63], v[62:63], v[214:215]
 v_cvt_pk_bf16_f32 v18, v56, v57
 v_cvt_pk_bf16_f32 v19, v58, v59
 v_cvt_pk_bf16_f32 v20, v60, v61
 v_cvt_pk_bf16_f32 v21, v62, v63
 s_mov_b32 s48, 65536
 s_nop 0
 v_permlane16_swap_b32 v18, v20
 v_permlane16_swap_b32 v19, v21
 buffer_store_dwordx4 v[18:21], v36, s[28:31], s48 offen sc1 nt
 v_pk_add_f32 v[64:65], v[64:65], v[120:121]
 v_pk_add_f32 v[66:67], v[66:67], v[122:123]
 v_pk_add_f32 v[68:69], v[68:69], v[124:125]
 v_pk_add_f32 v[70:71], v[70:71], v[126:127]
 v_pk_add_f32 v[64:65], v[64:65], v[168:169]
 v_pk_add_f32 v[66:67], v[66:67], v[170:171]
 s_waitcnt lgkmcnt(14)
 v_pk_add_f32 v[68:69], v[68:69], v[172:173]
 v_pk_add_f32 v[70:71], v[70:71], v[174:175]
 s_waitcnt lgkmcnt(13)
 v_pk_add_f32 v[64:65], v[64:65], v[216:217]
 v_pk_add_f32 v[66:67], v[66:67], v[218:219]
 s_waitcnt lgkmcnt(12)
 v_pk_add_f32 v[68:69], v[68:69], v[220:221]
 v_pk_add_f32 v[70:71], v[70:71], v[222:223]
 v_cvt_pk_bf16_f32 v22, v64, v65
 v_cvt_pk_bf16_f32 v23, v66, v67
 v_cvt_pk_bf16_f32 v24, v68, v69
 v_cvt_pk_bf16_f32 v25, v70, v71
 s_mov_b32 s48, 98304
 s_nop 0
 v_permlane16_swap_b32 v22, v24
 v_permlane16_swap_b32 v23, v25
 buffer_store_dwordx4 v[22:25], v36, s[28:31], s48 offen sc1 nt
 s_waitcnt lgkmcnt(11)
 v_pk_add_f32 v[72:73], v[72:73], v[128:129]
 v_pk_add_f32 v[74:75], v[74:75], v[130:131]
 s_waitcnt lgkmcnt(10)
 v_pk_add_f32 v[76:77], v[76:77], v[132:133]
 v_pk_add_f32 v[78:79], v[78:79], v[134:135]
 s_waitcnt lgkmcnt(9)
 v_pk_add_f32 v[72:73], v[72:73], v[176:177]
 v_pk_add_f32 v[74:75], v[74:75], v[178:179]
 s_waitcnt lgkmcnt(8)
 v_pk_add_f32 v[76:77], v[76:77], v[180:181]
 v_pk_add_f32 v[78:79], v[78:79], v[182:183]
 s_waitcnt lgkmcnt(7)
 v_pk_add_f32 v[72:73], v[72:73], v[224:225]
 v_pk_add_f32 v[74:75], v[74:75], v[226:227]
 s_waitcnt lgkmcnt(6)
 v_pk_add_f32 v[76:77], v[76:77], v[228:229]
 v_pk_add_f32 v[78:79], v[78:79], v[230:231]
 v_cvt_pk_bf16_f32 v26, v72, v73
 v_cvt_pk_bf16_f32 v27, v74, v75
 v_cvt_pk_bf16_f32 v28, v76, v77
 v_cvt_pk_bf16_f32 v29, v78, v79
 s_mov_b32 s48, 131072
 s_nop 0
 v_permlane16_swap_b32 v26, v28
 v_permlane16_swap_b32 v27, v29
 buffer_store_dwordx4 v[26:29], v36, s[28:31], s48 offen sc1 nt
 s_waitcnt lgkmcnt(5)
 v_pk_add_f32 v[80:81], v[80:81], v[136:137]
 v_pk_add_f32 v[82:83], v[82:83], v[138:139]
 s_waitcnt lgkmcnt(4)
 v_pk_add_f32 v[84:85], v[84:85], v[140:141]
 v_pk_add_f32 v[86:87], v[86:87], v[142:143]
 s_waitcnt lgkmcnt(3)
 v_pk_add_f32 v[80:81], v[80:81], v[184:185]
 v_pk_add_f32 v[82:83], v[82:83], v[186:187]
 s_waitcnt lgkmcnt(2)
 v_pk_add_f32 v[84:85], v[84:85], v[188:189]
 v_pk_add_f32 v[86:87], v[86:87], v[190:191]
 s_waitcnt lgkmcnt(1)
 v_pk_add_f32 v[80:81], v[80:81], v[232:233]
 v_pk_add_f32 v[82:83], v[82:83], v[234:235]
 s_waitcnt lgkmcnt(0)
 v_pk_add_f32 v[84:85], v[84:85], v[236:237]
 v_pk_add_f32 v[86:87], v[86:87], v[238:239]
 v_cvt_pk_bf16_f32 v30, v80, v81
 v_cvt_pk_bf16_f32 v31, v82, v83
 v_cvt_pk_bf16_f32 v32, v84, v85
 v_cvt_pk_bf16_f32 v33, v86, v87
 s_mov_b32 s48, 163840
 s_nop 0
 v_permlane16_swap_b32 v30, v32
 v_permlane16_swap_b32 v31, v33
 buffer_store_dwordx4 v[30:33], v36, s[28:31], s48 offen sc1 nt
L1_end:
 s_endpgm
L2_slow0:
 s_waitcnt vmcnt(0)
 s_barrier
 s_cmp_lg_u32 s36, 0
 s_cbranch_scc1 L1_nosigb
 s_mov_b64 exec, 0xffff
 buffer_store_dword v38, v179, s[84:87], s73 offen sc1
 s_mov_b64 exec, -1
L1_nosigb:
 s_mov_b32 s93, 1
 s_branch L2_slow0x
L2_slow0w:
 s_sleep 16
L2_slow0x:
 buffer_load_dword v37, v39, s[84:87], s92 offen sc1
 s_waitcnt vmcnt(0)
 s_add_u32 s75, s75, 1
 s_cmp_ge_u32 s75, 0x40000
 s_cbranch_scc1 L2_back0
 v_cmp_ne_u32 vcc, v37, v38
 s_and_b32 s48, vcc_lo, s50
 s_cbranch_scc1 L2_slow0w
 s_branch L2_back0
L2_slow1:
 s_sleep 16
 buffer_load_dword v37, v39, s[84:87], s92 offen sc1
 s_waitcnt vmcnt(0)
 s_add_u32 s75, s75, 1
 s_cmp_ge_u32 s75, 0x40000
 s_cbranch_scc1 L2_back1
 v_cmp_ne_u32 vcc, v37, v38
 s_and_b32 s48, vcc_lo, s50
 s_cbranch_scc1 L2_slow1
 s_branch L2_back1
L1_tagslow:
 s_mov_b32 s75, 0
L1_tagloop:
 s_sleep 8
 buffer_load_dword v63, v0, s[88:91], 0 offen sc1
 s_waitcnt vmcnt(0)
 v_readfirstlane_b32 s93, v63
 s_add_u32 s75, s75, 1
 s_cmp_lg_u32 s93, 0
 s_cbranch_scc1 L1_tagok
 s_cmp_lt_u32 s75, 0x40000
 s_cbranch_scc1 L1_tagloop
 s_branch L1_tagok
L1_fallback:
 s_waitcnt vmcnt(0) lgkmcnt(0)
 s_barrier
 s_mov_b32 s59, 1
 s_mov_b32 s30, 262144
 v_mov_b32 v52, 0xff800000
 v_mov_b32 v53, 0xff800000
 v_mov_b32 v54, 0xff800000
 v_mov_b32 v55, 0xff800000
 v_mov_b32 v56, 0xff800000
 v_mov_b32 v57, 0xff800000
 s_mov_b32 s50, 0
 s_mov_b32 s51, 4096
 s_mov_b32 s45, 0
L1_fb_loop:
 s_add_u32 m0, s52, 0
 s_nop 0
 buffer_load_dwordx4 v48, s[28:31], s50 offen nt lds
 buffer_load_dwordx4 v49, s[28:31], s50 offen offset:1024 nt lds
 buffer_load_dwordx4 v50, s[28:31], s50 offen offset:2048 nt lds
 buffer_load_dwordx4 v51, s[28:31], s50 offen offset:3072 nt lds
 s_add_u32 m0, s52, 4096
 s_nop 0
 buffer_load_dwordx4 v48, s[28:31], s51 offen nt lds
 buffer_load_dwordx4 v49, s[28:31], s51 offen offset:1024 nt lds
 buffer_load_dwordx4 v50, s[28:31], s51 offen offset:2048 nt lds
 buffer_load_dwordx4 v51, s[28:31], s51 offen offset:3072 nt lds
 s_add_u32 s50, s50, 8192
 s_and_b32 s50, s50, 262143
 s_add_u32 s51, s50, 4096
 s_waitcnt vmcnt(0)
 s_barrier
 ds_read_b64 a[192:193], v32
 ds_read_b64 a[194:195], v33
 ds_read_b64 a[196:197], v32 offset:4096
 ds_read_b64 a[198:199], v33 offset:4096
 ds_read_b64 a[200:201], v34
 ds_read_b64 a[202:203], v35
 ds_read_b64 a[204:205], v34 offset:4096
 ds_read_b64 a[206:207], v35 offset:4096
 ds_read_b64 a[208:209], v36
 ds_read_b64 a[210:211], v37
 ds_read_b64 a[212:213], v36 offset:4096
 ds_read_b64 a[214:215], v37 offset:4096
 ds_read_b64 a[216:217], v38
 ds_read_b64 a[218:219], v39
 ds_read_b64 a[220:221], v38 offset:4096
 ds_read_b64 a[222:223], v39 offset:4096
 s_waitcnt lgkmcnt(14)
 v_mfma_f32_16x16x32_bf16 v[160:163], a[192:195], v[64:67], 0
 s_waitcnt lgkmcnt(12)
 v_mfma_f32_16x16x32_bf16 v[184:187], a[196:199], v[64:67], 0
 s_waitcnt lgkmcnt(10)
 v_mfma_f32_16x16x32_bf16 v[160:163], a[200:203], v[72:75], v[160:163]
 s_waitcnt lgkmcnt(8)
 v_mfma_f32_16x16x32_bf16 v[184:187], a[204:207], v[72:75], v[184:187]
 s_waitcnt lgkmcnt(6)
 v_mfma_f32_16x16x32_bf16 v[160:163], a[208:211], v[80:83], v[160:163]
 s_waitcnt lgkmcnt(4)
 v_mfma_f32_16x16x32_bf16 v[184:187], a[212:215], v[80:83], v[184:187]
 s_waitcnt lgkmcnt(2)
 v_mfma_f32_16x16x32_bf16 v[160:163], a[216:219], v[88:91], v[160:163]
 s_waitcnt lgkmcnt(0)
 v_mfma_f32_16x16x32_bf16 v[184:187], a[220:223], v[88:91], v[184:187]
 v_mfma_f32_16x16x32_bf16 v[164:167], a[192:195], v[68:71], 0
 v_mfma_f32_16x16x32_bf16 v[188:191], a[196:199], v[68:71], 0
 v_mfma_f32_16x16x32_bf16 v[164:167], a[200:203], v[76:79], v[164:167]
 v_mfma_f32_16x16x32_bf16 v[188:191], a[204:207], v[76:79], v[188:191]
 v_mfma_f32_16x16x32_bf16 v[164:167], a[208:211], v[84:87], v[164:167]
 v_mfma_f32_16x16x32_bf16 v[188:191], a[212:215], v[84:87], v[188:191]
 v_mfma_f32_16x16x32_bf16 v[164:167], a[216:219], v[92:95], v[164:167]
 v_mfma_f32_16x16x32_bf16 v[188:191], a[220:223], v[92:95], v[188:191]
 v_mfma_f32_16x16x32_bf16 v[168:171], a[192:195], v[96:99], 0
 v_mfma_f32_16x16x32_bf16 v[192:195], a[196:199], v[96:99], 0
 v_mfma_f32_16x16x32_bf16 v[168:171], a[200:203], v[104:107], v[168:171]
 v_mfma_f32_16x16x32_bf16 v[192:195], a[204:207], v[104:107], v[192:195]
 v_mfma_f32_16x16x32_bf16 v[168:171], a[208:211], v[112:115], v[168:171]
 v_mfma_f32_16x16x32_bf16 v[192:195], a[212:215], v[112:115], v[192:195]
 v_mfma_f32_16x16x32_bf16 v[168:171], a[216:219], v[120:123], v[168:171]
 v_mfma_f32_16x16x32_bf16 v[192:195], a[220:223], v[120:123], v[192:195]
 v_mfma_f32_16x16x32_bf16 v[172:175], a[192:195], v[100:103], 0
 v_mfma_f32_16x16x32_bf16 v[196:199], a[196:199], v[100:103], 0
 v_mfma_f32_16x16x32_bf16 v[172:175], a[200:203], v[108:111], v[172:175]
 v_mfma_f32_16x16x32_bf16 v[196:199], a[204:207], v[108:111], v[196:199]
 v_mfma_f32_16x16x32_bf16 v[172:175], a[208:211], v[116:119], v[172:175]
 v_mfma_f32_16x16x32_bf16 v[196:199], a[212:215], v[116:119], v[196:199]
 v_mfma_f32_16x16x32_bf16 v[172:175], a[216:219], v[124:127], v[172:175]
 v_mfma_f32_16x16x32_bf16 v[196:199], a[220:223], v[124:127], v[196:199]
 v_mfma_f32_16x16x32_bf16 v[176:179], a[192:195], v[128:131], 0
 v_mfma_f32_16x16x32_bf16 v[200:203], a[196:199], v[128:131], 0
 v_mfma_f32_16x16x32_bf16 v[176:179], a[200:203], v[136:139], v[176:179]
 v_mfma_f32_16x16x32_bf16 v[200:203], a[204:207], v[136:139], v[200:203]
 v_mfma_f32_16x16x32_bf16 v[176:179], a[208:211], v[144:147], v[176:179]
 v_mfma_f32_16x16x32_bf16 v[200:203], a[212:215], v[144:147], v[200:203]
 v_mfma_f32_16x16x32_bf16 v[176:179], a[216:219], v[152:155], v[176:179]
 v_mfma_f32_16x16x32_bf16 v[200:203], a[220:223], v[152:155], v[200:203]
 v_mfma_f32_16x16x32_bf16 v[180:183], a[192:195], v[132:135], 0
 v_mfma_f32_16x16x32_bf16 v[204:207], a[196:199], v[132:135], 0
 v_mfma_f32_16x16x32_bf16 v[180:183], a[200:203], v[140:143], v[180:183]
 v_mfma_f32_16x16x32_bf16 v[204:207], a[204:207], v[140:143], v[204:207]
 v_mfma_f32_16x16x32_bf16 v[180:183], a[208:211], v[148:151], v[180:183]
 v_mfma_f32_16x16x32_bf16 v[204:207], a[212:215], v[148:151], v[204:207]
 v_mfma_f32_16x16x32_bf16 v[180:183], a[216:219], v[156:159], v[180:183]
 v_mfma_f32_16x16x32_bf16 v[204:207], a[220:223], v[156:159], v[204:207]
 s_nop 15
 v_max3_f32 v2, v160, v161, v162
 v_max3_f32 v2, v2, v163, v184
 v_max3_f32 v2, v2, v185, v186
 v_max_f32 v2, v2, v187
 v_mov_b32 v3, v2
 s_nop 1
 v_permlane16_swap_b32 v2, v3
 s_nop 1
 v_max_f32 v2, v2, v3
 v_mov_b32 v3, v2
 s_nop 1
 v_permlane32_swap_b32 v2, v3
 s_nop 1
 v_max_f32 v2, v2, v3
 v_max_f32 v52, v52, v2
 v_max3_f32 v2, v164, v165, v166
 v_max3_f32 v2, v2, v167, v188
 v_max3_f32 v2, v2, v189, v190
 v_max_f32 v2, v2, v191
 v_mov_b32 v3, v2
 s_nop 1
 v_permlane16_swap_b32 v2, v3
 s_nop 1
 v_max_f32 v2, v2, v3
 v_mov_b32 v3, v2
 s_nop 1
 v_permlane32_swap_b32 v2, v3
 s_nop 1
 v_max_f32 v2, v2, v3
 v_max_f32 v53, v53, v2
 v_max3_f32 v2, v168, v169, v170
 v_max3_f32 v2, v2, v171, v192
 v_max3_f32 v2, v2, v193, v194
 v_max_f32 v2, v2, v195
 v_mov_b32 v3, v2
 s_nop 1
 v_permlane16_swap_b32 v2, v3
 s_nop 1
 v_max_f32 v2, v2, v3
 v_mov_b32 v3, v2
 s_nop 1
 v_permlane32_swap_b32 v2, v3
 s_nop 1
 v_max_f32 v2, v2, v3
 v_max_f32 v54, v54, v2
 v_max3_f32 v2, v172, v173, v174
 v_max3_f32 v2, v2, v175, v196
 v_max3_f32 v2, v2, v197, v198
 v_max_f32 v2, v2, v199
 v_mov_b32 v3, v2
 s_nop 1
 v_permlane16_swap_b32 v2, v3
 s_nop 1
 v_max_f32 v2, v2, v3
 v_mov_b32 v3, v2
 s_nop 1
 v_permlane32_swap_b32 v2, v3
 s_nop 1
 v_max_f32 v2, v2, v3
 v_max_f32 v55, v55, v2
 v_max3_f32 v2, v176, v177, v178
 v_max3_f32 v2, v2, v179, v200
 v_max3_f32 v2, v2, v201, v202
 v_max_f32 v2, v2, v203
 v_mov_b32 v3, v2
 s_nop 1
 v_permlane16_swap_b32 v2, v3
 s_nop 1
 v_max_f32 v2, v2, v3
 v_mov_b32 v3, v2
 s_nop 1
 v_permlane32_swap_b32 v2, v3
 s_nop 1
 v_max_f32 v2, v2, v3
 v_max_f32 v56, v56, v2
 v_max3_f32 v2, v180, v181, v182
 v_max3_f32 v2, v2, v183, v204
 v_max3_f32 v2, v2, v205, v206
 v_max_f32 v2, v2, v207
 v_mov_b32 v3, v2
 s_nop 1
 v_permlane16_swap_b32 v2, v3
 s_nop 1
 v_max_f32 v2, v2, v3
 v_mov_b32 v3, v2
 s_nop 1
 v_permlane32_swap_b32 v2, v3
 s_nop 1
 v_max_f32 v2, v2, v3
 v_max_f32 v57, v57, v2
 s_barrier
 s_add_u32 s45, s45, 1
 s_cmp_lt_u32 s45, 32
 s_cbranch_scc1 L1_fb_loop
 s_mov_b32 s50, s58
 s_add_u32 s51, s50, 4096
 s_add_u32 s42, s52, 0
 s_add_u32 m0, s42, 0
 s_nop 0
 buffer_load_dwordx4 v48, s[28:31], s50 offen nt lds
 buffer_load_dwordx4 v49, s[28:31], s50 offen offset:1024 nt lds
 buffer_load_dwordx4 v50, s[28:31], s50 offen offset:2048 nt lds
 buffer_load_dwordx4 v51, s[28:31], s50 offen offset:3072 nt lds
 s_add_u32 m0, s42, 4096
 s_nop 0
 buffer_load_dwordx4 v48, s[28:31], s51 offen nt lds
 buffer_load_dwordx4 v49, s[28:31], s51 offen offset:1024 nt lds
 buffer_load_dwordx4 v50, s[28:31], s51 offen offset:2048 nt lds
 buffer_load_dwordx4 v51, s[28:31], s51 offen offset:3072 nt lds
 s_add_u32 s50, s50, 8192
 s_and_b32 s50, s50, 262143
 s_add_u32 s51, s50, 4096
 s_add_u32 s42, s52, 16384
 s_add_u32 m0, s42, 0
 s_nop 0
 buffer_load_dwordx4 v48, s[28:31], s50 offen nt lds
 buffer_load_dwordx4 v49, s[28:31], s50 offen offset:1024 nt lds
 buffer_load_dwordx4 v50, s[28:31], s50 offen offset:2048 nt lds
 buffer_load_dwordx4 v51, s[28:31], s50 offen offset:3072 nt lds
 s_add_u32 m0, s42, 4096
 s_nop 0
 buffer_load_dwordx4 v48, s[28:31], s51 offen nt lds
 buffer_load_dwordx4 v49, s[28:31], s51 offen offset:1024 nt lds
 buffer_load_dwordx4 v50, s[28:31], s51 offen offset:2048 nt lds
 buffer_load_dwordx4 v51, s[28:31], s51 offen offset:3072 nt lds
 s_add_u32 s50, s50, 8192
 s_and_b32 s50, s50, 262143
 s_add_u32 s51, s50, 4096
 s_add_u32 s42, s52, 32768
 s_add_u32 m0, s42, 0
 s_nop 0
 buffer_load_dwordx4 v48, s[28:31], s50 offen nt lds
 buffer_load_dwordx4 v49, s[28:31], s50 offen offset:1024 nt lds
 buffer_load_dwordx4 v50, s[28:31], s50 offen offset:2048 nt lds
 buffer_load_dwordx4 v51, s[28:31], s50 offen offset:3072 nt lds
 s_add_u32 m0, s42, 4096
 s_nop 0
 buffer_load_dwordx4 v48, s[28:31], s51 offen nt lds
 buffer_load_dwordx4 v49, s[28:31], s51 offen offset:1024 nt lds
 buffer_load_dwordx4 v50, s[28:31], s51 offen offset:2048 nt lds
 buffer_load_dwordx4 v51, s[28:31], s51 offen offset:3072 nt lds
 s_add_u32 s50, s50, 8192
 s_and_b32 s50, s50, 262143
 s_add_u32 s51, s50, 4096
 s_add_u32 s42, s52, 49152
 s_add_u32 m0, s42, 0
 s_nop 0
 buffer_load_dwordx4 v48, s[28:31], s50 offen nt lds
 buffer_load_dwordx4 v49, s[28:31], s50 offen offset:1024 nt lds
 buffer_load_dwordx4 v50, s[28:31], s50 offen offset:2048 nt lds
 buffer_load_dwordx4 v51, s[28:31], s50 offen offset:3072 nt lds
 s_add_u32 m0, s42, 4096
 s_nop 0
 buffer_load_dwordx4 v48, s[28:31], s51 offen nt lds
 buffer_load_dwordx4 v49, s[28:31], s51 offen offset:1024 nt lds
 buffer_load_dwordx4 v50, s[28:31], s51 offen offset:2048 nt lds
 buffer_load_dwordx4 v51, s[28:31], s51 offen offset:3072 nt lds
 s_add_u32 s50, s50, 8192
 s_and_b32 s50, s50, 262143
 s_add_u32 s51, s50, 4096
 s_add_u32 m0, s72, 0
 s_nop 0
 buffer_load_dwordx4 v48, s[28:31], s50 offen nt lds
 buffer_load_dwordx4 v49, s[28:31], s50 offen offset:1024 nt lds
 buffer_load_dwordx4 v50, s[28:31], s50 offen offset:2048 nt lds
 buffer_load_dwordx4 v51, s[28:31], s50 offen offset:3072 nt lds
 s_add_u32 m0, s72, 4096
 s_nop 0
 buffer_load_dwordx4 v48, s[28:31], s51 offen nt lds
 buffer_load_dwordx4 v49, s[28:31], s51 offen offset:1024 nt lds
 buffer_load_dwordx4 v50, s[28:31], s51 offen offset:2048 nt lds
 buffer_load_dwordx4 v51, s[28:31], s51 offen offset:3072 nt lds
 s_add_u32 s50, s50, 8192
 s_and_b32 s50, s50, 262143
 s_add_u32 s51, s50, 4096
 s_add_u32 s39, s58, 40960
 s_and_b32 s39, s39, 262143
 buffer_load_dwordx4 v[208:211], v48, s[28:31], s39 offen nt
 buffer_load_dwordx4 v[212:215], v49, s[28:31], s39 offen offset:1024 nt
 buffer_load_dwordx4 v[216:219], v50, s[28:31], s39 offen offset:2048 nt
 buffer_load_dwordx4 v[220:223], v51, s[28:31], s39 offen offset:3072 nt
 s_add_u32 s39, s58, 45056
 s_and_b32 s39, s39, 262143
 buffer_load_dwordx4 v[224:227], v48, s[28:31], s39 offen nt
 buffer_load_dwordx4 v[228:231], v49, s[28:31], s39 offen offset:1024 nt
 buffer_load_dwordx4 v[232:235], v50, s[28:31], s39 offen offset:2048 nt
 buffer_load_dwordx4 v[236:239], v51, s[28:31], s39 offen offset:3072 nt
 s_mov_b32 s94, s78
 v_sub_f32 v160, 0, v52
 v_sub_f32 v161, 0, v52
 v_sub_f32 v162, 0, v52
 v_sub_f32 v163, 0, v52
 v_mov_b32 v52, 0
 v_sub_f32 v164, 0, v53
 v_sub_f32 v165, 0, v53
 v_sub_f32 v166, 0, v53
 v_sub_f32 v167, 0, v53
 v_mov_b32 v53, 0
 v_sub_f32 v168, 0, v54
 v_sub_f32 v169, 0, v54
 v_sub_f32 v170, 0, v54
 v_sub_f32 v171, 0, v54
 v_mov_b32 v54, 0
 v_sub_f32 v172, 0, v55
 v_sub_f32 v173, 0, v55
 v_sub_f32 v174, 0, v55
 v_sub_f32 v175, 0, v55
 v_mov_b32 v55, 0
 v_sub_f32 v176, 0, v56
 v_sub_f32 v177, 0, v56
 v_sub_f32 v178, 0, v56
 v_sub_f32 v179, 0, v56
 v_mov_b32 v56, 0
 v_sub_f32 v180, 0, v57
 v_sub_f32 v181, 0, v57
 v_sub_f32 v182, 0, v57
 v_sub_f32 v183, 0, v57
 v_mov_b32 v57, 0
 v_mov_b32 v184, 0
 v_mov_b32 v185, 0
 v_mov_b32 v186, 0
 v_mov_b32 v187, 0
 v_mov_b32 v188, 0
 v_mov_b32 v189, 0
 v_mov_b32 v190, 0
 v_mov_b32 v191, 0
 v_mov_b32 v192, 0
 v_mov_b32 v193, 0
 v_mov_b32 v194, 0
 v_mov_b32 v195, 0
 v_mov_b32 v196, 0
 v_mov_b32 v197, 0
 v_mov_b32 v198, 0
 v_mov_b32 v199, 0xf149f2ca
 v_mov_b32 v204, 0
 v_mov_b32 v205, 0
 v_mov_b32 v206, 0
 v_mov_b32 v207, 0
 s_nop 1
 v_mfma_f32_32x32x16_bf16 a[0:15], v[252:255], v[252:255], 0
 v_mfma_f32_32x32x16_bf16 a[16:31], v[252:255], v[252:255], 0
 v_mfma_f32_32x32x16_bf16 a[32:47], v[252:255], v[252:255], 0
 v_mfma_f32_32x32x16_bf16 a[48:63], v[252:255], v[252:255], 0
 v_mfma_f32_32x32x16_bf16 a[64:79], v[252:255], v[252:255], 0
 v_mfma_f32_32x32x16_bf16 a[80:95], v[252:255], v[252:255], 0
 v_mfma_f32_32x32x16_bf16 a[96:111], v[252:255], v[252:255], 0
 v_mfma_f32_32x32x16_bf16 a[112:127], v[252:255], v[252:255], 0
 v_mfma_f32_32x32x16_bf16 a[128:143], v[252:255], v[252:255], 0
 v_mfma_f32_32x32x16_bf16 a[144:159], v[252:255], v[252:255], 0
 v_mfma_f32_32x32x16_bf16 a[160:175], v[252:255], v[252:255], 0
 v_mfma_f32_32x32x16_bf16 a[176:191], v[252:255], v[252:255], 0
 v_mfma_f32_32x32x16_bf16 a[224:239], v[252:255], v[252:255], 0
 v_mfma_f32_32x32x16_bf16 a[240:255], v[252:255], v[252:255], 0
 s_sub_u32 s57, 0, s40
 s_lshl_b32 s42, s40, 13
 s_add_u32 s50, s58, 49152
 s_sub_u32 s50, s50, s42
 s_and_b32 s50, s50, 262143
 s_add_u32 s51, s50, 4096
 s_mov_b32 s45, 0
 s_waitcnt vmcnt(0)
 s_barrier
 ds_read_b64 a[192:193], v32
 ds_read_b64 a[194:195], v33
 ds_read_b64 a[196:197], v32 offset:4096
 ds_read_b64 a[198:199], v33 offset:4096
 ds_read_b64 a[200:201], v34
 ds_read_b64 a[202:203], v35
 ds_read_b64 a[204:205], v34 offset:4096
 ds_read_b64 a[206:207], v35 offset:4096
 ds_read_b64 a[208:209], v36
 ds_read_b64 a[210:211], v37
 ds_read_b64 a[212:213], v36 offset:4096
 ds_read_b64 a[214:215], v37 offset:4096
 ds_read_b64 a[216:217], v38
 ds_read_b64 a[218:219], v39
 ds_read_b64 a[220:221], v38 offset:4096
 ds_read_b64 a[222:223], v39 offset:4096
 s_waitcnt lgkmcnt(0)
 s_nop 15
 s_branch L1_tile0
L_text_end:
.section .rodata,"a"
.p2align 6
.amdhsa_kernel mha_qattn_kernel
  .amdhsa_next_free_vgpr 512
  .amdhsa_next_free_sgpr 102
  .amdhsa_accum_offset 256
  .amdhsa_group_segment_fixed_size 0
  .amdhsa_kernarg_size 64
  .amdhsa_user_sgpr_count 2
  .amdhsa_user_sgpr_kernarg_segment_ptr 1
  .amdhsa_system_sgpr_workgroup_id_x 1
.end_amdhsa_kernel
```
